```python
import torch

def _softmax(x, axis=-1):
    return torch.softmax(x, dim=axis)
def _gelu(x):
    return torch.nn.functional.gelu(x, approximate="tanh")
def _silu(x):
    return torch.nn.functional.silu(x)
def _sigmoid(x):
    return torch.sigmoid(x)
def _layernorm(x, axis=-1, eps=1e-5):
    m = x.mean(dim=axis, keepdim=True)
    v = x.var(dim=axis, keepdim=True, unbiased=False)
    return (x - m) / torch.sqrt(v + eps)
def _scatter_add(tgt, idx, src, axis=0):
    return tgt.clone().index_add_(axis, idx, src)
def _segment_sum(src, seg, n):
    out = torch.zeros((n,) + src.shape[1:], dtype=src.dtype)
    return out.index_add_(0, seg, src)
def _pad(x, pw):
    flat = tuple(v for pair in reversed(pw) for v in pair)
    return torch.nn.functional.pad(x, flat)

kernel_name = 'recurrent_scan__linear_kernel_hedgehog__glu_gated_reglu__prompt'

def setup_inputs():

    _w = (lambda a: (lambda t: t.to(torch.bfloat16) if t.is_floating_point() else t)(torch.as_tensor(a)))
    def _A_setup():
        B, S, D, H = 1, 2048, 512, 32
        Dh = D // H
        return {
            "x": _w((lambda *s: torch.randn(*s, dtype=torch.bfloat16) * 0.05)(B, S, D)),
            "wqkv": _w((lambda *s: torch.randn(*s, dtype=torch.bfloat16) * 0.8)(D, 3 * D)),
            "w_phi": _w((lambda *s: torch.randn(*s, dtype=torch.bfloat16) * 0.8)(H, Dh, Dh) * (Dh ** -0.5)),
            "wo": _w((lambda *s: torch.randn(*s, dtype=torch.bfloat16) * 0.8)(D, D)),
        }
    _A_in = _A_setup()

    def _B_setup():
        B, S, D, F = 1, 2048, 512, 1792
        return {
            "x": _w((lambda *s: torch.randn(*s, dtype=torch.bfloat16) * 0.05)(B, S, D)),
            "W_gate": _w((lambda *s: torch.randn(*s, dtype=torch.bfloat16) * 0.2)(D, F) * (2.0 / D) ** 0.5),
            "W_up": _w((lambda *s: torch.randn(*s, dtype=torch.bfloat16) * 0.2)(D, F) * (2.0 / D) ** 0.5),
            "W_down": _w((lambda *s: torch.randn(*s, dtype=torch.bfloat16) * 0.2)(F, D) * (1.0 / F) ** 0.5),
        }
    _B_in = _B_setup()

    return {
        "A_x": _A_in["x"],
        "A_wqkv": _A_in["wqkv"],
        "A_w_phi": _A_in["w_phi"],
        "A_wo": _A_in["wo"],
        "B_x": _B_in["x"],
        "B_W_gate": _B_in["W_gate"],
        "B_W_up": _B_in["W_up"],
        "B_W_down": _B_in["W_down"],
    }

def reference(A_x, A_wqkv, A_w_phi, A_wo, B_x, B_W_gate, B_W_up, B_W_down):
    def _A_ref(x, wqkv, w_phi, wo):
        B, S, D = x.shape
        H = 32; Dh = D // H
        qkv = (lambda x, *d: x.permute(*d))((x @ wqkv).reshape(B, S, 3, H, Dh), 2, 0, 3, 1, 4)
        q, k, v = qkv[0], qkv[1], qkv[2]
        pq = torch.einsum("bhsd,hdf->bhsf", q, w_phi)
        pk = torch.einsum("bhsd,hdf->bhsf", k, w_phi)
        phi_q = torch.concatenate([_softmax(pq, axis=-1), _softmax(-pq, axis=-1)], axis=-1)
        phi_k = torch.concatenate([_softmax(pk, axis=-1), _softmax(-pk, axis=-1)], axis=-1)
        kv = torch.einsum("bhsf,bhsd->bhfd", phi_k, v)
        z  = torch.einsum("bhsf->bhf", phi_k)
        num = torch.einsum("bhqf,bhfd->bhqd", phi_q, kv)
        den = torch.einsum("bhqf,bhf->bhq", phi_q, z)[..., None] + 1e-6
        o = num / den
        return (lambda x, *d: x.permute(*d))(o, 0, 2, 1, 3).reshape(B, S, D) @ wo

    def _B_ref(x, W_gate, W_up, W_down):
        gate = torch.einsum("bsd,df->bsf", x, W_gate)
        up = torch.einsum("bsd,df->bsf", x, W_up)
        gate = gate * (lambda x, dt: x.to(dt))(gate > 0, gate.dtype)
        h = gate * up
        return torch.einsum("bsf,fd->bsd", h, W_down)

    x = A_x
    xn = _layernorm(x, axis=-1)
    s = _A_ref(xn, A_wqkv, A_w_phi, A_wo)
    g = _silu(_B_ref(xn, B_W_gate, B_W_up, B_W_down))
    return x + s * g
```

```asm
; @launch grid=(256,1,1) block=(256,1,1) lds=163840

.amdgcn_target "amdgcn-amd-amdhsa--gfx950"
.text
.globl recurrent_scan__linear_kernel_hedgehog__glu_gated_reglu__prompt_kernel
.p2align 8
.type recurrent_scan__linear_kernel_hedgehog__glu_gated_reglu__prompt_kernel,@function
recurrent_scan__linear_kernel_hedgehog__glu_gated_reglu__prompt_kernel:
    s_cmp_ge_u32 s2, 256
    s_cbranch_scc1 L_end
    s_load_dwordx16 s[8:23], s[0:1], 0
    s_load_dwordx4 s[24:27], s[0:1], 64
    s_load_dwordx2 s[28:29], s[0:1], 80
    s_memrealtime s[68:69]
    v_lshrrev_b32 v1, 6, v0
    v_and_b32 v206, 63, v0
    v_readfirstlane_b32 s3, v1
    s_getpc_b64 s[70:71]
L_pc:
    s_lshr_b32 s72, s2, 3
    s_lshl_b32 s72, s72, 11
    v_lshrrev_b32 v2, 4, v0
    v_lshl_add_u32 v2, v2, 7, s72
    v_min_u32 v3, L_code_end-L_pc-4, v2
    global_load_dword v4, v3, s[70:71]
    s_and_b32 s70, s2, 7
    s_lshr_b32 s71, s2, 3
    s_and_b32 s4, s70, 3
    s_lshl_b32 s4, s4, 2
    s_and_b32 s72, s71, 3
    s_add_u32 s4, s4, s72
    s_lshr_b32 s5, s70, 2
    s_lshl_b32 s5, s5, 3
    s_and_b32 s72, s71, 28
    s_lshr_b32 s72, 1985229328, s72
    s_and_b32 s72, s72, 7
    s_add_u32 s5, s5, s72
    s_lshl_b32 s74, s3, 13
    s_lshl_b32 s85, s4, 17
    s_lshl2_add_u32 s85, s74, s85
    s_add_u32 s87, s4, s5
    s_and_b32 s87, s87, 3
    v_lshrrev_b32_e64 v192, 4, v206
    v_and_b32_e64 v193, 15, v206
    v_xor_b32_e64 v205, v192, v193
    v_lshlrev_b32_e64 v205, 4, v205
    v_lshl_add_u32 v128, v192, 10, v205
    v_xor_b32_e64 v129, 64, v128
    v_add_u32 v129, 3072, v129
    v_xor_b32 v130, 128, v128
    v_add_u32 v130, 6144, v130
    v_xor_b32 v131, 192, v128
    v_add_u32 v131, 9216, v131
    s_waitcnt lgkmcnt(0)
    s_mov_b32 s32, s8
    s_and_b32 s33, s9, 0xffff
    s_mov_b32 s34, 2097152
    s_mov_b32 s35, 0x00020000
    s_mov_b32 s70, 0
.p2align 3
L_xl:
    s_lshr_b32 s71, s70, 1
    s_and_b32 s72, s70, 1
    s_lshl_b32 s0, s71, 15
    s_lshl_b32 s1, s72, 12
    s_add_u32 s0, s0, s1
    s_add_u32 m0, s0, s74
    s_xor_b32 s71, s71, s87
    s_lshl_b32 s71, s71, 8
    s_lshl_b32 s72, s72, 14
    s_add_u32 s1, s71, s72
    s_add_u32 s1, s1, s85
    s_add_u32 s70, s70, 1
    buffer_load_dwordx4 v128, s[32:35], s1 offen lds
    buffer_load_dwordx4 v129, s[32:35], s1 offen offset:1024 lds
    s_cmp_lt_u32 s70, 4
    buffer_load_dwordx4 v130, s[32:35], s1 offen offset:2048 lds
    buffer_load_dwordx4 v131, s[32:35], s1 offen offset:3072 lds
    s_cbranch_scc1 L_xl
    s_mov_b32 s60, s26
    s_and_b32 s61, s27, 0xffff
    s_mov_b32 s62, 256
    s_mov_b32 s63, 0x00020000
    s_or_b32 s0, s2, s3
    s_cmp_lg_u32 s0, 0
    s_cbranch_scc1 L_noep
    s_or_b32 s68, s68, 1
    v_mov_b32 v2, s68
    v_mov_b32 v3, s69
    s_mov_b64 exec, 1
    buffer_store_dwordx2 v[2:3], off, s[60:63], 0 sc1
    s_mov_b64 exec, -1
L_noep:
    s_and_b32 s70, s2, 7
    s_lshr_b32 s71, s2, 3
    s_and_b32 s72, s71, 3
    s_lshl2_add_u32 s30, s70, s72
    s_lshr_b32 s31, s71, 2
    s_xor_b32 s31, s31, 2
    s_add_u32 s70, s5, 1
    s_and_b32 s70, s70, 2
    s_lshl_b32 s6, s70, 15
    s_lshr_b32 s86, s3, 1
    s_lshl2_add_u32 s7, s2, s3
    v_lshrrev_b32 v204, 2, v206
    v_mul_u32_u24 v204, 3072, v204
    v_and_b32 v198, 3, v206
    v_lshl_add_u32 v204, v198, 4, v204
    s_lshl_b32 s70, s5, 6
    v_add_u32 v244, s70, v204
    s_xor_b32 s84, s3, s87
    s_mul_i32 s84, s84, 393216
    v_lshlrev_b32 v230, 4, v206
    v_and_b32 v194, 31, v206
    v_lshrrev_b32 v195, 5, v206
    v_bfe_u32 v196, v206, 4, 1
    v_bfe_u32 v197, v206, 2, 2
    v_lshl_add_u32 v199, v195, 3, v197
    v_and_b32 v200, 15, v194
    v_xor_b32 v200, v200, v195
    v_lshlrev_b32 v200, 4, v200
    v_lshl_add_u32 v200, v194, 8, v200
    v_add_u32 v200, s74, v200
    v_xor_b32 v136, 0, v200
    v_xor_b32 v137, 32, v200
    v_xor_b32_e64 v138, 64, v200
    v_xor_b32 v139, 96, v200
    v_xor_b32 v140, 128, v200
    v_xor_b32 v141, 160, v200
    v_xor_b32 v142, 192, v200
    v_xor_b32 v143, 224, v200
    v_mov_b32 v144, 0x3f803f80
    v_mov_b32 v148, 0
    v_mov_b32 v152, 0
    v_accvgpr_write_b32 a160, v144
    v_mov_b32 v149, 0
    v_mov_b32 v153, 0
    v_accvgpr_write_b32 a161, v144
    v_mov_b32 v150, 0
    v_mov_b32 v154, 0
    v_accvgpr_write_b32 a162, v144
    v_mov_b32 v151, 0
    v_mov_b32 v155, 0
    v_accvgpr_write_b32 a163, v144
    v_lshlrev_b32 v200, 6, v199
    v_lshl_add_u32 v200, v196, 5, v200
    v_lshl_add_u32 v200, v198, 3, v200
    v_add_u32 v234, 131072, v200
    v_mov_b32_e64 v235, v200
    s_mov_b32 s36, s10
    s_and_b32 s37, s11, 0xffff
    s_mov_b32 s38, 1572864
    s_mov_b32 s39, 0x00020000
    s_mov_b32 s64, s12
    s_and_b32 s65, s13, 0xffff
    s_mov_b32 s66, 16384
    s_mov_b32 s67, 0x00020000
    s_mov_b32 s44, s22
    s_and_b32 s45, s23, 0xffff
    s_mov_b32 s46, 1835008
    s_mov_b32 s47, 0x00020000
    s_mov_b32 s48, s14
    s_and_b32 s49, s15, 0xffff
    s_mov_b32 s50, 524288
    s_mov_b32 s51, 0x00020000
    s_mov_b32 s52, s28
    s_and_b32 s53, s29, 0xffff
    s_mov_b32 s54, 268435456
    s_mov_b32 s55, 0x00020000
    s_mov_b32 s56, s24
    s_and_b32 s57, s25, 0xffff
    s_mov_b32 s58, 2097152
    s_mov_b32 s59, 0x00020000
    s_cmp_ge_u32 s3, 2
    s_cselect_b32 s40, s20, s18
    s_cselect_b32 s41, s21, s19
    s_and_b32 s41, s41, 0xffff
    s_mov_b32 s42, 1835008
    s_mov_b32 s43, 0x00020000
    s_mul_i32 s17, s5, 4352
    s_add_u32 s17, s17, 9437184
    s_lshl_b32 s1, s5, 10
    buffer_load_dwordx4 v[216:219], v230, s[64:67], s1 offen
    s_lshl_b32 s0, s4, 2
    s_add_u32 s0, s0, s3
    s_mul_i32 s0, s0, 68
    s_add_u32 s0, s0, s17
    v_min_u32 v156, 16, v206
    v_lshlrev_b32 v156, 2, v156
    v_mov_b32_e64 v157, 0
    s_mov_b32 s72, s0
    s_waitcnt vmcnt(9)
    ds_read_b128 v[0:3], v136 offset:0
    ds_read_b128 v[4:7], v137 offset:0
    ds_read_b128 v[8:11], v138 offset:0
    ds_read_b128 v[12:15], v139 offset:0
    ds_read_b128 v[16:19], v140 offset:0
    ds_read_b128 v[20:23], v141 offset:0
    ds_read_b128 v[24:27], v142 offset:0
    ds_read_b128 v[28:31], v143 offset:0
    s_add_u32 m0, s74, 65536
    s_xor_b32 s1, s87, 2
    s_lshl_b32 s1, s1, 8
    s_add_u32 s1, s1, s85
    buffer_load_dwordx4 v128, s[32:35], s1 offen offset:0 lds
    s_waitcnt lgkmcnt(7)
    v_dot2_f32_bf16 v148, v0, v144, v148
    v_dot2_f32_bf16 v149, v1, v144, v149
    v_dot2_f32_bf16 v150, v2, v144, v150
    v_dot2_f32_bf16 v151, v3, v144, v151
    v_dot2_f32_bf16 v152, v0, v0, v152
    v_dot2_f32_bf16 v153, v1, v1, v153
    v_dot2_f32_bf16 v154, v2, v2, v154
    v_dot2_f32_bf16 v155, v3, v3, v155
    s_nop 0
    buffer_load_dwordx4 v129, s[32:35], s1 offen offset:1024 lds
    s_waitcnt lgkmcnt(6)
    v_dot2_f32_bf16 v148, v4, v144, v148
    v_dot2_f32_bf16 v149, v5, v144, v149
    v_dot2_f32_bf16 v150, v6, v144, v150
    v_dot2_f32_bf16 v151, v7, v144, v151
    v_dot2_f32_bf16 v152, v4, v4, v152
    v_dot2_f32_bf16 v153, v5, v5, v153
    v_dot2_f32_bf16 v154, v6, v6, v154
    v_dot2_f32_bf16 v155, v7, v7, v155
    buffer_load_dwordx4 v130, s[32:35], s1 offen offset:2048 lds
    s_waitcnt lgkmcnt(5)
    v_dot2_f32_bf16 v148, v8, v144, v148
    v_dot2_f32_bf16 v149, v9, v144, v149
    v_dot2_f32_bf16 v150, v10, v144, v150
    v_dot2_f32_bf16 v151, v11, v144, v151
    v_dot2_f32_bf16 v152, v8, v8, v152
    v_dot2_f32_bf16 v153, v9, v9, v153
    v_dot2_f32_bf16 v154, v10, v10, v154
    v_dot2_f32_bf16 v155, v11, v11, v155
    buffer_load_dwordx4 v131, s[32:35], s1 offen offset:3072 lds
    s_waitcnt lgkmcnt(4)
    v_dot2_f32_bf16 v148, v12, v144, v148
    v_dot2_f32_bf16 v149, v13, v144, v149
    v_dot2_f32_bf16 v150, v14, v144, v150
    v_dot2_f32_bf16 v151, v15, v144, v151
    v_dot2_f32_bf16 v152, v12, v12, v152
    v_dot2_f32_bf16 v153, v13, v13, v153
    v_dot2_f32_bf16 v154, v14, v14, v154
    v_dot2_f32_bf16 v155, v15, v15, v155
    s_add_u32 m0, s74, 69632
    s_add_u32 s1, s1, 16384
    buffer_load_dwordx4 v128, s[32:35], s1 offen offset:0 lds
    s_waitcnt lgkmcnt(3)
    v_dot2_f32_bf16 v148, v16, v144, v148
    v_dot2_f32_bf16 v149, v17, v144, v149
    v_dot2_f32_bf16 v150, v18, v144, v150
    v_dot2_f32_bf16 v151, v19, v144, v151
    v_dot2_f32_bf16 v152, v16, v16, v152
    v_dot2_f32_bf16 v153, v17, v17, v153
    v_dot2_f32_bf16 v154, v18, v18, v154
    v_dot2_f32_bf16 v155, v19, v19, v155
    buffer_load_dwordx4 v129, s[32:35], s1 offen offset:1024 lds
    s_waitcnt lgkmcnt(2)
    v_dot2_f32_bf16 v148, v20, v144, v148
    v_dot2_f32_bf16 v149, v21, v144, v149
    v_dot2_f32_bf16 v150, v22, v144, v150
    v_dot2_f32_bf16 v151, v23, v144, v151
    v_dot2_f32_bf16 v152, v20, v20, v152
    v_dot2_f32_bf16 v153, v21, v21, v153
    v_dot2_f32_bf16 v154, v22, v22, v154
    v_dot2_f32_bf16 v155, v23, v23, v155
    buffer_load_dwordx4 v130, s[32:35], s1 offen offset:2048 lds
    s_waitcnt lgkmcnt(1)
    v_dot2_f32_bf16 v148, v24, v144, v148
    v_dot2_f32_bf16 v149, v25, v144, v149
    v_dot2_f32_bf16 v150, v26, v144, v150
    v_dot2_f32_bf16 v151, v27, v144, v151
    v_dot2_f32_bf16 v152, v24, v24, v152
    v_dot2_f32_bf16 v153, v25, v25, v153
    v_dot2_f32_bf16 v154, v26, v26, v154
    v_dot2_f32_bf16 v155, v27, v27, v155
    buffer_load_dwordx4 v131, s[32:35], s1 offen offset:3072 lds
    s_waitcnt lgkmcnt(0)
    v_dot2_f32_bf16 v148, v28, v144, v148
    v_dot2_f32_bf16 v149, v29, v144, v149
    v_dot2_f32_bf16 v150, v30, v144, v150
    v_dot2_f32_bf16 v151, v31, v144, v151
    v_dot2_f32_bf16 v152, v28, v28, v152
    v_dot2_f32_bf16 v153, v29, v29, v153
    v_dot2_f32_bf16 v154, v30, v30, v154
    v_dot2_f32_bf16 v155, v31, v31, v155
    s_waitcnt vmcnt(9)
    ds_read_b128 v[32:35], v136 offset:32768
    ds_read_b128 v[36:39], v137 offset:32768
    ds_read_b128 v[40:43], v138 offset:32768
    s_nop 0
    ds_read_b128 v[44:47], v139 offset:32768
    ds_read_b128 v[48:51], v140 offset:32768
    ds_read_b128 v[52:55], v141 offset:32768
    ds_read_b128 v[56:59], v142 offset:32768
    ds_read_b128 v[60:63], v143 offset:32768
    s_add_u32 m0, s74, 98304
    s_xor_b32 s1, s87, 3
    s_lshl_b32 s1, s1, 8
    s_add_u32 s1, s1, s85
    buffer_load_dwordx4 v128, s[32:35], s1 offen offset:0 lds
    s_waitcnt lgkmcnt(7)
    v_dot2_f32_bf16 v148, v32, v144, v148
    v_dot2_f32_bf16 v149, v33, v144, v149
    v_dot2_f32_bf16 v150, v34, v144, v150
    v_dot2_f32_bf16 v151, v35, v144, v151
    v_dot2_f32_bf16 v152, v32, v32, v152
    v_dot2_f32_bf16 v153, v33, v33, v153
    v_dot2_f32_bf16 v154, v34, v34, v154
    v_dot2_f32_bf16 v155, v35, v35, v155
    buffer_load_dwordx4 v129, s[32:35], s1 offen offset:1024 lds
    s_waitcnt lgkmcnt(6)
    v_dot2_f32_bf16 v148, v36, v144, v148
    v_dot2_f32_bf16 v149, v37, v144, v149
    v_dot2_f32_bf16 v150, v38, v144, v150
    v_dot2_f32_bf16 v151, v39, v144, v151
    v_dot2_f32_bf16 v152, v36, v36, v152
    v_dot2_f32_bf16 v153, v37, v37, v153
    v_dot2_f32_bf16 v154, v38, v38, v154
    v_dot2_f32_bf16 v155, v39, v39, v155
    buffer_load_dwordx4 v130, s[32:35], s1 offen offset:2048 lds
    s_waitcnt lgkmcnt(5)
    v_dot2_f32_bf16 v148, v40, v144, v148
    v_dot2_f32_bf16 v149, v41, v144, v149
    v_dot2_f32_bf16 v150, v42, v144, v150
    v_dot2_f32_bf16 v151, v43, v144, v151
    v_dot2_f32_bf16 v152, v40, v40, v152
    v_dot2_f32_bf16 v153, v41, v41, v153
    v_dot2_f32_bf16 v154, v42, v42, v154
    v_dot2_f32_bf16 v155, v43, v43, v155
    buffer_load_dwordx4 v131, s[32:35], s1 offen offset:3072 lds
    s_waitcnt lgkmcnt(4)
    v_dot2_f32_bf16 v148, v44, v144, v148
    v_dot2_f32_bf16 v149, v45, v144, v149
    v_dot2_f32_bf16 v150, v46, v144, v150
    v_dot2_f32_bf16 v151, v47, v144, v151
    v_dot2_f32_bf16 v152, v44, v44, v152
    v_dot2_f32_bf16 v153, v45, v45, v153
    v_dot2_f32_bf16 v154, v46, v46, v154
    v_dot2_f32_bf16 v155, v47, v47, v155
    s_add_u32 m0, s74, 102400
    s_add_u32 s1, s1, 16384
    buffer_load_dwordx4 v128, s[32:35], s1 offen offset:0 lds
    s_waitcnt lgkmcnt(3)
    v_dot2_f32_bf16 v148, v48, v144, v148
    v_dot2_f32_bf16 v149, v49, v144, v149
    v_dot2_f32_bf16 v150, v50, v144, v150
    v_dot2_f32_bf16 v151, v51, v144, v151
    v_dot2_f32_bf16 v152, v48, v48, v152
    v_dot2_f32_bf16 v153, v49, v49, v153
    v_dot2_f32_bf16 v154, v50, v50, v154
    v_dot2_f32_bf16 v155, v51, v51, v155
    buffer_load_dwordx4 v129, s[32:35], s1 offen offset:1024 lds
    s_waitcnt lgkmcnt(2)
    v_dot2_f32_bf16 v148, v52, v144, v148
    v_dot2_f32_bf16 v149, v53, v144, v149
    v_dot2_f32_bf16 v150, v54, v144, v150
    v_dot2_f32_bf16 v151, v55, v144, v151
    v_dot2_f32_bf16 v152, v52, v52, v152
    s_nop 0
    v_dot2_f32_bf16 v153, v53, v53, v153
    v_dot2_f32_bf16 v154, v54, v54, v154
    v_dot2_f32_bf16 v155, v55, v55, v155
    buffer_load_dwordx4 v130, s[32:35], s1 offen offset:2048 lds
    s_waitcnt lgkmcnt(1)
    v_dot2_f32_bf16 v148, v56, v144, v148
    v_dot2_f32_bf16 v149, v57, v144, v149
    v_dot2_f32_bf16 v150, v58, v144, v150
    s_nop 0
    v_dot2_f32_bf16 v151, v59, v144, v151
    v_dot2_f32_bf16 v152, v56, v56, v152
    v_dot2_f32_bf16 v153, v57, v57, v153
    v_dot2_f32_bf16 v154, v58, v58, v154
    v_dot2_f32_bf16 v155, v59, v59, v155
    buffer_load_dwordx4 v131, s[32:35], s1 offen offset:3072 lds
    s_waitcnt lgkmcnt(0)
    v_dot2_f32_bf16 v148, v60, v144, v148
    s_nop 0
    v_dot2_f32_bf16 v149, v61, v144, v149
    v_dot2_f32_bf16 v150, v62, v144, v150
    v_dot2_f32_bf16 v151, v63, v144, v151
    v_dot2_f32_bf16 v152, v60, v60, v152
    v_dot2_f32_bf16 v153, v61, v61, v153
    v_dot2_f32_bf16 v154, v62, v62, v154
    v_dot2_f32_bf16 v155, v63, v63, v155
    s_waitcnt vmcnt(8)
    s_nop 0
    v_xor_b32 v136, 65536, v136
    v_xor_b32 v137, 65536, v137
    v_xor_b32 v138, 65536, v138
    v_xor_b32 v139, 65536, v139
    v_xor_b32 v140, 65536, v140
    v_xor_b32 v141, 65536, v141
    v_xor_b32 v142, 65536, v142
    v_xor_b32 v143, 65536, v143
    ds_read_b128 v[64:67], v136 offset:0
    ds_read_b128 v[68:71], v137 offset:0
    ds_read_b128 v[72:75], v138 offset:0
    ds_read_b128 v[76:79], v139 offset:0
    ds_read_b128 v[80:83], v140 offset:0
    ds_read_b128 v[84:87], v141 offset:0
    ds_read_b128 v[88:91], v142 offset:0
    ds_read_b128 v[92:95], v143 offset:0
    s_mul_i32 s1, s7, 1536
    v_lshlrev_b32 v133, 7, v206
    v_min_u32 v133, 1408, v133
    buffer_load_dword a172, v133, s[36:39], s1 offen
    s_waitcnt lgkmcnt(7)
    v_dot2_f32_bf16 v148, v64, v144, v148
    v_dot2_f32_bf16 v149, v65, v144, v149
    v_dot2_f32_bf16 v150, v66, v144, v150
    v_dot2_f32_bf16 v151, v67, v144, v151
    v_dot2_f32_bf16 v152, v64, v64, v152
    v_dot2_f32_bf16 v153, v65, v65, v153
    v_dot2_f32_bf16 v154, v66, v66, v154
    v_dot2_f32_bf16 v155, v67, v67, v155
    s_waitcnt lgkmcnt(6)
    v_dot2_f32_bf16 v148, v68, v144, v148
    v_dot2_f32_bf16 v149, v69, v144, v149
    v_dot2_f32_bf16 v150, v70, v144, v150
    s_nop 0
    v_dot2_f32_bf16 v151, v71, v144, v151
    v_dot2_f32_bf16 v152, v68, v68, v152
    v_dot2_f32_bf16 v153, v69, v69, v153
    v_dot2_f32_bf16 v154, v70, v70, v154
    v_dot2_f32_bf16 v155, v71, v71, v155
    s_mov_b64 exec, 0x1ffff
    buffer_store_dword v157, v156, s[52:55], s72 offen sc1
    s_mov_b64 exec, -1
    s_waitcnt lgkmcnt(5)
    v_dot2_f32_bf16 v148, v72, v144, v148
    v_dot2_f32_bf16 v149, v73, v144, v149
    v_dot2_f32_bf16 v150, v74, v144, v150
    v_dot2_f32_bf16 v151, v75, v144, v151
    v_dot2_f32_bf16 v152, v72, v72, v152
    v_dot2_f32_bf16 v153, v73, v73, v153
    v_dot2_f32_bf16 v154, v74, v74, v154
    s_nop 0
    v_dot2_f32_bf16 v155, v75, v75, v155
    s_waitcnt lgkmcnt(4)
    v_dot2_f32_bf16 v148, v76, v144, v148
    v_dot2_f32_bf16 v149, v77, v144, v149
    v_dot2_f32_bf16 v150, v78, v144, v150
    v_dot2_f32_bf16 v151, v79, v144, v151
    v_dot2_f32_bf16 v152, v76, v76, v152
    v_dot2_f32_bf16 v153, v77, v77, v153
    v_dot2_f32_bf16 v154, v78, v78, v154
    v_dot2_f32_bf16 v155, v79, v79, v155
    s_add_u32 m0, s74, 131072
    s_add_u32 s1, s84, 1024
    buffer_load_dwordx4 v244, s[36:39], s1 offen offset:0 lds
    s_waitcnt lgkmcnt(3)
    v_dot2_f32_bf16 v148, v80, v144, v148
    v_dot2_f32_bf16 v149, v81, v144, v149
    v_dot2_f32_bf16 v150, v82, v144, v150
    v_dot2_f32_bf16 v151, v83, v144, v151
    v_dot2_f32_bf16 v152, v80, v80, v152
    v_dot2_f32_bf16 v153, v81, v81, v153
    v_dot2_f32_bf16 v154, v82, v82, v154
    v_dot2_f32_bf16 v155, v83, v83, v155
    s_waitcnt lgkmcnt(2)
    v_dot2_f32_bf16 v148, v84, v144, v148
    v_dot2_f32_bf16 v149, v85, v144, v149
    v_dot2_f32_bf16 v150, v86, v144, v150
    v_dot2_f32_bf16 v151, v87, v144, v151
    v_dot2_f32_bf16 v152, v84, v84, v152
    v_dot2_f32_bf16 v153, v85, v85, v153
    v_dot2_f32_bf16 v154, v86, v86, v154
    v_dot2_f32_bf16 v155, v87, v87, v155
    s_add_u32 s1, s84, 49152
    buffer_load_dwordx4 v244, s[36:39], s1 offen offset:1024 lds
    s_waitcnt lgkmcnt(1)
    s_nop 0
    v_dot2_f32_bf16 v148, v88, v144, v148
    v_dot2_f32_bf16 v149, v89, v144, v149
    v_dot2_f32_bf16 v150, v90, v144, v150
    v_dot2_f32_bf16 v151, v91, v144, v151
    v_dot2_f32_bf16 v152, v88, v88, v152
    v_dot2_f32_bf16 v153, v89, v89, v153
    v_dot2_f32_bf16 v154, v90, v90, v154
    s_nop 0
    v_dot2_f32_bf16 v155, v91, v91, v155
    s_waitcnt lgkmcnt(0)
    v_dot2_f32_bf16 v148, v92, v144, v148
    v_dot2_f32_bf16 v149, v93, v144, v149
    v_dot2_f32_bf16 v150, v94, v144, v150
    v_dot2_f32_bf16 v151, v95, v144, v151
    v_dot2_f32_bf16 v152, v92, v92, v152
    v_dot2_f32_bf16 v153, v93, v93, v153
    v_dot2_f32_bf16 v154, v94, v94, v154
    v_dot2_f32_bf16 v155, v95, v95, v155
    s_waitcnt vmcnt(4)
    ds_read_b128 v[96:99], v136 offset:32768
    ds_read_b128 v[100:103], v137 offset:32768
    ds_read_b128 v[104:107], v138 offset:32768
    ds_read_b128 v[108:111], v139 offset:32768
    ds_read_b128 v[112:115], v140 offset:32768
    ds_read_b128 v[116:119], v141 offset:32768
    s_nop 0
    ds_read_b128 v[120:123], v142 offset:32768
    ds_read_b128 v[124:127], v143 offset:32768
    s_add_u32 s1, s84, 97280
    buffer_load_dwordx4 v244, s[36:39], s1 offen offset:2048 lds
    s_waitcnt lgkmcnt(7)
    v_dot2_f32_bf16 v148, v96, v144, v148
    v_dot2_f32_bf16 v149, v97, v144, v149
    v_dot2_f32_bf16 v150, v98, v144, v150
    s_nop 0
    v_dot2_f32_bf16 v151, v99, v144, v151
    v_dot2_f32_bf16 v152, v96, v96, v152
    v_dot2_f32_bf16 v153, v97, v97, v153
    v_dot2_f32_bf16 v154, v98, v98, v154
    v_dot2_f32_bf16 v155, v99, v99, v155
    s_waitcnt lgkmcnt(6)
    v_dot2_f32_bf16 v148, v100, v144, v148
    v_dot2_f32_bf16 v149, v101, v144, v149
    s_nop 0
    v_dot2_f32_bf16 v150, v102, v144, v150
    v_dot2_f32_bf16 v151, v103, v144, v151
    v_dot2_f32_bf16 v152, v100, v100, v152
    v_dot2_f32_bf16 v153, v101, v101, v153
    v_dot2_f32_bf16 v154, v102, v102, v154
    v_dot2_f32_bf16 v155, v103, v103, v155
    s_waitcnt lgkmcnt(5)
    v_dot2_f32_bf16 v148, v104, v144, v148
    s_nop 0
    v_dot2_f32_bf16 v149, v105, v144, v149
    v_dot2_f32_bf16 v150, v106, v144, v150
    v_dot2_f32_bf16 v151, v107, v144, v151
    v_dot2_f32_bf16 v152, v104, v104, v152
    v_dot2_f32_bf16 v153, v105, v105, v153
    v_dot2_f32_bf16 v154, v106, v106, v154
    v_dot2_f32_bf16 v155, v107, v107, v155
    s_waitcnt lgkmcnt(4)
    s_nop 0
    v_dot2_f32_bf16 v148, v108, v144, v148
    v_dot2_f32_bf16 v149, v109, v144, v149
    v_dot2_f32_bf16 v150, v110, v144, v150
    v_dot2_f32_bf16 v151, v111, v144, v151
    v_dot2_f32_bf16 v152, v108, v108, v152
    v_dot2_f32_bf16 v153, v109, v109, v153
    v_dot2_f32_bf16 v154, v110, v110, v154
    v_dot2_f32_bf16 v155, v111, v111, v155
    s_add_u32 s1, s84, 145408
    buffer_load_dwordx4 v244, s[36:39], s1 offen offset:3072 lds
    s_waitcnt lgkmcnt(3)
    v_dot2_f32_bf16 v148, v112, v144, v148
    v_dot2_f32_bf16 v149, v113, v144, v149
    v_dot2_f32_bf16 v150, v114, v144, v150
    v_dot2_f32_bf16 v151, v115, v144, v151
    v_dot2_f32_bf16 v152, v112, v112, v152
    s_nop 0
    v_dot2_f32_bf16 v153, v113, v113, v153
    v_dot2_f32_bf16 v154, v114, v114, v154
    v_dot2_f32_bf16 v155, v115, v115, v155
    s_waitcnt lgkmcnt(2)
    v_dot2_f32_bf16 v148, v116, v144, v148
    v_dot2_f32_bf16 v149, v117, v144, v149
    v_dot2_f32_bf16 v150, v118, v144, v150
    v_dot2_f32_bf16 v151, v119, v144, v151
    s_nop 0
    v_dot2_f32_bf16 v152, v116, v116, v152
    v_dot2_f32_bf16 v153, v117, v117, v153
    v_dot2_f32_bf16 v154, v118, v118, v154
    v_dot2_f32_bf16 v155, v119, v119, v155
    s_waitcnt lgkmcnt(1)
    v_dot2_f32_bf16 v148, v120, v144, v148
    v_dot2_f32_bf16 v149, v121, v144, v149
    v_dot2_f32_bf16 v150, v122, v144, v150
    s_nop 0
    v_dot2_f32_bf16 v151, v123, v144, v151
    v_dot2_f32_bf16 v152, v120, v120, v152
    v_dot2_f32_bf16 v153, v121, v121, v153
    v_dot2_f32_bf16 v154, v122, v122, v154
    v_dot2_f32_bf16 v155, v123, v123, v155
    s_waitcnt lgkmcnt(0)
    v_dot2_f32_bf16 v148, v124, v144, v148
    v_dot2_f32_bf16 v149, v125, v144, v149
    s_nop 0
    v_dot2_f32_bf16 v150, v126, v144, v150
    v_dot2_f32_bf16 v151, v127, v144, v151
    v_dot2_f32_bf16 v152, v124, v124, v152
    v_dot2_f32_bf16 v153, v125, v125, v153
    v_dot2_f32_bf16 v154, v126, v126, v154
    v_dot2_f32_bf16 v155, v127, v127, v155
    v_add_f32 v148, v148, v149
    v_add_f32 v150, v150, v151
    v_add_f32 v152, v152, v153
    v_add_f32 v154, v154, v155
    v_add_f32 v148, v148, v150
    v_add_f32 v152, v152, v154
    v_mov_b32 v149, v148
    v_mov_b32 v153, v152
    s_nop 0
    v_permlane32_swap_b32 v148, v149
    v_permlane32_swap_b32 v152, v153
    v_add_f32 v148, v148, v149
    v_add_f32 v152, v152, v153
    v_mul_f32 v148, 0x3b000000, v148
    v_mul_f32 v152, 0x3b000000, v152
    v_fma_f32 v152, -v148, v148, v152
    v_max_f32 v152, 0, v152
    v_add_f32 v152, 0x3727c5ac, v152
    v_rsq_f32 v152, v152
    v_mov_b32 v153, 0
    v_cvt_pk_bf16_f32 v154, v152, v153
    v_lshlrev_b32_e64 v155, 16, v154
    v_mul_f32_e64 v149, -v148, v155
    v_dot2_f32_bf16 v160, v0, v154, v149
    v_dot2_f32_bf16 v161, v0, v155, v149
    v_dot2_f32_bf16 v162, v1, v154, v149
    v_dot2_f32_bf16 v163, v1, v155, v149
    v_dot2_f32_bf16 v164, v2, v154, v149
    v_dot2_f32_bf16 v165, v2, v155, v149
    v_cvt_pk_bf16_f32 v168, v160, v161
    s_add_u32 m0, s74, 135168
    s_add_u32 s1, s84, 197632
    buffer_load_dwordx4 v244, s[36:39], s1 offen offset:0 lds
    v_dot2_f32_bf16 v166, v3, v154, v149
    v_dot2_f32_bf16 v167, v3, v155, v149
    v_cvt_pk_bf16_f32 v169, v162, v163
    v_accvgpr_write_b32 a0, v168
    v_dot2_f32_bf16 v160, v4, v154, v149
    v_dot2_f32_bf16 v161, v4, v155, v149
    v_cvt_pk_bf16_f32 v168, v164, v165
    v_accvgpr_write_b32 a1, v169
    v_dot2_f32_bf16 v162, v5, v154, v149
    v_dot2_f32_bf16 v163, v5, v155, v149
    v_cvt_pk_bf16_f32 v169, v166, v167
    v_accvgpr_write_b32 a2, v168
    v_dot2_f32_bf16 v164, v6, v154, v149
    v_dot2_f32_bf16 v165, v6, v155, v149
    v_cvt_pk_bf16_f32 v168, v160, v161
    v_accvgpr_write_b32 a3, v169
    v_dot2_f32_bf16 v166, v7, v154, v149
    v_dot2_f32_bf16 v167, v7, v155, v149
    v_cvt_pk_bf16_f32 v169, v162, v163
    v_accvgpr_write_b32 a4, v168
    v_dot2_f32_bf16 v160, v8, v154, v149
    v_dot2_f32_bf16 v161, v8, v155, v149
    v_cvt_pk_bf16_f32 v168, v164, v165
    v_accvgpr_write_b32 a5, v169
    v_dot2_f32_bf16 v162, v9, v154, v149
    v_dot2_f32_bf16 v163, v9, v155, v149
    v_cvt_pk_bf16_f32 v169, v166, v167
    v_accvgpr_write_b32 a6, v168
    v_dot2_f32_bf16 v164, v10, v154, v149
    v_dot2_f32_bf16 v165, v10, v155, v149
    v_cvt_pk_bf16_f32 v168, v160, v161
    v_accvgpr_write_b32 a7, v169
    v_dot2_f32_bf16 v166, v11, v154, v149
    v_dot2_f32_bf16 v167, v11, v155, v149
    v_cvt_pk_bf16_f32 v169, v162, v163
    v_accvgpr_write_b32 a8, v168
    v_dot2_f32_bf16 v160, v12, v154, v149
    v_dot2_f32_bf16 v161, v12, v155, v149
    v_cvt_pk_bf16_f32 v168, v164, v165
    v_accvgpr_write_b32 a9, v169
    s_add_u32 s1, s84, 245760
    buffer_load_dwordx4 v244, s[36:39], s1 offen offset:1024 lds
    v_dot2_f32_bf16 v162, v13, v154, v149
    v_dot2_f32_bf16 v163, v13, v155, v149
    v_cvt_pk_bf16_f32 v169, v166, v167
    v_accvgpr_write_b32 a10, v168
    v_dot2_f32_bf16 v164, v14, v154, v149
    v_dot2_f32_bf16 v165, v14, v155, v149
    v_cvt_pk_bf16_f32 v168, v160, v161
    v_accvgpr_write_b32 a11, v169
    v_dot2_f32_bf16 v166, v15, v154, v149
    v_dot2_f32_bf16 v167, v15, v155, v149
    v_cvt_pk_bf16_f32 v169, v162, v163
    v_accvgpr_write_b32 a12, v168
    v_dot2_f32_bf16 v160, v16, v154, v149
    v_dot2_f32_bf16 v161, v16, v155, v149
    v_cvt_pk_bf16_f32 v168, v164, v165
    v_accvgpr_write_b32 a13, v169
    v_dot2_f32_bf16 v162, v17, v154, v149
    v_dot2_f32_bf16 v163, v17, v155, v149
    v_cvt_pk_bf16_f32 v169, v166, v167
    v_accvgpr_write_b32 a14, v168
    v_dot2_f32_bf16 v164, v18, v154, v149
    v_dot2_f32_bf16 v165, v18, v155, v149
    v_cvt_pk_bf16_f32 v168, v160, v161
    v_accvgpr_write_b32 a15, v169
    v_dot2_f32_bf16 v166, v19, v154, v149
    v_dot2_f32_bf16 v167, v19, v155, v149
    v_cvt_pk_bf16_f32 v169, v162, v163
    v_accvgpr_write_b32 a16, v168
    v_dot2_f32_bf16 v160, v20, v154, v149
    v_dot2_f32_bf16 v161, v20, v155, v149
    v_cvt_pk_bf16_f32 v168, v164, v165
    v_accvgpr_write_b32 a17, v169
    v_dot2_f32_bf16 v162, v21, v154, v149
    v_dot2_f32_bf16 v163, v21, v155, v149
    v_cvt_pk_bf16_f32 v169, v166, v167
    v_accvgpr_write_b32 a18, v168
    v_dot2_f32_bf16 v164, v22, v154, v149
    v_dot2_f32_bf16 v165, v22, v155, v149
    v_cvt_pk_bf16_f32 v168, v160, v161
    v_accvgpr_write_b32 a19, v169
    s_add_u32 s1, s84, 293888
    buffer_load_dwordx4 v244, s[36:39], s1 offen offset:2048 lds
    v_dot2_f32_bf16 v166, v23, v154, v149
    v_dot2_f32_bf16 v167, v23, v155, v149
    v_cvt_pk_bf16_f32 v169, v162, v163
    v_accvgpr_write_b32 a20, v168
    v_dot2_f32_bf16 v160, v24, v154, v149
    v_dot2_f32_bf16 v161, v24, v155, v149
    v_cvt_pk_bf16_f32 v168, v164, v165
    v_accvgpr_write_b32 a21, v169
    v_dot2_f32_bf16 v162, v25, v154, v149
    v_dot2_f32_bf16 v163, v25, v155, v149
    v_cvt_pk_bf16_f32 v169, v166, v167
    v_accvgpr_write_b32 a22, v168
    v_dot2_f32_bf16 v164, v26, v154, v149
    v_dot2_f32_bf16 v165, v26, v155, v149
    v_cvt_pk_bf16_f32 v168, v160, v161
    v_accvgpr_write_b32 a23, v169
    v_dot2_f32_bf16 v166, v27, v154, v149
    v_dot2_f32_bf16 v167, v27, v155, v149
    v_cvt_pk_bf16_f32 v169, v162, v163
    v_accvgpr_write_b32 a24, v168
    v_dot2_f32_bf16 v160, v28, v154, v149
    v_dot2_f32_bf16 v161, v28, v155, v149
    v_cvt_pk_bf16_f32 v168, v164, v165
    v_accvgpr_write_b32 a25, v169
    v_dot2_f32_bf16 v162, v29, v154, v149
    v_dot2_f32_bf16 v163, v29, v155, v149
    v_cvt_pk_bf16_f32 v169, v166, v167
    v_accvgpr_write_b32 a26, v168
    v_dot2_f32_bf16 v164, v30, v154, v149
    v_dot2_f32_bf16 v165, v30, v155, v149
    v_cvt_pk_bf16_f32 v168, v160, v161
    v_accvgpr_write_b32 a27, v169
    v_dot2_f32_bf16 v166, v31, v154, v149
    v_dot2_f32_bf16 v167, v31, v155, v149
    v_cvt_pk_bf16_f32 v169, v162, v163
    v_accvgpr_write_b32 a28, v168
    v_dot2_f32_bf16 v160, v32, v154, v149
    v_dot2_f32_bf16 v161, v32, v155, v149
    v_cvt_pk_bf16_f32 v168, v164, v165
    v_accvgpr_write_b32 a29, v169
    s_add_u32 s1, s84, 342016
    buffer_load_dwordx4 v244, s[36:39], s1 offen offset:3072 lds
    v_dot2_f32_bf16 v162, v33, v154, v149
    v_dot2_f32_bf16 v163, v33, v155, v149
    v_cvt_pk_bf16_f32 v169, v166, v167
    v_accvgpr_write_b32 a30, v168
    v_dot2_f32_bf16 v164, v34, v154, v149
    v_dot2_f32_bf16 v165, v34, v155, v149
    v_cvt_pk_bf16_f32 v168, v160, v161
    v_accvgpr_write_b32 a31, v169
    v_dot2_f32_bf16 v166, v35, v154, v149
    v_dot2_f32_bf16 v167, v35, v155, v149
    v_cvt_pk_bf16_f32 v169, v162, v163
    v_accvgpr_write_b32 a32, v168
    v_dot2_f32_bf16 v160, v36, v154, v149
    v_dot2_f32_bf16 v161, v36, v155, v149
    v_cvt_pk_bf16_f32 v168, v164, v165
    v_accvgpr_write_b32 a33, v169
    v_dot2_f32_bf16 v162, v37, v154, v149
    v_dot2_f32_bf16 v163, v37, v155, v149
    v_cvt_pk_bf16_f32 v169, v166, v167
    v_accvgpr_write_b32 a34, v168
    v_dot2_f32_bf16 v164, v38, v154, v149
    v_dot2_f32_bf16 v165, v38, v155, v149
    v_cvt_pk_bf16_f32 v168, v160, v161
    v_accvgpr_write_b32 a35, v169
    v_dot2_f32_bf16 v166, v39, v154, v149
    v_dot2_f32_bf16 v167, v39, v155, v149
    v_cvt_pk_bf16_f32 v169, v162, v163
    v_accvgpr_write_b32 a36, v168
    v_dot2_f32_bf16 v160, v40, v154, v149
    v_dot2_f32_bf16 v161, v40, v155, v149
    v_cvt_pk_bf16_f32 v168, v164, v165
    v_accvgpr_write_b32 a37, v169
    v_dot2_f32_bf16 v162, v41, v154, v149
    v_dot2_f32_bf16 v163, v41, v155, v149
    v_cvt_pk_bf16_f32 v169, v166, v167
    v_accvgpr_write_b32 a38, v168
    v_dot2_f32_bf16 v164, v42, v154, v149
    v_dot2_f32_bf16 v165, v42, v155, v149
    v_cvt_pk_bf16_f32 v168, v160, v161
    v_accvgpr_write_b32 a39, v169
    s_add_u32 m0, s74, 0
    s_add_u32 s1, s84, 2048
    buffer_load_dwordx4 v244, s[36:39], s1 offen offset:0 lds
    s_nop 0
    v_dot2_f32_bf16 v166, v43, v154, v149
    v_dot2_f32_bf16 v167, v43, v155, v149
    v_cvt_pk_bf16_f32 v169, v162, v163
    v_accvgpr_write_b32 a40, v168
    v_dot2_f32_bf16 v160, v44, v154, v149
    v_dot2_f32_bf16 v161, v44, v155, v149
    v_cvt_pk_bf16_f32 v168, v164, v165
    v_accvgpr_write_b32 a41, v169
    v_dot2_f32_bf16 v162, v45, v154, v149
    v_dot2_f32_bf16 v163, v45, v155, v149
    v_cvt_pk_bf16_f32 v169, v166, v167
    v_accvgpr_write_b32 a42, v168
    v_dot2_f32_bf16 v164, v46, v154, v149
    v_dot2_f32_bf16 v165, v46, v155, v149
    v_cvt_pk_bf16_f32 v168, v160, v161
    v_accvgpr_write_b32 a43, v169
    v_dot2_f32_bf16 v166, v47, v154, v149
    v_dot2_f32_bf16 v167, v47, v155, v149
    v_cvt_pk_bf16_f32 v169, v162, v163
    v_accvgpr_write_b32 a44, v168
    v_dot2_f32_bf16 v160, v48, v154, v149
    v_dot2_f32_bf16 v161, v48, v155, v149
    v_cvt_pk_bf16_f32 v168, v164, v165
    v_accvgpr_write_b32 a45, v169
    v_dot2_f32_bf16 v162, v49, v154, v149
    v_dot2_f32_bf16 v163, v49, v155, v149
    v_cvt_pk_bf16_f32 v169, v166, v167
    v_accvgpr_write_b32 a46, v168
    v_dot2_f32_bf16 v164, v50, v154, v149
    v_dot2_f32_bf16 v165, v50, v155, v149
    v_cvt_pk_bf16_f32 v168, v160, v161
    v_accvgpr_write_b32 a47, v169
    v_dot2_f32_bf16 v166, v51, v154, v149
    v_dot2_f32_bf16 v167, v51, v155, v149
    v_cvt_pk_bf16_f32 v169, v162, v163
    v_accvgpr_write_b32 a48, v168
    v_dot2_f32_bf16 v160, v52, v154, v149
    v_dot2_f32_bf16 v161, v52, v155, v149
    v_cvt_pk_bf16_f32 v168, v164, v165
    v_accvgpr_write_b32 a49, v169
    s_add_u32 s1, s84, 50176
    buffer_load_dwordx4 v244, s[36:39], s1 offen offset:1024 lds
    v_dot2_f32_bf16 v162, v53, v154, v149
    v_dot2_f32_bf16 v163, v53, v155, v149
    v_cvt_pk_bf16_f32 v169, v166, v167
    v_accvgpr_write_b32 a50, v168
    v_dot2_f32_bf16 v164, v54, v154, v149
    v_dot2_f32_bf16 v165, v54, v155, v149
    v_cvt_pk_bf16_f32 v168, v160, v161
    v_accvgpr_write_b32 a51, v169
    v_dot2_f32_bf16 v166, v55, v154, v149
    v_dot2_f32_bf16 v167, v55, v155, v149
    v_cvt_pk_bf16_f32 v169, v162, v163
    v_accvgpr_write_b32 a52, v168
    v_dot2_f32_bf16 v160, v56, v154, v149
    v_dot2_f32_bf16 v161, v56, v155, v149
    v_cvt_pk_bf16_f32 v168, v164, v165
    v_accvgpr_write_b32 a53, v169
    v_dot2_f32_bf16 v162, v57, v154, v149
    v_dot2_f32_bf16 v163, v57, v155, v149
    v_cvt_pk_bf16_f32 v169, v166, v167
    v_accvgpr_write_b32 a54, v168
    v_dot2_f32_bf16 v164, v58, v154, v149
    v_dot2_f32_bf16 v165, v58, v155, v149
    v_cvt_pk_bf16_f32 v168, v160, v161
    v_accvgpr_write_b32 a55, v169
    v_dot2_f32_bf16 v166, v59, v154, v149
    v_dot2_f32_bf16 v167, v59, v155, v149
    v_cvt_pk_bf16_f32 v169, v162, v163
    v_accvgpr_write_b32 a56, v168
    v_dot2_f32_bf16 v160, v60, v154, v149
    v_dot2_f32_bf16 v161, v60, v155, v149
    v_cvt_pk_bf16_f32 v168, v164, v165
    v_accvgpr_write_b32 a57, v169
    v_dot2_f32_bf16 v162, v61, v154, v149
    v_dot2_f32_bf16 v163, v61, v155, v149
    v_cvt_pk_bf16_f32 v169, v166, v167
    v_accvgpr_write_b32 a58, v168
    v_dot2_f32_bf16 v164, v62, v154, v149
    v_dot2_f32_bf16 v165, v62, v155, v149
    v_cvt_pk_bf16_f32 v168, v160, v161
    v_accvgpr_write_b32 a59, v169
    s_add_u32 s1, s84, 98304
    buffer_load_dwordx4 v244, s[36:39], s1 offen offset:2048 lds
    v_dot2_f32_bf16 v166, v63, v154, v149
    v_dot2_f32_bf16 v167, v63, v155, v149
    v_cvt_pk_bf16_f32 v169, v162, v163
    v_accvgpr_write_b32 a60, v168
    v_dot2_f32_bf16 v160, v64, v154, v149
    v_dot2_f32_bf16 v161, v64, v155, v149
    v_cvt_pk_bf16_f32 v168, v164, v165
    v_accvgpr_write_b32 a61, v169
    v_dot2_f32_bf16 v162, v65, v154, v149
    v_dot2_f32_bf16 v163, v65, v155, v149
    v_cvt_pk_bf16_f32 v169, v166, v167
    v_accvgpr_write_b32 a62, v168
    v_dot2_f32_bf16 v164, v66, v154, v149
    v_dot2_f32_bf16 v165, v66, v155, v149
    v_cvt_pk_bf16_f32 v168, v160, v161
    v_accvgpr_write_b32 a63, v169
    v_dot2_f32_bf16 v166, v67, v154, v149
    v_dot2_f32_bf16 v167, v67, v155, v149
    v_cvt_pk_bf16_f32 v169, v162, v163
    v_accvgpr_write_b32 a64, v168
    v_dot2_f32_bf16 v160, v68, v154, v149
    v_dot2_f32_bf16 v161, v68, v155, v149
    v_cvt_pk_bf16_f32 v168, v164, v165
    v_accvgpr_write_b32 a65, v169
    v_dot2_f32_bf16 v162, v69, v154, v149
    v_dot2_f32_bf16 v163, v69, v155, v149
    v_cvt_pk_bf16_f32 v169, v166, v167
    v_accvgpr_write_b32 a66, v168
    v_dot2_f32_bf16 v164, v70, v154, v149
    v_dot2_f32_bf16 v165, v70, v155, v149
    v_cvt_pk_bf16_f32 v168, v160, v161
    v_accvgpr_write_b32 a67, v169
    v_dot2_f32_bf16 v166, v71, v154, v149
    v_dot2_f32_bf16 v167, v71, v155, v149
    v_cvt_pk_bf16_f32 v169, v162, v163
    v_accvgpr_write_b32 a68, v168
    v_dot2_f32_bf16 v160, v72, v154, v149
    v_dot2_f32_bf16 v161, v72, v155, v149
    v_cvt_pk_bf16_f32 v168, v164, v165
    v_accvgpr_write_b32 a69, v169
    s_add_u32 s1, s84, 146432
    buffer_load_dwordx4 v244, s[36:39], s1 offen offset:3072 lds
    v_dot2_f32_bf16 v162, v73, v154, v149
    v_dot2_f32_bf16 v163, v73, v155, v149
    v_cvt_pk_bf16_f32 v169, v166, v167
    v_accvgpr_write_b32 a70, v168
    v_dot2_f32_bf16 v164, v74, v154, v149
    v_dot2_f32_bf16 v165, v74, v155, v149
    v_cvt_pk_bf16_f32 v168, v160, v161
    v_accvgpr_write_b32 a71, v169
    v_dot2_f32_bf16 v166, v75, v154, v149
    v_dot2_f32_bf16 v167, v75, v155, v149
    v_cvt_pk_bf16_f32 v169, v162, v163
    v_accvgpr_write_b32 a72, v168
    v_dot2_f32_bf16 v160, v76, v154, v149
    v_dot2_f32_bf16 v161, v76, v155, v149
    v_cvt_pk_bf16_f32 v168, v164, v165
    v_accvgpr_write_b32 a73, v169
    v_dot2_f32_bf16 v162, v77, v154, v149
    v_dot2_f32_bf16 v163, v77, v155, v149
    v_cvt_pk_bf16_f32 v169, v166, v167
    v_accvgpr_write_b32 a74, v168
    v_dot2_f32_bf16 v164, v78, v154, v149
    v_dot2_f32_bf16 v165, v78, v155, v149
    v_cvt_pk_bf16_f32 v168, v160, v161
    v_accvgpr_write_b32 a75, v169
    v_dot2_f32_bf16 v166, v79, v154, v149
    v_dot2_f32_bf16 v167, v79, v155, v149
    v_cvt_pk_bf16_f32 v169, v162, v163
    v_accvgpr_write_b32 a76, v168
    v_dot2_f32_bf16 v160, v80, v154, v149
    v_dot2_f32_bf16 v161, v80, v155, v149
    v_cvt_pk_bf16_f32 v168, v164, v165
    v_accvgpr_write_b32 a77, v169
    v_dot2_f32_bf16 v162, v81, v154, v149
    v_dot2_f32_bf16 v163, v81, v155, v149
    v_cvt_pk_bf16_f32 v169, v166, v167
    v_accvgpr_write_b32 a78, v168
    v_dot2_f32_bf16 v164, v82, v154, v149
    v_dot2_f32_bf16 v165, v82, v155, v149
    v_cvt_pk_bf16_f32 v168, v160, v161
    v_accvgpr_write_b32 a79, v169
    s_add_u32 m0, s74, 4096
    s_add_u32 s1, s84, 198656
    buffer_load_dwordx4 v244, s[36:39], s1 offen offset:0 lds
    v_dot2_f32_bf16 v166, v83, v154, v149
    v_dot2_f32_bf16 v167, v83, v155, v149
    v_cvt_pk_bf16_f32 v169, v162, v163
    v_accvgpr_write_b32 a80, v168
    v_dot2_f32_bf16 v160, v84, v154, v149
    v_dot2_f32_bf16 v161, v84, v155, v149
    v_cvt_pk_bf16_f32 v168, v164, v165
    v_accvgpr_write_b32 a81, v169
    v_dot2_f32_bf16 v162, v85, v154, v149
    v_dot2_f32_bf16 v163, v85, v155, v149
    v_cvt_pk_bf16_f32 v169, v166, v167
    v_accvgpr_write_b32 a82, v168
    v_dot2_f32_bf16 v164, v86, v154, v149
    v_dot2_f32_bf16 v165, v86, v155, v149
    v_cvt_pk_bf16_f32 v168, v160, v161
    v_accvgpr_write_b32 a83, v169
    v_dot2_f32_bf16 v166, v87, v154, v149
    v_dot2_f32_bf16 v167, v87, v155, v149
    v_cvt_pk_bf16_f32 v169, v162, v163
    v_accvgpr_write_b32 a84, v168
    v_dot2_f32_bf16 v160, v88, v154, v149
    v_dot2_f32_bf16 v161, v88, v155, v149
    v_cvt_pk_bf16_f32 v168, v164, v165
    v_accvgpr_write_b32 a85, v169
    v_dot2_f32_bf16 v162, v89, v154, v149
    v_dot2_f32_bf16 v163, v89, v155, v149
    v_cvt_pk_bf16_f32 v169, v166, v167
    v_accvgpr_write_b32 a86, v168
    v_dot2_f32_bf16 v164, v90, v154, v149
    v_dot2_f32_bf16 v165, v90, v155, v149
    v_cvt_pk_bf16_f32 v168, v160, v161
    v_accvgpr_write_b32 a87, v169
    v_dot2_f32_bf16 v166, v91, v154, v149
    v_dot2_f32_bf16 v167, v91, v155, v149
    v_cvt_pk_bf16_f32 v169, v162, v163
    v_accvgpr_write_b32 a88, v168
    v_dot2_f32_bf16 v160, v92, v154, v149
    v_dot2_f32_bf16 v161, v92, v155, v149
    v_cvt_pk_bf16_f32 v168, v164, v165
    v_accvgpr_write_b32 a89, v169
    s_add_u32 s1, s84, 246784
    buffer_load_dwordx4 v244, s[36:39], s1 offen offset:1024 lds
    v_dot2_f32_bf16 v162, v93, v154, v149
    v_dot2_f32_bf16 v163, v93, v155, v149
    v_cvt_pk_bf16_f32 v169, v166, v167
    v_accvgpr_write_b32 a90, v168
    v_dot2_f32_bf16 v164, v94, v154, v149
    v_dot2_f32_bf16 v165, v94, v155, v149
    v_cvt_pk_bf16_f32 v168, v160, v161
    v_accvgpr_write_b32 a91, v169
    v_dot2_f32_bf16 v166, v95, v154, v149
    v_dot2_f32_bf16 v167, v95, v155, v149
    v_cvt_pk_bf16_f32 v169, v162, v163
    v_accvgpr_write_b32 a92, v168
    v_dot2_f32_bf16 v160, v96, v154, v149
    v_dot2_f32_bf16 v161, v96, v155, v149
    v_cvt_pk_bf16_f32 v168, v164, v165
    v_accvgpr_write_b32 a93, v169
    v_dot2_f32_bf16 v162, v97, v154, v149
    v_dot2_f32_bf16 v163, v97, v155, v149
    v_cvt_pk_bf16_f32 v169, v166, v167
    v_accvgpr_write_b32 a94, v168
    v_dot2_f32_bf16 v164, v98, v154, v149
    v_dot2_f32_bf16 v165, v98, v155, v149
    v_cvt_pk_bf16_f32 v168, v160, v161
    v_accvgpr_write_b32 a95, v169
    v_dot2_f32_bf16 v166, v99, v154, v149
    v_dot2_f32_bf16 v167, v99, v155, v149
    v_cvt_pk_bf16_f32 v169, v162, v163
    v_accvgpr_write_b32 a96, v168
    v_dot2_f32_bf16 v160, v100, v154, v149
    v_dot2_f32_bf16 v161, v100, v155, v149
    v_cvt_pk_bf16_f32 v168, v164, v165
    v_accvgpr_write_b32 a97, v169
    v_dot2_f32_bf16 v162, v101, v154, v149
    v_dot2_f32_bf16 v163, v101, v155, v149
    v_cvt_pk_bf16_f32 v169, v166, v167
    v_accvgpr_write_b32 a98, v168
    v_dot2_f32_bf16 v164, v102, v154, v149
    v_dot2_f32_bf16 v165, v102, v155, v149
    v_cvt_pk_bf16_f32 v168, v160, v161
    v_accvgpr_write_b32 a99, v169
    s_add_u32 s1, s84, 294912
    buffer_load_dwordx4 v244, s[36:39], s1 offen offset:2048 lds
    v_dot2_f32_bf16 v166, v103, v154, v149
    v_dot2_f32_bf16 v167, v103, v155, v149
    v_cvt_pk_bf16_f32 v169, v162, v163
    v_accvgpr_write_b32 a100, v168
    v_dot2_f32_bf16 v160, v104, v154, v149
    v_dot2_f32_bf16 v161, v104, v155, v149
    v_cvt_pk_bf16_f32 v168, v164, v165
    v_accvgpr_write_b32 a101, v169
    v_dot2_f32_bf16 v162, v105, v154, v149
    v_dot2_f32_bf16 v163, v105, v155, v149
    v_cvt_pk_bf16_f32 v169, v166, v167
    v_accvgpr_write_b32 a102, v168
    v_dot2_f32_bf16 v164, v106, v154, v149
    v_dot2_f32_bf16 v165, v106, v155, v149
    v_cvt_pk_bf16_f32 v168, v160, v161
    v_accvgpr_write_b32 a103, v169
    v_dot2_f32_bf16 v166, v107, v154, v149
    v_dot2_f32_bf16 v167, v107, v155, v149
    v_cvt_pk_bf16_f32 v169, v162, v163
    v_accvgpr_write_b32 a104, v168
    v_dot2_f32_bf16 v160, v108, v154, v149
    v_dot2_f32_bf16 v161, v108, v155, v149
    v_cvt_pk_bf16_f32 v168, v164, v165
    v_accvgpr_write_b32 a105, v169
    v_dot2_f32_bf16 v162, v109, v154, v149
    v_dot2_f32_bf16 v163, v109, v155, v149
    v_cvt_pk_bf16_f32 v169, v166, v167
    v_accvgpr_write_b32 a106, v168
    v_dot2_f32_bf16 v164, v110, v154, v149
    v_dot2_f32_bf16 v165, v110, v155, v149
    v_cvt_pk_bf16_f32 v168, v160, v161
    v_accvgpr_write_b32 a107, v169
    v_dot2_f32_bf16 v166, v111, v154, v149
    v_dot2_f32_bf16 v167, v111, v155, v149
    v_cvt_pk_bf16_f32 v169, v162, v163
    v_accvgpr_write_b32 a108, v168
    v_dot2_f32_bf16 v160, v112, v154, v149
    v_dot2_f32_bf16 v161, v112, v155, v149
    v_cvt_pk_bf16_f32 v168, v164, v165
    v_accvgpr_write_b32 a109, v169
    s_add_u32 s1, s84, 343040
    buffer_load_dwordx4 v244, s[36:39], s1 offen offset:3072 lds
    v_dot2_f32_bf16 v162, v113, v154, v149
    v_dot2_f32_bf16 v163, v113, v155, v149
    v_cvt_pk_bf16_f32 v169, v166, v167
    v_accvgpr_write_b32 a110, v168
    v_dot2_f32_bf16 v164, v114, v154, v149
    v_dot2_f32_bf16 v165, v114, v155, v149
    v_cvt_pk_bf16_f32 v168, v160, v161
    v_accvgpr_write_b32 a111, v169
    v_dot2_f32_bf16 v166, v115, v154, v149
    v_dot2_f32_bf16 v167, v115, v155, v149
    v_cvt_pk_bf16_f32 v169, v162, v163
    v_accvgpr_write_b32 a112, v168
    v_dot2_f32_bf16 v160, v116, v154, v149
    v_dot2_f32_bf16 v161, v116, v155, v149
    v_cvt_pk_bf16_f32 v168, v164, v165
    v_accvgpr_write_b32 a113, v169
    v_dot2_f32_bf16 v162, v117, v154, v149
    v_dot2_f32_bf16 v163, v117, v155, v149
    v_cvt_pk_bf16_f32 v169, v166, v167
    v_accvgpr_write_b32 a114, v168
    v_dot2_f32_bf16 v164, v118, v154, v149
    v_dot2_f32_bf16 v165, v118, v155, v149
    v_cvt_pk_bf16_f32 v168, v160, v161
    v_accvgpr_write_b32 a115, v169
    v_dot2_f32_bf16 v166, v119, v154, v149
    v_dot2_f32_bf16 v167, v119, v155, v149
    v_cvt_pk_bf16_f32 v169, v162, v163
    v_accvgpr_write_b32 a116, v168
    v_dot2_f32_bf16 v160, v120, v154, v149
    v_dot2_f32_bf16 v161, v120, v155, v149
    v_cvt_pk_bf16_f32 v168, v164, v165
    v_accvgpr_write_b32 a117, v169
    v_dot2_f32_bf16 v162, v121, v154, v149
    v_dot2_f32_bf16 v163, v121, v155, v149
    v_cvt_pk_bf16_f32 v169, v166, v167
    v_accvgpr_write_b32 a118, v168
    v_dot2_f32_bf16 v164, v122, v154, v149
    v_dot2_f32_bf16 v165, v122, v155, v149
    v_cvt_pk_bf16_f32 v168, v160, v161
    v_accvgpr_write_b32 a119, v169
    v_dot2_f32_bf16 v166, v123, v154, v149
    v_dot2_f32_bf16 v167, v123, v155, v149
    v_cvt_pk_bf16_f32 v169, v162, v163
    v_accvgpr_write_b32 a120, v168
    v_dot2_f32_bf16 v160, v124, v154, v149
    v_dot2_f32_bf16 v161, v124, v155, v149
    v_cvt_pk_bf16_f32 v168, v164, v165
    v_accvgpr_write_b32 a121, v169
    v_dot2_f32_bf16 v162, v125, v154, v149
    v_dot2_f32_bf16 v163, v125, v155, v149
    v_cvt_pk_bf16_f32 v169, v166, v167
    v_accvgpr_write_b32 a122, v168
    v_dot2_f32_bf16 v164, v126, v154, v149
    v_dot2_f32_bf16 v165, v126, v155, v149
    v_cvt_pk_bf16_f32 v168, v160, v161
    v_accvgpr_write_b32 a123, v169
    v_dot2_f32_bf16 v166, v127, v154, v149
    v_dot2_f32_bf16 v167, v127, v155, v149
    v_cvt_pk_bf16_f32 v169, v162, v163
    v_accvgpr_write_b32 a124, v168
    v_cvt_pk_bf16_f32 v168, v164, v165
    v_accvgpr_write_b32 a125, v169
    v_cvt_pk_bf16_f32 v169, v166, v167
    v_accvgpr_write_b32 a126, v168
    v_accvgpr_write_b32 a127, v169
    buffer_load_dwordx2 v[228:229], off, s[60:63], 0 sc1
    s_cmp_lg_u32 s6, 0
    s_cbranch_scc1 L_var6
    s_waitcnt vmcnt(9)
    s_barrier
    ds_read_b64_tr_b16 a[208:209], v234 offset:0
    ds_read_b64_tr_b16 a[210:211], v234 offset:256
    ds_read_b64_tr_b16 a[212:213], v234 offset:1024
    ds_read_b64_tr_b16 a[214:215], v234 offset:1280
    ds_read_b64_tr_b16 a[216:217], v234 offset:2048
    ds_read_b64_tr_b16 a[218:219], v234 offset:2304
    ds_read_b64_tr_b16 a[220:221], v234 offset:3072
    ds_read_b64_tr_b16 a[222:223], v234 offset:3328
    ds_read_b64_tr_b16 a[224:225], v234 offset:4096
    ds_read_b64_tr_b16 a[226:227], v234 offset:4352
    ds_read_b64_tr_b16 a[228:229], v234 offset:5120
    ds_read_b64_tr_b16 a[230:231], v234 offset:5376
    ds_read_b64_tr_b16 a[232:233], v234 offset:6144
    ds_read_b64_tr_b16 a[234:235], v234 offset:6400
    s_waitcnt lgkmcnt(6)
    v_mfma_f32_32x32x16_bf16 v[128:143], a[208:211], a[0:3], 0
    ds_read_b64_tr_b16 a[236:237], v234 offset:7168
    ds_read_b64_tr_b16 a[238:239], v234 offset:7424
    s_add_u32 m0, s74, 32768
    s_add_u32 s1, s84, 0
    buffer_load_dwordx4 v244, s[36:39], s1 offen offset:0 lds
    v_lshl_add_u32 v200, v195, 2, v197
    v_lshlrev_b32_e64 v200, 5, v200
    v_mfma_f32_32x32x16_bf16 v[128:143], a[212:215], a[4:7], v[128:143]
    ds_read_b64_tr_b16 a[240:241], v234 offset:8192
    ds_read_b64_tr_b16 a[242:243], v234 offset:8448
    v_lshrrev_b32 v201, 1, v198
    v_lshl_add_u32 v201, v196, 1, v201
    v_lshl_add_u32 v200, v201, 3, v200
    s_lshl_b32 s19, s3, 10
    s_add_u32 s19, s19, 131072
    v_mfma_f32_32x32x16_bf16 v[128:143], a[216:219], a[8:11], v[128:143]
    ds_read_b64_tr_b16 a[244:245], v234 offset:9216
    ds_read_b64_tr_b16 a[246:247], v234 offset:9472
    v_add_u32 v254, s19, v200
    v_and_b32_e64 v200, 1, v197
    v_mov_b32 v201, 0x80008000
    v_mul_lo_u32 v255, v200, v201
    s_lshl_b32 s19, s4, 2
    v_mfma_f32_32x32x16_bf16 v[128:143], a[220:223], a[12:15], v[128:143]
    ds_read_b64_tr_b16 a[248:249], v234 offset:10240
    ds_read_b64_tr_b16 a[250:251], v234 offset:10496
    s_add_u32 s19, s19, s3
    s_lshl4_add_u32 s23, s4, s3
    s_lshl_b32 s13, s5, 11
    s_add_u32 s13, s13, 10878976
    s_lshl3_add_u32 s12, s23, s13
    s_lshr_b32 s19, s19, 1
    s_waitcnt lgkmcnt(6)
    v_mfma_f32_32x32x16_bf16 v[128:143], a[224:227], a[16:19], v[128:143]
    ds_read_b64_tr_b16 a[252:253], v234 offset:11264
    ds_read_b64_tr_b16 a[254:255], v234 offset:11520
    s_add_u32 s1, s84, 48128
    buffer_load_dwordx4 v244, s[36:39], s1 offen offset:1024 lds
    s_lshr_b32 s23, s5, 2
    s_lshl2_add_u32 s19, s19, s23
    s_lshl_b32 s19, s19, 5
    v_mfma_f32_32x32x16_bf16 v[128:143], a[228:231], a[20:23], v[128:143]
    ds_read_b64_tr_b16 a[208:209], v234 offset:12288
    ds_read_b64_tr_b16 a[210:211], v234 offset:12544
    s_and_b32 s23, s3, 1
    s_lshl2_add_u32 s19, s23, s19
    s_and_b32 s23, s5, 3
    s_add_u32 s19, s19, s23
    s_lshl_b32 s19, s19, 2
    v_mfma_f32_32x32x16_bf16 v[128:143], a[232:235], a[24:27], v[128:143]
    ds_read_b64_tr_b16 a[212:213], v234 offset:13312
    ds_read_b64_tr_b16 a[214:215], v234 offset:13568
    s_add_u32 s14, s19, 10813440
    s_add_u32 s15, s19, 10829824
    s_nop 0
    s_mov_b32 s73, 1069066811
    s_and_b32 s19, s3, 1
    s_mul_i32 s23, s19, 229376
    v_mfma_f32_32x32x16_bf16 v[128:143], a[236:239], a[28:31], v[128:143]
    ds_read_b64_tr_b16 a[216:217], v234 offset:14336
    ds_read_b64_tr_b16 a[218:219], v234 offset:14592
    s_xor_b32 vcc_lo, s87, 0
    s_mul_i32 vcc_lo, vcc_lo, 458752
    s_add_u32 s26, vcc_lo, s23
    s_xor_b32 vcc_lo, s87, 1
    s_mul_i32 vcc_lo, vcc_lo, 458752
    s_waitcnt lgkmcnt(6)
    v_mfma_f32_32x32x16_bf16 v[128:143], a[240:243], a[32:35], v[128:143]
    ds_read_b64_tr_b16 a[220:221], v234 offset:15360
    ds_read_b64_tr_b16 a[222:223], v234 offset:15616
    s_add_u32 s1, s84, 96256
    buffer_load_dwordx4 v244, s[36:39], s1 offen offset:2048 lds
    s_add_u32 s27, vcc_lo, s23
    s_xor_b32 vcc_lo, s87, 2
    s_mul_i32 vcc_lo, vcc_lo, 458752
    v_mfma_f32_32x32x16_bf16 v[128:143], a[244:247], a[36:39], v[128:143]
    ds_read_b64_tr_b16 a[224:225], v234 offset:16384
    ds_read_b64_tr_b16 a[226:227], v234 offset:16640
    s_add_u32 s28, vcc_lo, s23
    s_xor_b32 vcc_lo, s87, 3
    s_mul_i32 vcc_lo, vcc_lo, 458752
    s_add_u32 s29, vcc_lo, s23
    s_xor_b32 vcc_lo, s87, s19
    v_mfma_f32_32x32x16_bf16 v[128:143], a[248:251], a[40:43], v[128:143]
    ds_read_b64_tr_b16 a[228:229], v234 offset:17408
    ds_read_b64_tr_b16 a[230:231], v234 offset:17664
    s_mul_i32 s75, vcc_lo, 458752
    s_xor_b32 vcc_lo, vcc_lo, 2
    s_mul_i32 s76, vcc_lo, 458752
    s_and_b32 s19, s5, 3
    s_lshl_b32 s19, s19, 2
    v_mfma_f32_32x32x16_bf16 v[128:143], a[252:255], a[44:47], v[128:143]
    ds_read_b64_tr_b16 a[232:233], v234 offset:18432
    ds_read_b64_tr_b16 a[234:235], v234 offset:18688
    s_lshr_b32 s80, 0x6280, s19
    s_and_b32 s80, s80, 15
    s_lshr_b32 s81, 0xa0c4, s19
    s_and_b32 s81, s81, 15
    s_lshr_b32 s19, s5, 1
    s_waitcnt lgkmcnt(6)
    v_mfma_f32_32x32x16_bf16 v[128:143], a[208:211], a[48:51], v[128:143]
    ds_read_b64_tr_b16 a[236:237], v234 offset:19456
    ds_read_b64_tr_b16 a[238:239], v234 offset:19712
    s_add_u32 s1, s84, 144384
    buffer_load_dwordx4 v244, s[36:39], s1 offen offset:3072 lds
    s_mul_i32 s19, s19, 14
    s_add_u32 s80, s80, s19
    s_add_u32 s81, s81, s19
    v_mfma_f32_32x32x16_bf16 v[128:143], a[212:215], a[52:55], v[128:143]
    ds_read_b64_tr_b16 a[240:241], v234 offset:20480
    ds_read_b64_tr_b16 a[242:243], v234 offset:20736
    v_lshrrev_b32 v200, 3, v206
    v_mul_u32_u24 v200, 3584, v200
    v_lshlrev_b32 v201, 1, v196
    v_add_u32 v201, s86, v201
    v_lshlrev_b32 v201, 1, v201
    v_mfma_f32_32x32x16_bf16 v[128:143], a[216:219], a[56:59], v[128:143]
    ds_read_b64_tr_b16 a[244:245], v234 offset:21504
    ds_read_b64_tr_b16 a[246:247], v234 offset:21760
    v_and_b32 v202, 7, v206
    v_xor_b32 v201, v201, v202
    v_lshl_add_u32 v200, v201, 4, v200
    s_lshl_b32 s19, s80, 5
    v_add_u32 v231, s19, v200
    v_mfma_f32_32x32x16_bf16 v[128:143], a[220:223], a[60:63], v[128:143]
    ds_read_b64_tr_b16 a[248:249], v234 offset:22528
    ds_read_b64_tr_b16 a[250:251], v234 offset:22784
    v_add_u32 v120, 27648, v231
    v_add_u32 v121, 55296, v231
    v_add_u32 v122, 82944, v231
    v_lshrrev_b32 v201, 2, v206
    v_mul_u32_u24 v201, 3584, v201
    s_waitcnt vmcnt(5)
    s_barrier
    s_lshl_b32 s70, s3, 10
    s_add_u32 s70, s70, 131072
    v_add_u32_e64 v224, s70, v230
    ds_write_b128 v224, v[216:219]
    s_waitcnt lgkmcnt(7)
    v_mfma_f32_32x32x16_bf16 v[128:143], a[224:227], a[64:67], v[128:143]
    ds_read_b64_tr_b16 a[252:253], v234 offset:23552
    ds_read_b64_tr_b16 a[254:255], v234 offset:23808
    s_add_u32 m0, s74, 36864
    s_add_u32 s1, s84, 196608
    buffer_load_dwordx4 v244, s[36:39], s1 offen offset:0 lds
    s_lshl_b32 s19, s86, 1
    v_xor_b32 v203, s19, v198
    v_mfma_f32_32x32x16_bf16 v[128:143], a[228:231], a[68:71], v[128:143]
    ds_read_b64_tr_b16 a[208:209], v234 offset:24576
    ds_read_b64_tr_b16 a[210:211], v234 offset:24832
    v_lshl_add_u32 v201, v203, 4, v201
    s_lshl_b32 s19, s81, 5
    v_add_u32_e64 v232, s19, v201
    s_cmp_lg_u32 s6, 0
    s_cselect_b32 s75, s75, 128
    s_lshl_b32 s19, s3, 8
    v_mfma_f32_32x32x16_bf16 v[128:143], a[232:235], a[72:75], v[128:143]
    ds_read_b64_tr_b16 a[212:213], v234 offset:25600
    ds_read_b64_tr_b16 a[214:215], v234 offset:25856
    ds_read_b64_tr_b16 v[216:217], v254 offset:0
    ds_read_b64_tr_b16 v[218:219], v254 offset:256
    ds_read_b64_tr_b16 v[220:221], v254 offset:512
    ds_read_b64_tr_b16 v[222:223], v254 offset:768
    v_lshl_add_u32 v200, v194, 3, s19
    v_mfma_f32_32x32x16_bf16 v[128:143], a[236:239], a[76:79], v[128:143]
    ds_read_b64_tr_b16 a[216:217], v234 offset:26624
    ds_read_b64_tr_b16 a[218:219], v234 offset:26880
    v_mul_u32_u24 v201, 4352, v195
    v_add3_u32 v246, v200, v201, 0
    v_add_u32 v246, 135168, v246
    v_mul_u32_u24 v201, 1088, v195
    v_add_u32 v201, 152576, v201
    s_waitcnt lgkmcnt(10)
    v_mfma_f32_32x32x16_bf16 v[128:143], a[240:243], a[80:83], v[128:143]
    ds_read_b64_tr_b16 a[220:221], v234 offset:27648
    ds_read_b64_tr_b16 a[222:223], v234 offset:27904
    s_add_u32 s1, s84, 244736
    buffer_load_dwordx4 v244, s[36:39], s1 offen offset:1024 lds
    v_add_u32 v247, v200, v201
    v_mul_u32_u24 v200, 1088, v198
    v_lshrrev_b32_e64 v201, 2, v206
    v_mfma_f32_32x32x16_bf16 v[128:143], a[244:247], a[84:87], v[128:143]
    ds_read_b64_tr_b16 a[224:225], v234 offset:28672
    ds_read_b64_tr_b16 a[226:227], v234 offset:28928
    v_lshl_add_u32 v200, v201, 3, v200
    s_mul_i32 s19, s3, 4352
    s_add_u32 s19, s19, 135168
    v_add_u32_e64 v248, s19, v200
    s_mul_i32 s19, s86, 4352
    v_mfma_f32_32x32x16_bf16 v[128:143], a[248:251], a[88:91], v[128:143]
    ds_read_b64_tr_b16 a[228:229], v234 offset:29696
    ds_read_b64_tr_b16 a[230:231], v234 offset:29952
    s_waitcnt lgkmcnt(8)
    v_xor_b32 v216, v216, v255
    v_xor_b32 v217, v217, v255
    v_xor_b32 v218, v218, v255
    v_xor_b32_e64 v219, v219, v255
    v_mfma_f32_32x32x16_bf16 v[128:143], a[252:255], a[92:95], v[128:143]
    ds_read_b64_tr_b16 a[232:233], v234 offset:30720
    ds_read_b64_tr_b16 a[234:235], v234 offset:30976
    v_xor_b32 v220, v220, v255
    v_xor_b32 v221, v221, v255
    v_xor_b32 v222, v222, v255
    v_xor_b32 v223, v223, v255
    s_waitcnt vmcnt(6)
    v_readfirstlane_b32 s68, v228
    v_readfirstlane_b32 s69, v229
    s_mov_b32 s7, 0
    s_cmp_lg_u32 s68, 0
    s_cbranch_scc1 L_epok_2
L_ep_1:
    buffer_load_dwordx2 v[228:229], off, s[60:63], 0 sc1
    s_waitcnt vmcnt(0)
    v_readfirstlane_b32 s68, v228
    v_readfirstlane_b32 s69, v229
    s_add_u32 s7, s7, 1
    s_cmp_gt_u32 s7, 0x40000
    s_cbranch_scc1 L_epok_2
    s_cmp_eq_u32 s68, 0
    s_cbranch_scc1 L_ep_1
L_epok_2:
    s_waitcnt lgkmcnt(6)
    v_mfma_f32_32x32x16_bf16 v[128:143], a[208:211], a[96:99], v[128:143]
    ds_read_b64_tr_b16 a[236:237], v234 offset:31744
    ds_read_b64_tr_b16 a[238:239], v234 offset:32000
    s_add_u32 s1, s84, 292864
    buffer_load_dwordx4 v244, s[36:39], s1 offen offset:2048 lds
    s_add_u32 s70, s12, 32768
    v_mov_b32 v228, s68
    v_mov_b32 v229, s69
    buffer_store_dwordx2 v[228:229], off, s[52:55], s70 sc1
    v_mfma_f32_32x32x16_bf16 v[128:143], a[212:215], a[100:103], v[128:143]
    ds_read_b64_tr_b16 a[240:241], v235 offset:0
    ds_read_b64_tr_b16 a[242:243], v235 offset:256
    s_add_u32 s19, s19, 152576
    v_add_u32 v249, s19, v200
    v_lshlrev_b32 v200, 8, v192
    v_lshl_add_u32 v200, v193, 2, v200
    s_and_b32 s19, s3, 1
    v_mfma_f32_32x32x16_bf16 v[128:143], a[216:219], a[104:107], v[128:143]
    ds_read_b64_tr_b16 a[244:245], v235 offset:1024
    ds_read_b64_tr_b16 a[246:247], v235 offset:1280
    s_mul_i32 s19, s19, 1088
    v_add_u32 v250, s19, v200
    v_min_u32_e64 v200, 16, v194
    v_lshlrev_b32 v200, 6, v200
    v_mul_u32_u24 v201, 1088, v195
    v_mfma_f32_32x32x16_bf16 v[128:143], a[220:223], a[108:111], v[128:143]
    ds_read_b64_tr_b16 a[248:249], v235 offset:2048
    ds_read_b64_tr_b16 a[250:251], v235 offset:2304
    s_lshl_b32 s19, s3, 4
    v_add3_u32 v251, v200, v201, s19
    s_lshl_b32 s19, s86, 13
    s_and_b32 s23, s3, 1
    s_lshl_b32 s23, s23, 3
    s_waitcnt lgkmcnt(6)
    v_mfma_f32_32x32x16_bf16 v[128:143], a[224:227], a[112:115], v[128:143]
    ds_read_b64_tr_b16 a[252:253], v235 offset:3072
    ds_read_b64_tr_b16 a[254:255], v235 offset:3328
    s_add_u32 s19, s19, s23
    s_add_u32 s19, s19, 138240
    v_add_u32 v252, s19, v230
    v_add_u32 v253, 138240, v230
    v_lshlrev_b32_e64 v200, 7, v199
    v_mfma_f32_32x32x16_bf16 v[128:143], a[228:231], a[116:119], v[128:143]
    ds_read_b64_tr_b16 a[208:209], v235 offset:4096
    ds_read_b64_tr_b16 a[210:211], v235 offset:4352
    s_add_u32 s1, s84, 340992
    buffer_load_dwordx4 v244, s[36:39], s1 offen offset:3072 lds
    v_lshl_add_u32 v200, v196, 14, v200
    v_lshl_add_u32 v200, v198, 3, v200
    v_lshrrev_b32_e64 v201, 1, v197
    v_mfma_f32_32x32x16_bf16 v[128:143], a[232:235], a[120:123], v[128:143]
    ds_read_b64_tr_b16 a[212:213], v235 offset:5120
    ds_read_b64_tr_b16 a[214:215], v235 offset:5376
    v_lshl_add_u32 v201, v201, 1, v196
    v_xor_b32 v202, 0, v201
    v_lshl_add_u32 v236, v202, 5, v200
    v_add_u32 v240, 65536, v236
    v_xor_b32 v202, 1, v201
    v_mfma_f32_32x32x16_bf16 v[128:143], a[236:239], a[124:127], v[128:143]
    ds_read_b64_tr_b16 a[216:217], v235 offset:6144
    ds_read_b64_tr_b16 a[218:219], v235 offset:6400
    v_lshl_add_u32 v237, v202, 5, v200
    v_add_u32 v241, 65536, v237
    v_xor_b32 v202, 2, v201
    v_lshl_add_u32 v238, v202, 5, v200
    v_add_u32 v242, 65536, v238
    s_waitcnt lgkmcnt(6)
    v_mfma_f32_32x32x16_bf16 v[144:159], a[240:243], a[0:3], 0
    ds_read_b64_tr_b16 a[220:221], v235 offset:7168
    ds_read_b64_tr_b16 a[222:223], v235 offset:7424
    v_xor_b32_e64 v202, 3, v201
    v_lshl_add_u32 v239, v202, 5, v200
    v_add_u32 v243, 65536, v239
    v_and_b32_e64 v202, 7, v206
    v_lshlrev_b32_e64 v201, 2, v196
    v_mfma_f32_32x32x16_bf16 v[144:159], a[244:247], a[4:7], v[144:159]
    ds_read_b64_tr_b16 a[224:225], v235 offset:8192
    ds_read_b64_tr_b16 a[226:227], v235 offset:8448
    s_add_u32 m0, s74, 65536
    s_add_u32 s85, s26, 0
    buffer_load_dwordx4 v231, s[40:43], s85 offen offset:0 lds
    v_xor_b32 v201, v201, v202
    v_lshlrev_b32_e64 v201, 4, v201
    v_mfma_f32_32x32x16_bf16 v[144:159], a[248:251], a[8:11], v[144:159]
    ds_read_b64_tr_b16 a[228:229], v235 offset:9216
    ds_read_b64_tr_b16 a[230:231], v235 offset:9472
    v_lshrrev_b32 v200, 3, v206
    v_lshl_add_u32 v200, v200, 10, v201
    s_lshl_b32 s19, s31, 7
    v_add_u32_e64 v233, s19, v200
    v_add_u32 v123, 7168, v233
    v_add_u32 v124, 14336, v233
    v_mfma_f32_32x32x16_bf16 v[144:159], a[252:255], a[12:15], v[144:159]
    ds_read_b64_tr_b16 a[232:233], v235 offset:10240
    ds_read_b64_tr_b16 a[234:235], v235 offset:10496
    buffer_load_dwordx4 v120, s[40:43], s85 offen offset:1024 lds
    v_cvt_pk_bf16_f32 v208, v128, v129
    v_cvt_pk_bf16_f32 v209, v130, v131
    v_cvt_pk_bf16_f32 v210, v132, v133
    v_cvt_pk_bf16_f32 v211, v134, v135
    s_waitcnt lgkmcnt(6)
    v_mfma_f32_32x32x16_bf16 v[144:159], a[208:211], a[16:19], v[144:159]
    s_nop 0
    ds_read_b64_tr_b16 a[236:237], v235 offset:11264
    ds_read_b64_tr_b16 a[238:239], v235 offset:11520
    v_cvt_pk_bf16_f32 v212, v136, v137
    v_cvt_pk_bf16_f32 v213, v138, v139
    v_cvt_pk_bf16_f32 v214, v140, v141
    v_cvt_pk_bf16_f32 v215, v142, v143
    v_mfma_f32_32x32x16_bf16 v[176:191], v[216:219], v[208:211], 0
    v_mfma_f32_32x32x16_bf16 v[144:159], a[212:215], a[20:23], v[144:159]
    ds_read_b64_tr_b16 a[240:241], v235 offset:12288
    ds_read_b64_tr_b16 a[242:243], v235 offset:12544
    buffer_load_dwordx4 v121, s[40:43], s85 offen offset:2048 lds
    v_mfma_f32_32x32x16_bf16 v[128:143], v[220:223], v[212:215], 0
    v_mfma_f32_32x32x16_bf16 v[144:159], a[216:219], a[24:27], v[144:159]
    ds_read_b64_tr_b16 a[244:245], v235 offset:13312
    ds_read_b64_tr_b16 a[246:247], v235 offset:13568
    v_add_u32 v125, 21504, v233
    s_mul_i32 s78, s3, 458752
    s_lshl_b32 s79, s3, 17
    s_lshl_b32 s77, s4, 2
    s_add_u32 s77, s77, s3
    s_mul_i32 s77, s77, 147456
    v_mfma_f32_32x32x16_bf16 v[144:159], a[220:223], a[28:31], v[144:159]
    ds_read_b64_tr_b16 a[248:249], v235 offset:14336
    ds_read_b64_tr_b16 a[250:251], v235 offset:14592
    buffer_load_dwordx4 v122, s[40:43], s85 offen offset:3072 lds
    s_nop 0
    v_max3_f32 v224, v176, v177, v178
    v_max3_f32 v64, v128, v129, v130
    v_max3_f32 v225, v179, v180, v181
    v_max3_f32 v65, v131, v132, v133
    s_waitcnt lgkmcnt(6)
    v_mfma_f32_32x32x16_bf16 v[144:159], a[224:227], a[32:35], v[144:159]
    ds_read_b64_tr_b16 a[252:253], v235 offset:15360
    ds_read_b64_tr_b16 a[254:255], v235 offset:15616
    s_nop 0
    v_max3_f32 v224, v224, v182, v183
    v_max3_f32 v64, v64, v134, v135
    v_max3_f32 v225, v225, v184, v185
    v_max3_f32 v65, v65, v136, v137
    v_max3_f32 v224, v224, v186, v187
    v_max3_f32 v64, v64, v138, v139
    v_mfma_f32_32x32x16_bf16 v[144:159], a[228:231], a[36:39], v[144:159]
    ds_read_b64_tr_b16 a[208:209], v235 offset:16384
    ds_read_b64_tr_b16 a[210:211], v235 offset:16640
    s_add_u32 m0, s74, 69632
    s_add_u32 s85, s26, 114688
    buffer_load_dwordx4 v231, s[40:43], s85 offen offset:0 lds
    v_max3_f32 v225, v225, v188, v189
    v_max3_f32 v65, v65, v140, v141
    v_mfma_f32_32x32x16_bf16 v[144:159], a[232:235], a[40:43], v[144:159]
    ds_read_b64_tr_b16 a[212:213], v235 offset:17408
    ds_read_b64_tr_b16 a[214:215], v235 offset:17664
    v_max3_f32 v224, v224, v190, v191
    v_max3_f32 v64, v64, v142, v143
    v_max_f32_e64 v224, v224, v225
    v_max_f32_e64 v64, v64, v65
    v_mul_f32 v225, 0xbfb8aa3b, v224
    v_mul_f32 v65, 0xbfb8aa3b, v64
    v_mfma_f32_32x32x16_bf16 v[144:159], a[236:239], a[44:47], v[144:159]
    ds_read_b64_tr_b16 a[216:217], v235 offset:18432
    ds_read_b64_tr_b16 a[218:219], v235 offset:18688
    buffer_load_dwordx4 v120, s[40:43], s85 offen offset:1024 lds
    v_fma_f32 v176, v176, s73, v225
    v_fma_f32 v128, v128, s73, v65
    v_fma_f32 v177, v177, s73, v225
    v_fma_f32 v129, v129, s73, v65
    s_waitcnt lgkmcnt(6)
    s_nop 0
    v_mfma_f32_32x32x16_bf16 v[144:159], a[240:243], a[48:51], v[144:159]
    ds_read_b64_tr_b16 a[220:221], v235 offset:19456
    ds_read_b64_tr_b16 a[222:223], v235 offset:19712
    v_fma_f32 v178, v178, s73, v225
    v_fma_f32 v130, v130, s73, v65
    v_fma_f32 v179, v179, s73, v225
    v_fma_f32 v131, v131, s73, v65
    v_fma_f32 v180, v180, s73, v225
    v_fma_f32 v132, v132, s73, v65
    v_mfma_f32_32x32x16_bf16 v[144:159], a[244:247], a[52:55], v[144:159]
    ds_read_b64_tr_b16 a[224:225], v235 offset:20480
    ds_read_b64_tr_b16 a[226:227], v235 offset:20736
    buffer_load_dwordx4 v121, s[40:43], s85 offen offset:2048 lds
    v_fma_f32 v181, v181, s73, v225
    v_fma_f32 v133, v133, s73, v65
    v_fma_f32 v182, v182, s73, v225
    v_fma_f32 v134, v134, s73, v65
    v_mfma_f32_32x32x16_bf16 v[144:159], a[248:251], a[56:59], v[144:159]
    ds_read_b64_tr_b16 a[228:229], v235 offset:21504
    ds_read_b64_tr_b16 a[230:231], v235 offset:21760
    v_fma_f32 v183, v183, s73, v225
    v_fma_f32 v135, v135, s73, v65
    v_fma_f32 v184, v184, s73, v225
    v_fma_f32 v136, v136, s73, v65
    v_fma_f32 v185, v185, s73, v225
    v_fma_f32 v137, v137, s73, v65
    v_mfma_f32_32x32x16_bf16 v[144:159], a[252:255], a[60:63], v[144:159]
    ds_read_b64_tr_b16 a[232:233], v235 offset:22528
    ds_read_b64_tr_b16 a[234:235], v235 offset:22784
    buffer_load_dwordx4 v122, s[40:43], s85 offen offset:3072 lds
    v_fma_f32 v186, v186, s73, v225
    v_fma_f32 v138, v138, s73, v65
    v_fma_f32 v187, v187, s73, v225
    v_fma_f32 v139, v139, s73, v65
    s_waitcnt vmcnt(8)
    s_barrier
    s_waitcnt lgkmcnt(6)
    v_mfma_f32_32x32x16_bf16 v[144:159], a[208:211], a[64:67], v[144:159]
    ds_read_b64_tr_b16 a[236:237], v235 offset:23552
    ds_read_b64_tr_b16 a[238:239], v235 offset:23808
    v_fma_f32 v188, v188, s73, v225
    s_nop 0
    v_fma_f32 v140, v140, s73, v65
    v_fma_f32 v189, v189, s73, v225
    v_fma_f32 v141, v141, s73, v65
    v_fma_f32 v190, v190, s73, v225
    v_fma_f32 v142, v142, s73, v65
    v_mfma_f32_32x32x16_bf16 v[144:159], a[212:215], a[68:71], v[144:159]
    ds_read_b64_tr_b16 a[240:241], v235 offset:24576
    ds_read_b64_tr_b16 a[242:243], v235 offset:24832
    s_add_u32 m0, s74, 98304
    s_add_u32 s85, s27, 0
    buffer_load_dwordx4 v231, s[40:43], s85 offen offset:0 lds
    v_fma_f32 v191, v191, s73, v225
    v_fma_f32 v143, v143, s73, v65
    v_mfma_f32_32x32x16_bf16 v[144:159], a[216:219], a[72:75], v[144:159]
    ds_read_b64_tr_b16 a[244:245], v235 offset:25600
    ds_read_b64_tr_b16 a[246:247], v235 offset:25856
    v_exp_f32 v176, v176
    v_exp_f32 v128, v128
    v_exp_f32 v177, v177
    v_mfma_f32_32x32x16_bf16 v[144:159], a[220:223], a[76:79], v[144:159]
    ds_read_b64_tr_b16 a[248:249], v235 offset:26624
    ds_read_b64_tr_b16 a[250:251], v235 offset:26880
    v_exp_f32 v129, v129
    v_exp_f32 v178, v178
    s_lshl_b32 s80, s80, 10
    s_waitcnt lgkmcnt(6)
    v_mfma_f32_32x32x16_bf16 v[144:159], a[224:227], a[80:83], v[144:159]
    ds_read_b64_tr_b16 a[252:253], v235 offset:27648
    ds_read_b64_tr_b16 a[254:255], v235 offset:27904
    buffer_load_dwordx4 v120, s[40:43], s85 offen offset:1024 lds
    v_exp_f32 v130, v130
    v_exp_f32 v179, v179
    s_add_u32 s80, s80, s77
    v_mfma_f32_32x32x16_bf16 v[144:159], a[228:231], a[84:87], v[144:159]
    ds_read_b64_tr_b16 a[208:209], v235 offset:28672
    ds_read_b64_tr_b16 a[210:211], v235 offset:28928
    v_exp_f32 v131, v131
    v_exp_f32 v180, v180
    s_lshl_b32 s81, s81, 10
    v_mfma_f32_32x32x16_bf16 v[144:159], a[232:235], a[88:91], v[144:159]
    ds_read_b64_tr_b16 a[212:213], v235 offset:29696
    ds_read_b64_tr_b16 a[214:215], v235 offset:29952
    v_exp_f32 v132, v132
    v_add_f32 v226, v176, v177
    v_add_f32 v66, v128, v129
    v_exp_f32 v181, v181
    v_mfma_f32_32x32x16_bf16 v[144:159], a[236:239], a[92:95], v[144:159]
    ds_read_b64_tr_b16 a[216:217], v235 offset:30720
    ds_read_b64_tr_b16 a[218:219], v235 offset:30976
    buffer_load_dwordx4 v121, s[40:43], s85 offen offset:2048 lds
    v_exp_f32 v133, v133
    v_exp_f32 v182, v182
    s_waitcnt lgkmcnt(6)
    v_mfma_f32_32x32x16_bf16 v[144:159], a[240:243], a[96:99], v[144:159]
    ds_read_b64_tr_b16 a[220:221], v235 offset:31744
    ds_read_b64_tr_b16 a[222:223], v235 offset:32000
    v_exp_f32 v134, v134
    v_add_f32 v227, v178, v179
    v_add_f32 v67, v130, v131
    v_exp_f32_e64 v183, v183
    v_mfma_f32_32x32x16_bf16 v[144:159], a[244:247], a[100:103], v[144:159]
    ds_read_b64_tr_b16 a[224:225], v235 offset:32768
    ds_read_b64_tr_b16 a[226:227], v235 offset:33024
    v_bfe_u32 v112, v230, 4, 3
    v_min_u32 v112, 5, v112
    v_lshlrev_b32 v112, 21, v112
    buffer_load_dword a172, v112, s[52:55], 0 offen
    buffer_load_dword a172, off, s[56:59], 0
    v_mfma_f32_32x32x16_bf16 v[144:159], a[248:251], a[104:107], v[144:159]
    ds_read_b64_tr_b16 a[228:229], v235 offset:33792
    ds_read_b64_tr_b16 a[230:231], v235 offset:34048
    v_exp_f32 v135, v135
    v_add_f32 v227, v227, v180
    v_add_f32 v67, v67, v132
    v_exp_f32 v184, v184
    v_mfma_f32_32x32x16_bf16 v[144:159], a[252:255], a[108:111], v[144:159]
    ds_read_b64_tr_b16 a[232:233], v235 offset:34816
    ds_read_b64_tr_b16 a[234:235], v235 offset:35072
    buffer_load_dwordx4 v122, s[40:43], s85 offen offset:3072 lds
    v_exp_f32 v136, v136
    v_add_f32 v226, v226, v181
    v_add_f32 v66, v66, v133
    s_waitcnt lgkmcnt(6)
    v_mfma_f32_32x32x16_bf16 v[144:159], a[208:211], a[112:115], v[144:159]
    ds_read_b64_tr_b16 a[236:237], v235 offset:35840
    ds_read_b64_tr_b16 a[238:239], v235 offset:36096
    v_exp_f32 v185, v185
    v_exp_f32 v137, v137
    v_add_f32 v227, v227, v182
    v_add_f32 v67, v67, v134
    v_mfma_f32_32x32x16_bf16 v[144:159], a[212:215], a[116:119], v[144:159]
    ds_read_b64_tr_b16 a[240:241], v235 offset:36864
    ds_read_b64_tr_b16 a[242:243], v235 offset:37120
    v_lshlrev_b32 v113, 3, v230
    v_and_b32 v114, 0x1ff, v113
    v_and_b32 v113, 0x7ff, v113
    s_lshl_b32 s70, s2, 2
    s_add_u32 s70, s70, s3
    s_mul_i32 s0, s70, 1792
    s_lshl_b32 s72, s70, 9
    buffer_load_dword a172, v113, s[44:47], s0 offen
    buffer_load_dword a172, v114, s[48:51], s72 offen
    v_mfma_f32_32x32x16_bf16 v[144:159], a[216:219], a[120:123], v[144:159]
    ds_read_b64_tr_b16 a[244:245], v235 offset:37888
    ds_read_b64_tr_b16 a[246:247], v235 offset:38144
    v_exp_f32 v186, v186
    v_exp_f32 v138, v138
    v_add_f32 v226, v226, v183
    v_add_f32 v66, v66, v135
    v_mfma_f32_32x32x16_bf16 v[144:159], a[220:223], a[124:127], v[144:159]
    ds_read_b64_tr_b16 a[248:249], v235 offset:38912
    ds_read_b64_tr_b16 a[250:251], v235 offset:39168
    v_exp_f32 v187, v187
    v_exp_f32 v139, v139
    v_add_f32 v227, v227, v184
    s_waitcnt lgkmcnt(6)
    v_mfma_f32_32x32x16_bf16 v[160:175], a[224:227], a[0:3], 0
    ds_read_b64_tr_b16 a[252:253], v235 offset:39936
    ds_read_b64_tr_b16 a[254:255], v235 offset:40192
    v_add_f32 v67, v67, v136
    v_exp_f32 v188, v188
    v_exp_f32 v140, v140
    v_add_f32 v226, v226, v185
    v_mfma_f32_32x32x16_bf16 v[160:175], a[228:231], a[4:7], v[160:175]
    ds_read_b64_tr_b16 a[208:209], v235 offset:40960
    ds_read_b64_tr_b16 a[210:211], v235 offset:41216
    v_add_f32 v66, v66, v137
    v_exp_f32 v189, v189
    v_exp_f32 v141, v141
    v_mfma_f32_32x32x16_bf16 v[160:175], a[232:235], a[8:11], v[160:175]
    ds_read_b64_tr_b16 a[212:213], v235 offset:41984
    ds_read_b64_tr_b16 a[214:215], v235 offset:42240
    v_add_f32 v227, v227, v186
    v_add_f32 v67, v67, v138
    v_exp_f32 v190, v190
    v_exp_f32 v142, v142
    v_mfma_f32_32x32x16_bf16 v[160:175], a[236:239], a[12:15], v[160:175]
    ds_read_b64_tr_b16 a[216:217], v235 offset:43008
    ds_read_b64_tr_b16 a[218:219], v235 offset:43264
    v_lshlrev_b32 v113, 6, v230
    v_and_b32 v114, 0xfff, v113
    v_min_u32 v113, 13312, v113
    s_lshr_b32 s70, s2, 3
    s_lshl2_add_u32 s70, s70, s3
    s_mul_i32 s0, s70, 14336
    s_lshl_b32 s72, s70, 12
    buffer_load_dword a172, v113, s[44:47], s0 offen offset:384
    buffer_load_dword a172, v114, s[48:51], s72 offen offset:384
    s_waitcnt lgkmcnt(6)
    v_mfma_f32_32x32x16_bf16 v[160:175], a[240:243], a[16:19], v[160:175]
    ds_read_b64_tr_b16 a[220:221], v235 offset:44032
    ds_read_b64_tr_b16 a[222:223], v235 offset:44288
    v_add_f32 v226, v226, v187
    v_add_f32 v66, v66, v139
    v_exp_f32_e64 v191, v191
    v_exp_f32_e64 v143, v143
    v_mfma_f32_32x32x16_bf16 v[160:175], a[244:247], a[20:23], v[160:175]
    ds_read_b64_tr_b16 a[224:225], v235 offset:45056
    ds_read_b64_tr_b16 a[226:227], v235 offset:45312
    v_add_f32_e64 v227, v227, v188
    v_add_f32_e64 v67, v67, v140
    v_add_f32_e64 v226, v226, v189
    v_add_f32_e64 v66, v66, v141
    v_add_f32_e64 v227, v227, v190
    v_mfma_f32_32x32x16_bf16 v[160:175], a[248:251], a[24:27], v[160:175]
    ds_read_b64_tr_b16 a[228:229], v235 offset:46080
    ds_read_b64_tr_b16 a[230:231], v235 offset:46336
    v_add_f32_e64 v67, v67, v142
    v_add_f32_e64 v226, v226, v191
    v_add_f32_e64 v66, v66, v143
    v_cvt_pk_bf16_f32 v144, v144, v145
    v_cvt_pk_bf16_f32 v145, v146, v147
    v_cvt_pk_bf16_f32 v146, v148, v149
    v_mfma_f32_32x32x16_bf16 v[160:175], a[252:255], a[28:31], v[160:175]
    ds_read_b64_tr_b16 a[232:233], v235 offset:47104
    ds_read_b64_tr_b16 a[234:235], v235 offset:47360
    v_cvt_pk_bf16_f32 v147, v150, v151
    v_cvt_pk_bf16_f32 v148, v152, v153
    v_cvt_pk_bf16_f32 v149, v154, v155
    v_cvt_pk_bf16_f32 v150, v156, v157
    v_cvt_pk_bf16_f32 v151, v158, v159
    s_waitcnt lgkmcnt(6)
    v_mfma_f32_32x32x16_bf16 v[160:175], a[208:211], a[32:35], v[160:175]
    ds_read_b64_tr_b16 a[236:237], v235 offset:48128
    ds_read_b64_tr_b16 a[238:239], v235 offset:48384
    v_add_f32 v226, v226, v227
    v_add_f32_e64 v66, v66, v67
    v_rcp_f32_e64 v226, v226
    v_rcp_f32 v66, v66
    v_mfma_f32_32x32x16_bf16 v[160:175], a[212:215], a[36:39], v[160:175]
    ds_read_b64_tr_b16 a[240:241], v235 offset:49152
    ds_read_b64_tr_b16 a[242:243], v235 offset:49408
    s_add_u32 m0, s74, 102400
    s_add_u32 s85, s27, 114688
    buffer_load_dwordx4 v231, s[40:43], s85 offen offset:0 lds
    ds_write_b64 v247, v[144:145] offset:0
    s_add_u32 s81, s81, s77
    v_mfma_f32_32x32x16_bf16 v[160:175], a[216:219], a[40:43], v[160:175]
    ds_read_b64_tr_b16 a[244:245], v235 offset:50176
    ds_read_b64_tr_b16 a[246:247], v235 offset:50432
    v_mul_f32_e64 v176, v176, v226
    v_mul_f32_e64 v128, v128, v66
    v_mul_f32_e64 v177, v177, v226
    v_mul_f32_e64 v129, v129, v66
    ds_write_b64 v247, v[146:147] offset:2176
    s_mul_i32 s19, s86, 2176
    v_mfma_f32_32x32x16_bf16 v[160:175], a[220:223], a[44:47], v[160:175]
    ds_read_b64_tr_b16 a[248:249], v235 offset:51200
    ds_read_b64_tr_b16 a[250:251], v235 offset:51456
    v_mul_f32_e64 v178, v178, v226
    v_mul_f32_e64 v130, v130, v66
    v_mul_f32_e64 v179, v179, v226
    v_mul_f32_e64 v131, v131, v66
    ds_write_b64 v247, v[148:149] offset:4352
    s_waitcnt lgkmcnt(9)
    v_mfma_f32_32x32x16_bf16 v[160:175], a[224:227], a[48:51], v[160:175]
    ds_read_b64_tr_b16 a[252:253], v235 offset:52224
    ds_read_b64_tr_b16 a[254:255], v235 offset:52480
    buffer_load_dwordx4 v120, s[40:43], s85 offen offset:1024 lds
    s_add_u32 s16, s19, s17
    s_lshl_b32 s18, s5, 11
    s_add_u32 s18, s18, s77
    s_add_u32 s18, s18, 114688
    s_mul_i32 vcc_lo, s30, 294912
    v_mfma_f32_32x32x16_bf16 v[160:175], a[228:231], a[52:55], v[160:175]
    ds_read_b64_tr_b16 a[208:209], v235 offset:53248
    ds_read_b64_tr_b16 a[210:211], v235 offset:53504
    v_cvt_pk_bf16_f32 v208, v176, v177
    v_cvt_pk_bf16_f32 v72, v128, v129
    v_mul_f32_e64 v180, v180, v226
    v_mul_f32_e64 v132, v132, v66
    ds_write_b64 v247, v[150:151] offset:6528
    v_mfma_f32_32x32x16_bf16 v[160:175], a[232:235], a[56:59], v[160:175]
    ds_read_b64_tr_b16 a[212:213], v235 offset:54272
    ds_read_b64_tr_b16 a[214:215], v235 offset:54528
    s_mul_i32 s23, s3, 28672
    s_add_u32 s82, vcc_lo, s23
    s_mul_i32 vcc_hi, s86, 147456
    s_sub_u32 s21, s82, vcc_hi
    s_add_u32 s21, s21, 147456
    s_add_u32 s82, s82, vcc_hi
    v_mfma_f32_32x32x16_bf16 v[160:175], a[236:239], a[60:63], v[160:175]
    ds_read_b64_tr_b16 a[216:217], v235 offset:55296
    ds_read_b64_tr_b16 a[218:219], v235 offset:55552
    buffer_load_dwordx4 v121, s[40:43], s85 offen offset:2048 lds
    v_mul_f32 v181, v181, v226
    v_mul_f32 v133, v133, v66
    v_cvt_pk_bf16_f32 v209, v178, v179
    v_cvt_pk_bf16_f32 v73, v130, v131
    v_mul_f32 v182, v182, v226
    v_mul_f32 v134, v134, v66
    v_mul_f32 v183, v183, v226
    v_mul_f32 v135, v135, v66
    v_cvt_pk_bf16_f32 v210, v180, v181
    v_cvt_pk_bf16_f32 v74, v132, v133
    v_mul_f32 v184, v184, v226
    v_mul_f32 v136, v136, v66
    v_mul_f32 v185, v185, v226
    v_mul_f32 v137, v137, v66
    v_cvt_pk_bf16_f32 v211, v182, v183
    v_cvt_pk_bf16_f32 v75, v134, v135
    v_mul_f32 v186, v186, v226
    v_mul_f32 v138, v138, v66
    v_mul_f32 v187, v187, v226
    v_mul_f32 v139, v139, v66
    v_cvt_pk_bf16_f32 v212, v184, v185
    v_cvt_pk_bf16_f32 v76, v136, v137
    v_mul_f32 v188, v188, v226
    v_mul_f32 v140, v140, v66
    v_mul_f32 v189, v189, v226
    v_mul_f32 v141, v141, v66
    v_cvt_pk_bf16_f32 v213, v186, v187
    v_cvt_pk_bf16_f32 v77, v138, v139
    v_mul_f32 v190, v190, v226
    v_mul_f32_e64 v142, v142, v66
    v_mul_f32_e64 v191, v191, v226
    v_mul_f32_e64 v143, v143, v66
    v_cvt_pk_bf16_f32 v214, v188, v189
    v_cvt_pk_bf16_f32 v78, v140, v141
    v_cvt_pk_bf16_f32 v215, v190, v191
    v_cvt_pk_bf16_f32 v79, v142, v143
    ds_write_b64 v246, v[208:209] offset:0
    ds_write_b64 v246, v[72:73] offset:8704
    ds_write_b64 v246, v[210:211] offset:1088
    ds_write_b64 v246, v[74:75] offset:9792
    ds_write_b64 v246, v[212:213] offset:2176
    ds_write_b64 v246, v[76:77] offset:10880
    ds_write_b64 v246, v[214:215] offset:3264
    ds_write_b64 v246, v[78:79] offset:11968
    s_waitcnt lgkmcnt(0)
    s_waitcnt vmcnt(13)
    s_barrier
    v_mfma_f32_32x32x16_bf16 v[160:175], a[240:243], a[64:67], v[160:175]
    ds_read_b64_tr_b16 a[220:221], v235 offset:56320
    ds_read_b64_tr_b16 a[222:223], v235 offset:56576
    v_lshrrev_b32 v152, 6, v230
    v_bfe_u32 v153, v230, 4, 2
    v_lshlrev_b32_e64 v153, 3, v153
    v_lshl_add_u32 v152, v152, 7, v153
    s_add_u32 s71, s13, 32768
    buffer_load_dwordx2 v[154:155], v152, s[52:55], s71 offen sc1
    v_mfma_f32_32x32x16_bf16 v[160:175], a[244:247], a[68:71], v[160:175]
    ds_read_b64_tr_b16 a[224:225], v235 offset:57344
    ds_read_b64_tr_b16 a[226:227], v235 offset:57600
    ds_read_b64_tr_b16 a[176:177], v248 offset:0
    ds_read_b64_tr_b16 a[192:193], v249 offset:0
    v_and_b32 v156, 0x100, v230
    v_mfma_f32_32x32x16_bf16 v[160:175], a[248:251], a[72:75], v[160:175]
    ds_read_b64_tr_b16 a[228:229], v235 offset:58368
    ds_read_b64_tr_b16 a[230:231], v235 offset:58624
    ds_read_b64_tr_b16 a[178:179], v248 offset:128
    ds_read_b64_tr_b16 a[194:195], v249 offset:128
    v_xor_b32 v246, 65536, v235
    v_lshl_add_u32 v246, v156, 6, v246
    v_mfma_f32_32x32x16_bf16 v[160:175], a[252:255], a[76:79], v[160:175]
    ds_read_b64_tr_b16 a[232:233], v235 offset:59392
    ds_read_b64_tr_b16 a[234:235], v235 offset:59648
    buffer_load_dwordx4 v122, s[40:43], s85 offen offset:3072 lds
    ds_read_b64_tr_b16 a[180:181], v248 offset:256
    ds_read_b64_tr_b16 a[196:197], v249 offset:256
    s_waitcnt lgkmcnt(12)
    v_mfma_f32_32x32x16_bf16 v[160:175], a[208:211], a[80:83], v[160:175]
    ds_read_b64_tr_b16 a[236:237], v235 offset:60416
    ds_read_b64_tr_b16 a[238:239], v235 offset:60672
    v_xor_b32 v247, 32, v246
    v_lshrrev_b32_e64 v156, 9, v230
    v_bfe_u32 v157, v230, 6, 2
    v_lshl_add_u32 v156, v156, 2, v157
    v_mfma_f32_32x32x16_bf16 v[160:175], a[212:215], a[84:87], v[160:175]
    ds_read_b64_tr_b16 a[240:241], v235 offset:61440
    ds_read_b64_tr_b16 a[242:243], v235 offset:61696
    s_add_u32 m0, s74, 0
    s_add_u32 s85, s28, 0
    buffer_load_dwordx4 v231, s[40:43], s85 offen offset:0 lds
    v_mfma_f32_32x32x16_bf16 v[160:175], a[216:219], a[88:91], v[160:175]
    ds_read_b64_tr_b16 a[244:245], v235 offset:62464
    ds_read_b64_tr_b16 a[246:247], v235 offset:62720
    ds_read_b64_tr_b16 a[182:183], v248 offset:384
    ds_read_b64_tr_b16 a[198:199], v249 offset:384
    v_lshlrev_b32_e64 v156, 7, v156
    v_lshrrev_b32_e64 v157, 1, v157
    v_mfma_f32_32x32x16_bf16 v[160:175], a[220:223], a[92:95], v[160:175]
    ds_read_b64_tr_b16 a[248:249], v235 offset:63488
    ds_read_b64_tr_b16 a[250:251], v235 offset:63744
    ds_read_b64_tr_b16 a[184:185], v248 offset:512
    ds_read_b64_tr_b16 a[200:201], v249 offset:512
    v_lshl_add_u32 v156, v157, 6, v156
    s_waitcnt lgkmcnt(10)
    v_mfma_f32_32x32x16_bf16 v[160:175], a[224:227], a[96:99], v[160:175]
    s_nop 0
    ds_read_b64_tr_b16 a[252:253], v235 offset:64512
    ds_read_b64_tr_b16 a[254:255], v235 offset:64768
    buffer_load_dwordx4 v120, s[40:43], s85 offen offset:1024 lds
    ds_read_b64_tr_b16 a[186:187], v248 offset:640
    ds_read_b64_tr_b16 a[202:203], v249 offset:640
    v_bfe_u32 v157, v230, 8, 1
    v_mfma_f32_32x32x16_bf16 v[160:175], a[228:231], a[100:103], v[160:175]
    ds_read_b64_tr_b16 a[208:209], v240 offset:0
    ds_read_b64_tr_b16 a[210:211], v240 offset:512
    ds_read_b64_tr_b16 a[188:189], v248 offset:768
    ds_read_b64_tr_b16 a[204:205], v249 offset:768
    v_lshl_add_u32 v156, v157, 5, v156
    v_mfma_f32_32x32x16_bf16 v[160:175], a[232:235], a[104:107], v[160:175]
    ds_read_b64_tr_b16 a[212:213], v241 offset:0
    ds_read_b64_tr_b16 a[214:215], v241 offset:512
    ds_read_b64_tr_b16 a[190:191], v248 offset:896
    ds_read_b64_tr_b16 a[206:207], v249 offset:896
    v_bfe_u32 v157, v230, 4, 2
    v_lshl_add_u32 v156, v157, 3, v156
    v_mfma_f32_32x32x16_bf16 v[160:175], a[236:239], a[108:111], v[160:175]
    ds_read_b64_tr_b16 a[216:217], v242 offset:0
    ds_read_b64_tr_b16 a[218:219], v242 offset:512
    buffer_load_dwordx4 v121, s[40:43], s85 offen offset:2048 lds
    s_nop 0
    v_mfma_f32_16x16x32_bf16 a[164:167], a[192:195], a[176:179], 0
    s_waitcnt lgkmcnt(12)
    v_mfma_f32_32x32x16_bf16 v[160:175], a[240:243], a[112:115], v[160:175]
    ds_read_b64_tr_b16 a[220:221], v243 offset:0
    ds_read_b64_tr_b16 a[222:223], v243 offset:512
    v_mfma_f32_16x16x32_bf16 a[168:171], a[160:163], a[176:179], 0
    v_mfma_f32_32x32x16_bf16 v[160:175], a[244:247], a[116:119], v[160:175]
    ds_read_b64_tr_b16 a[224:225], v240 offset:2048
    ds_read_b64_tr_b16 a[226:227], v240 offset:2560
    v_mfma_f32_16x16x32_bf16 a[164:167], a[196:199], a[180:183], a[164:167]
    v_mfma_f32_32x32x16_bf16 v[160:175], a[248:251], a[120:123], v[160:175]
    ds_read_b64_tr_b16 a[228:229], v241 offset:2048
    ds_read_b64_tr_b16 a[230:231], v241 offset:2560
    buffer_load_dwordx4 v122, s[40:43], s85 offen offset:3072 lds
    v_mfma_f32_16x16x32_bf16 a[168:171], a[160:163], a[180:183], a[168:171]
    s_waitcnt lgkmcnt(15)
    v_mfma_f32_32x32x16_bf16 v[160:175], a[252:255], a[124:127], v[160:175]
    s_nop 0
    ds_read_b64_tr_b16 a[232:233], v242 offset:2048
    ds_read_b64_tr_b16 a[234:235], v242 offset:2560
    v_mfma_f32_16x16x32_bf16 a[164:167], a[200:203], a[184:187], a[164:167]
    s_waitcnt lgkmcnt(6)
    v_mfma_f32_32x32x16_bf16 v[0:15], a[208:211], a[0:3], 0
    ds_read_b64_tr_b16 a[236:237], v243 offset:2048
    ds_read_b64_tr_b16 a[238:239], v243 offset:2560
    s_nop 0
    v_mfma_f32_16x16x32_bf16 a[168:171], a[160:163], a[184:187], a[168:171]
    s_lshl_b32 s23, s3, 13
    s_add_u32 s83, vcc_lo, s23
    s_add_u32 s83, s83, 114688
    s_sub_u32 s22, s83, vcc_hi
    s_add_u32 s22, s22, 147456
    s_add_u32 s83, s83, vcc_hi
    s_lshl2_add_u32 vcc_hi, s30, s3
    s_lshl_b32 vcc_hi, vcc_hi, 7
    s_add_u32 s8, vcc_hi, 10813440
    s_add_u32 s9, vcc_hi, 10829824
    s_lshl_b32 vcc_lo, s30, 1
    s_add_u32 vcc_lo, vcc_lo, s86
    s_lshl_b32 vcc_lo, vcc_lo, 15
    s_lshl_b32 vcc_hi, s31, 7
    s_add_u32 vcc_lo, vcc_lo, vcc_hi
    s_and_b32 s19, s3, 1
    s_lshl_b32 s23, s19, 6
    s_add_u32 s10, vcc_lo, s23
    s_add_u32 s24, s15, 16384
    s_mov_b32 s11, s86
    s_mov_b32 s6, s2
    v_mfma_f32_32x32x16_bf16 v[16:31], a[212:215], a[0:3], 0
    ds_read_b64_tr_b16 a[240:241], v240 offset:4096
    ds_read_b64_tr_b16 a[242:243], v240 offset:4608
    s_add_u32 m0, s74, 4096
    s_add_u32 s85, s28, 114688
    buffer_load_dwordx4 v231, s[40:43], s85 offen offset:0 lds
    v_mfma_f32_32x32x16_bf16 v[32:47], a[216:219], a[0:3], 0
    ds_read_b64_tr_b16 a[244:245], v241 offset:4096
    ds_read_b64_tr_b16 a[246:247], v241 offset:4608
    v_mfma_f32_16x16x32_bf16 a[164:167], a[204:207], a[188:191], a[164:167]
    v_mfma_f32_32x32x16_bf16 v[48:63], a[220:223], a[0:3], 0
    ds_read_b64_tr_b16 a[248:249], v242 offset:4096
    ds_read_b64_tr_b16 a[250:251], v242 offset:4608
    v_mfma_f32_16x16x32_bf16 a[168:171], a[160:163], a[188:191], a[168:171]
    s_waitcnt lgkmcnt(6)
    v_mfma_f32_32x32x16_bf16 v[0:15], a[224:227], a[4:7], v[0:15]
    ds_read_b64_tr_b16 a[252:253], v243 offset:4096
    ds_read_b64_tr_b16 a[254:255], v243 offset:4608
    buffer_load_dwordx4 v120, s[40:43], s85 offen offset:1024 lds
    s_waitcnt vmcnt(7)
    v_cmp_eq_u64 vcc, s[68:69], v[154:155]
    s_mov_b32 s7, 0
    s_cmp_eq_u64 vcc, exec
    s_cbranch_scc1 L_pok_3
L_plp_4:
    buffer_load_dwordx2 v[154:155], v152, s[52:55], s71 offen sc1
    s_waitcnt vmcnt(0)
    v_cmp_eq_u64 vcc, s[68:69], v[154:155]
    s_add_u32 s7, s7, 1
    s_cmp_gt_u32 s7, 0x40000
    s_cbranch_scc1 L_pok_3
    s_cmp_eq_u64 vcc, exec
    s_cbranch_scc0 L_plp_4
L_pok_3:
    v_mfma_f32_32x32x16_bf16 v[16:31], a[228:231], a[4:7], v[16:31]
    ds_read_b64_tr_b16 a[208:209], v240 offset:6144
    ds_read_b64_tr_b16 a[210:211], v240 offset:6656
    buffer_atomic_add_f32 a164, v250, s[52:55], s16 offen offset:0 sc1
    s_and_b32 s70, s3, 1
    s_lshl_b32 s70, s70, 6
    v_xor_b32_e64 v156, s70, v156
    v_mfma_f32_32x32x16_bf16 v[32:47], a[232:235], a[4:7], v[32:47]
    ds_read_b64_tr_b16 a[212:213], v241 offset:6144
    ds_read_b64_tr_b16 a[214:215], v241 offset:6656
    buffer_atomic_add_f32 a165, v250, s[52:55], s16 offen offset:64 sc1
    s_add_u32 s70, s74, 131072
    v_add_u32 v254, s70, v156
    v_xor_b32_e64 v255, 64, v254
    v_mfma_f32_32x32x16_bf16 v[48:63], a[236:239], a[4:7], v[48:63]
    ds_read_b64_tr_b16 a[216:217], v242 offset:6144
    ds_read_b64_tr_b16 a[218:219], v242 offset:6656
    buffer_atomic_add_f32 a166, v250, s[52:55], s16 offen offset:128 sc1
    s_mov_b32 s86, s68
    s_mov_b32 s87, s68
    s_waitcnt lgkmcnt(6)
    v_mfma_f32_32x32x16_bf16 v[0:15], a[240:243], a[8:11], v[0:15]
    ds_read_b64_tr_b16 a[220:221], v243 offset:6144
    ds_read_b64_tr_b16 a[222:223], v243 offset:6656
    buffer_atomic_add_f32 a167, v250, s[52:55], s16 offen offset:192 sc1
    v_subrev_u32 v248, 131072, v254
    v_subrev_u32 v249, 131072, v255
    v_cvt_pk_bf16_f32 v208, v160, v161
    v_mfma_f32_32x32x16_bf16 v[16:31], a[244:247], a[8:11], v[16:31]
    ds_read_b64_tr_b16 a[224:225], v240 offset:8192
    ds_read_b64_tr_b16 a[226:227], v240 offset:8704
    s_mov_b64 exec, 0xffff
    buffer_atomic_add_f32 a168, v250, s[52:55], s16 offen offset:1024 sc1
    s_mov_b64 exec, -1
    v_mfma_f32_32x32x16_bf16 v[32:47], a[248:251], a[8:11], v[32:47]
    ds_read_b64_tr_b16 a[228:229], v241 offset:8192
    s_nop 0
    ds_read_b64_tr_b16 a[230:231], v241 offset:8704
    v_cvt_pk_bf16_f32 v209, v162, v163
    v_cvt_pk_bf16_f32 v210, v164, v165
    v_cvt_pk_bf16_f32 v211, v166, v167
    v_cvt_pk_bf16_f32 v212, v168, v169
    v_mfma_f32_32x32x16_bf16 v[48:63], a[252:255], a[8:11], v[48:63]
    ds_read_b64_tr_b16 a[232:233], v242 offset:8192
    ds_read_b64_tr_b16 a[234:235], v242 offset:8704
    buffer_load_dwordx4 v121, s[40:43], s85 offen offset:2048 lds
    v_cvt_pk_bf16_f32 v213, v170, v171
    v_cvt_pk_bf16_f32 v214, v172, v173
    s_waitcnt lgkmcnt(6)
    v_mfma_f32_32x32x16_bf16 v[0:15], a[208:211], a[12:15], v[0:15]
    ds_read_b64_tr_b16 a[236:237], v243 offset:8192
    ds_read_b64_tr_b16 a[238:239], v243 offset:8704
    v_cvt_pk_bf16_f32 v215, v174, v175
    s_nop 0
    v_mfma_f32_32x32x16_bf16 v[176:191], v[216:219], v[208:211], 0
    v_mfma_f32_32x32x16_bf16 v[16:31], a[212:215], a[12:15], v[16:31]
    ds_read_b64_tr_b16 a[240:241], v240 offset:10240
    ds_read_b64_tr_b16 a[242:243], v240 offset:10752
    v_mfma_f32_32x32x16_bf16 v[128:143], v[220:223], v[212:215], 0
    v_mfma_f32_32x32x16_bf16 v[32:47], a[216:219], a[12:15], v[32:47]
    ds_read_b64_tr_b16 a[244:245], v241 offset:10240
    ds_read_b64_tr_b16 a[246:247], v241 offset:10752
    buffer_load_dwordx4 v122, s[40:43], s85 offen offset:3072 lds
    v_mfma_f32_32x32x16_bf16 v[48:63], a[220:223], a[12:15], v[48:63]
    ds_read_b64_tr_b16 a[248:249], v242 offset:10240
    ds_read_b64_tr_b16 a[250:251], v242 offset:10752
    s_nop 0
    v_max3_f32 v224, v176, v177, v178
    s_nop 2
    v_max3_f32 v156, v128, v129, v130
    v_max3_f32 v225, v179, v180, v181
    s_waitcnt vmcnt(13)
    s_barrier
    s_waitcnt lgkmcnt(6)
    v_mfma_f32_32x32x16_bf16 v[0:15], a[224:227], a[16:19], v[0:15]
    ds_read_b64_tr_b16 a[252:253], v243 offset:10240
    ds_read_b64_tr_b16 a[254:255], v243 offset:10752
    s_add_u32 m0, s74, 131072
    s_add_u32 s23, s78, 0
    buffer_load_dwordx4 v233, s[44:47], s23 offen offset:0 lds
    v_max3_f32 v157, v131, v132, v133
    v_mfma_f32_32x32x16_bf16 v[16:31], a[228:231], a[16:19], v[16:31]
    ds_read_b64_tr_b16 a[208:209], v240 offset:12288
    ds_read_b64_tr_b16 a[210:211], v240 offset:12800
    v_max3_f32 v224, v224, v182, v183
    v_max3_f32 v156, v156, v134, v135
    v_max3_f32 v225, v225, v184, v185
    v_mfma_f32_32x32x16_bf16 v[32:47], a[232:235], a[16:19], v[32:47]
    ds_read_b64_tr_b16 a[212:213], v241 offset:12288
    ds_read_b64_tr_b16 a[214:215], v241 offset:12800
    buffer_load_dwordx4 v123, s[44:47], s23 offen offset:1024 lds
    v_max3_f32 v157, v157, v136, v137
    v_max3_f32 v224, v224, v186, v187
    v_max3_f32 v156, v156, v138, v139
    v_mfma_f32_32x32x16_bf16 v[48:63], a[236:239], a[16:19], v[48:63]
    ds_read_b64_tr_b16 a[216:217], v242 offset:12288
    ds_read_b64_tr_b16 a[218:219], v242 offset:12800
    v_max3_f32 v225, v225, v188, v189
    v_max3_f32 v157, v157, v140, v141
    v_max3_f32 v224, v224, v190, v191
    s_waitcnt lgkmcnt(6)
    v_mfma_f32_32x32x16_bf16 v[0:15], a[240:243], a[20:23], v[0:15]
    ds_read_b64_tr_b16 a[220:221], v243 offset:12288
    ds_read_b64_tr_b16 a[222:223], v243 offset:12800
    buffer_load_dwordx4 v124, s[44:47], s23 offen offset:2048 lds
    v_max3_f32 v156, v156, v142, v143
    v_max_f32 v224, v224, v225
    v_max_f32_e64 v156, v156, v157
    v_mfma_f32_32x32x16_bf16 v[16:31], a[244:247], a[20:23], v[16:31]
    ds_read_b64_tr_b16 a[224:225], v240 offset:14336
    ds_read_b64_tr_b16 a[226:227], v240 offset:14848
    v_mul_f32 v225, 0xbfb8aa3b, v224
    v_mul_f32 v157, 0xbfb8aa3b, v156
    v_fma_f32 v176, v176, s73, v225
    v_mfma_f32_32x32x16_bf16 v[32:47], a[248:251], a[20:23], v[32:47]
    ds_read_b64_tr_b16 a[228:229], v241 offset:14336
    ds_read_b64_tr_b16 a[230:231], v241 offset:14848
    buffer_load_dwordx4 v125, s[44:47], s23 offen offset:3072 lds
    v_fma_f32 v128, v128, s73, v157
    v_fma_f32 v177, v177, s73, v225
    v_fma_f32 v129, v129, s73, v157
    v_mfma_f32_32x32x16_bf16 v[48:63], a[252:255], a[20:23], v[48:63]
    ds_read_b64_tr_b16 a[232:233], v242 offset:14336
    ds_read_b64_tr_b16 a[234:235], v242 offset:14848
    v_fma_f32 v178, v178, s73, v225
    v_fma_f32 v130, v130, s73, v157
    v_fma_f32 v179, v179, s73, v225
    s_waitcnt lgkmcnt(6)
    v_mfma_f32_32x32x16_bf16 v[0:15], a[208:211], a[24:27], v[0:15]
    ds_read_b64_tr_b16 a[236:237], v243 offset:14336
    s_nop 0
    ds_read_b64_tr_b16 a[238:239], v243 offset:14848
    s_add_u32 m0, s74, 135168
    s_add_u32 s23, s78, 32768
    buffer_load_dwordx4 v233, s[44:47], s23 offen offset:0 lds
    v_fma_f32 v131, v131, s73, v157
    v_mfma_f32_32x32x16_bf16 v[16:31], a[212:215], a[24:27], v[16:31]
    ds_read_b64_tr_b16 a[240:241], v240 offset:32768
    ds_read_b64_tr_b16 a[242:243], v240 offset:33280
    v_fma_f32 v180, v180, s73, v225
    v_fma_f32 v132, v132, s73, v157
    v_fma_f32 v181, v181, s73, v225
    v_mfma_f32_32x32x16_bf16 v[32:47], a[216:219], a[24:27], v[32:47]
    ds_read_b64_tr_b16 a[244:245], v241 offset:32768
    ds_read_b64_tr_b16 a[246:247], v241 offset:33280
    buffer_load_dwordx4 v123, s[44:47], s23 offen offset:1024 lds
    v_fma_f32 v133, v133, s73, v157
    v_fma_f32 v182, v182, s73, v225
    v_fma_f32 v134, v134, s73, v157
    v_mfma_f32_32x32x16_bf16 v[48:63], a[220:223], a[24:27], v[48:63]
    ds_read_b64_tr_b16 a[248:249], v242 offset:32768
    ds_read_b64_tr_b16 a[250:251], v242 offset:33280
    v_fma_f32 v183, v183, s73, v225
    v_fma_f32 v135, v135, s73, v157
    s_nop 0
    v_fma_f32 v184, v184, s73, v225
    s_waitcnt lgkmcnt(6)
    v_mfma_f32_32x32x16_bf16 v[0:15], a[224:227], a[28:31], v[0:15]
    ds_read_b64_tr_b16 a[252:253], v243 offset:32768
    ds_read_b64_tr_b16 a[254:255], v243 offset:33280
    buffer_load_dwordx4 v124, s[44:47], s23 offen offset:2048 lds
    v_fma_f32 v136, v136, s73, v157
    v_fma_f32 v185, v185, s73, v225
    v_fma_f32 v137, v137, s73, v157
    v_mfma_f32_32x32x16_bf16 v[16:31], a[228:231], a[28:31], v[16:31]
    ds_read_b64_tr_b16 a[208:209], v240 offset:34816
    ds_read_b64_tr_b16 a[210:211], v240 offset:35328
    v_fma_f32 v186, v186, s73, v225
    v_fma_f32 v138, v138, s73, v157
    v_fma_f32 v187, v187, s73, v225
    v_mfma_f32_32x32x16_bf16 v[32:47], a[232:235], a[28:31], v[32:47]
    ds_read_b64_tr_b16 a[212:213], v241 offset:34816
    ds_read_b64_tr_b16 a[214:215], v241 offset:35328
    buffer_load_dwordx4 v125, s[44:47], s23 offen offset:3072 lds
    v_fma_f32 v139, v139, s73, v157
    v_fma_f32 v188, v188, s73, v225
    v_fma_f32 v140, v140, s73, v157
    v_mfma_f32_32x32x16_bf16 v[48:63], a[236:239], a[28:31], v[48:63]
    ds_read_b64_tr_b16 a[216:217], v242 offset:34816
    ds_read_b64_tr_b16 a[218:219], v242 offset:35328
    v_fma_f32 v189, v189, s73, v225
    v_fma_f32 v141, v141, s73, v157
    v_fma_f32 v190, v190, s73, v225
    s_waitcnt lgkmcnt(6)
    v_mfma_f32_32x32x16_bf16 v[0:15], a[240:243], a[32:35], v[0:15]
    ds_read_b64_tr_b16 a[220:221], v243 offset:34816
    ds_read_b64_tr_b16 a[222:223], v243 offset:35328
    s_add_u32 m0, s74, 32768
    s_add_u32 s85, s29, 0
    buffer_load_dwordx4 v231, s[40:43], s85 offen offset:0 lds
    v_fma_f32 v142, v142, s73, v157
    v_mfma_f32_32x32x16_bf16 v[16:31], a[244:247], a[32:35], v[16:31]
    ds_read_b64_tr_b16 a[224:225], v240 offset:36864
    ds_read_b64_tr_b16 a[226:227], v240 offset:37376
    v_fma_f32 v191, v191, s73, v225
    v_fma_f32 v143, v143, s73, v157
    v_mfma_f32_32x32x16_bf16 v[32:47], a[248:251], a[32:35], v[32:47]
    ds_read_b64_tr_b16 a[228:229], v241 offset:36864
    ds_read_b64_tr_b16 a[230:231], v241 offset:37376
    v_exp_f32 v176, v176
    v_exp_f32 v128, v128
    v_mfma_f32_32x32x16_bf16 v[48:63], a[252:255], a[32:35], v[48:63]
    ds_read_b64_tr_b16 a[232:233], v242 offset:36864
    ds_read_b64_tr_b16 a[234:235], v242 offset:37376
    buffer_load_dwordx4 v120, s[40:43], s85 offen offset:1024 lds
    v_exp_f32 v177, v177
    s_waitcnt lgkmcnt(6)
    v_mfma_f32_32x32x16_bf16 v[0:15], a[208:211], a[36:39], v[0:15]
    ds_read_b64_tr_b16 a[236:237], v243 offset:36864
    ds_read_b64_tr_b16 a[238:239], v243 offset:37376
    v_exp_f32 v129, v129
    v_exp_f32 v178, v178
    v_mfma_f32_32x32x16_bf16 v[16:31], a[212:215], a[36:39], v[16:31]
    ds_read_b64_tr_b16 a[240:241], v240 offset:38912
    ds_read_b64_tr_b16 a[242:243], v240 offset:39424
    v_exp_f32_e64 v130, v130
    v_mfma_f32_32x32x16_bf16 v[32:47], a[216:219], a[36:39], v[32:47]
    ds_read_b64_tr_b16 a[244:245], v241 offset:38912
    ds_read_b64_tr_b16 a[246:247], v241 offset:39424
    buffer_load_dwordx4 v121, s[40:43], s85 offen offset:2048 lds
    v_exp_f32 v179, v179
    v_mfma_f32_32x32x16_bf16 v[48:63], a[220:223], a[36:39], v[48:63]
    ds_read_b64_tr_b16 a[248:249], v242 offset:38912
    ds_read_b64_tr_b16 a[250:251], v242 offset:39424
    v_exp_f32_e64 v131, v131
    s_waitcnt lgkmcnt(6)
    v_mfma_f32_32x32x16_bf16 v[0:15], a[224:227], a[40:43], v[0:15]
    ds_read_b64_tr_b16 a[252:253], v243 offset:38912
    ds_read_b64_tr_b16 a[254:255], v243 offset:39424
    v_exp_f32 v180, v180
    v_exp_f32 v132, v132
    v_mfma_f32_32x32x16_bf16 v[16:31], a[228:231], a[40:43], v[16:31]
    ds_read_b64_tr_b16 a[208:209], v240 offset:40960
    ds_read_b64_tr_b16 a[210:211], v240 offset:41472
    buffer_load_dwordx4 v122, s[40:43], s85 offen offset:3072 lds
    v_add_f32 v226, v176, v177
    v_add_f32 v158, v128, v129
    v_mfma_f32_32x32x16_bf16 v[32:47], a[232:235], a[40:43], v[32:47]
    ds_read_b64_tr_b16 a[212:213], v241 offset:40960
    ds_read_b64_tr_b16 a[214:215], v241 offset:41472
    v_exp_f32 v181, v181
    v_exp_f32 v133, v133
    v_mfma_f32_32x32x16_bf16 v[48:63], a[236:239], a[40:43], v[48:63]
    ds_read_b64_tr_b16 a[216:217], v242 offset:40960
    ds_read_b64_tr_b16 a[218:219], v242 offset:41472
    v_exp_f32 v182, v182
    s_waitcnt lgkmcnt(6)
    v_mfma_f32_32x32x16_bf16 v[0:15], a[240:243], a[44:47], v[0:15]
    ds_read_b64_tr_b16 a[220:221], v243 offset:40960
    ds_read_b64_tr_b16 a[222:223], v243 offset:41472
    s_add_u32 m0, s74, 36864
    s_add_u32 s85, s29, 114688
    buffer_load_dwordx4 v231, s[40:43], s85 offen offset:0 lds
    v_mfma_f32_32x32x16_bf16 v[16:31], a[244:247], a[44:47], v[16:31]
    ds_read_b64_tr_b16 a[224:225], v240 offset:43008
    ds_read_b64_tr_b16 a[226:227], v240 offset:43520
    v_exp_f32 v134, v134
    v_add_f32 v227, v178, v179
    v_mfma_f32_32x32x16_bf16 v[32:47], a[248:251], a[44:47], v[32:47]
    ds_read_b64_tr_b16 a[228:229], v241 offset:43008
    ds_read_b64_tr_b16 a[230:231], v241 offset:43520
    v_add_f32_e64 v159, v130, v131
    v_exp_f32_e64 v183, v183
    v_mfma_f32_32x32x16_bf16 v[48:63], a[252:255], a[44:47], v[48:63]
    ds_read_b64_tr_b16 a[232:233], v242 offset:43008
    ds_read_b64_tr_b16 a[234:235], v242 offset:43520
    buffer_load_dwordx4 v120, s[40:43], s85 offen offset:1024 lds
    v_exp_f32 v135, v135
    s_waitcnt vmcnt(14)
    s_barrier
    s_waitcnt lgkmcnt(6)
    v_mfma_f32_32x32x16_bf16 v[0:15], a[208:211], a[48:51], v[0:15]
    ds_read_b64_tr_b16 a[236:237], v243 offset:43008
    ds_read_b64_tr_b16 a[238:239], v243 offset:43520
    s_waitcnt vmcnt(6)
    ds_read_b64_tr_b16 a[128:129], v254 offset:0
    ds_read_b64_tr_b16 a[130:131], v254 offset:1024
    v_add_f32 v227, v227, v180
    v_mfma_f32_32x32x16_bf16 v[16:31], a[212:215], a[48:51], v[16:31]
    ds_read_b64_tr_b16 a[240:241], v240 offset:45056
    ds_read_b64_tr_b16 a[242:243], v240 offset:45568
    v_mov_b32_e64 v228, s68
    v_mov_b32_e64 v229, s69
    buffer_store_dwordx2 v[228:229], off, s[52:55], s12 sc1
    v_mfma_f32_32x32x16_bf16 v[32:47], a[216:219], a[48:51], v[32:47]
    ds_read_b64_tr_b16 a[244:245], v241 offset:45056
    ds_read_b64_tr_b16 a[246:247], v241 offset:45568
    buffer_load_dwordx4 v121, s[40:43], s85 offen offset:2048 lds
    ds_read_b64_tr_b16 a[132:133], v255 offset:0
    ds_read_b64_tr_b16 a[134:135], v255 offset:1024
    v_add_f32 v159, v159, v132
    v_mfma_f32_32x32x16_bf16 v[48:63], a[220:223], a[48:51], v[48:63]
    ds_read_b64_tr_b16 a[248:249], v242 offset:45056
    ds_read_b64_tr_b16 a[250:251], v242 offset:45568
    ds_read_b64_tr_b16 a[136:137], v254 offset:2048
    ds_read_b64_tr_b16 a[138:139], v254 offset:3072
    s_waitcnt lgkmcnt(12)
    v_mfma_f32_32x32x16_bf16 v[0:15], a[224:227], a[52:55], v[0:15]
    ds_read_b64_tr_b16 a[252:253], v243 offset:45056
    ds_read_b64_tr_b16 a[254:255], v243 offset:45568
    buffer_load_dwordx4 v122, s[40:43], s85 offen offset:3072 lds
    ds_read_b64_tr_b16 a[140:141], v255 offset:2048
    ds_read_b64_tr_b16 a[142:143], v255 offset:3072
    v_mfma_f32_32x32x16_bf16 v[16:31], a[228:231], a[52:55], v[16:31]
    ds_read_b64_tr_b16 a[208:209], v240 offset:47104
    ds_read_b64_tr_b16 a[210:211], v240 offset:47616
    ds_read_b64_tr_b16 a[144:145], v254 offset:4096
    ds_read_b64_tr_b16 a[146:147], v254 offset:5120
    v_mfma_f32_32x32x16_bf16 v[32:47], a[232:235], a[52:55], v[32:47]
    ds_read_b64_tr_b16 a[212:213], v241 offset:47104
    ds_read_b64_tr_b16 a[214:215], v241 offset:47616
    s_add_u32 m0, s74, 65536
    s_add_u32 s85, s26, s75
    buffer_load_dwordx4 v231, s[40:43], s85 offen offset:0 lds
    s_nop 0
    ds_read_b64_tr_b16 a[148:149], v255 offset:4096
    v_mfma_f32_32x32x16_bf16 v[48:63], a[236:239], a[52:55], v[48:63]
    ds_read_b64_tr_b16 a[216:217], v242 offset:47104
    ds_read_b64_tr_b16 a[218:219], v242 offset:47616
    ds_read_b64_tr_b16 a[150:151], v255 offset:5120
    v_exp_f32 v184, v184
    s_waitcnt lgkmcnt(12)
    v_mfma_f32_32x32x16_bf16 v[0:15], a[240:243], a[56:59], v[0:15]
    ds_read_b64_tr_b16 a[220:221], v243 offset:47104
    ds_read_b64_tr_b16 a[222:223], v243 offset:47616
    ds_read_b64_tr_b16 a[152:153], v254 offset:6144
    ds_read_b64_tr_b16 a[154:155], v254 offset:7168
    v_exp_f32_e64 v136, v136
    v_mfma_f32_32x32x16_bf16 v[16:31], a[244:247], a[56:59], v[16:31]
    ds_read_b64_tr_b16 a[224:225], v236 offset:0
    ds_read_b64_tr_b16 a[226:227], v236 offset:512
    buffer_load_dwordx4 v120, s[40:43], s85 offen offset:1024 lds
    ds_read_b64_tr_b16 a[156:157], v255 offset:6144
    ds_read_b64_tr_b16 a[158:159], v255 offset:7168
    v_mfma_f32_32x32x16_bf16 v[32:47], a[248:251], a[56:59], v[32:47]
    ds_read_b64_tr_b16 a[228:229], v237 offset:0
    ds_read_b64_tr_b16 a[230:231], v237 offset:512
    v_add_f32 v226, v226, v181
    v_add_f32 v158, v158, v133
    v_exp_f32_e64 v185, v185
    v_mfma_f32_32x32x16_bf16 v[48:63], a[252:255], a[56:59], v[48:63]
    ds_read_b64_tr_b16 a[232:233], v238 offset:0
    ds_read_b64_tr_b16 a[234:235], v238 offset:512
    v_exp_f32 v137, v137
    v_add_f32 v227, v227, v182
    s_waitcnt lgkmcnt(10)
    v_mfma_f32_32x32x16_bf16 v[0:15], a[208:211], a[60:63], v[0:15]
    ds_read_b64_tr_b16 a[236:237], v239 offset:0
    ds_read_b64_tr_b16 a[238:239], v239 offset:512
    buffer_load_dwordx4 v121, s[40:43], s85 offen offset:2048 lds
    s_waitcnt lgkmcnt(6)
    v_add_f32_e64 v159, v159, v134
    v_mfma_f32_32x32x16_bf16 v[16:31], a[212:215], a[60:63], v[16:31]
    ds_read_b64_tr_b16 a[240:241], v236 offset:2048
    ds_read_b64_tr_b16 a[242:243], v236 offset:2560
    v_exp_f32_e64 v186, v186
    v_mfma_f32_32x32x16_bf16 v[32:47], a[216:219], a[60:63], v[32:47]
    ds_read_b64_tr_b16 a[244:245], v237 offset:2048
    ds_read_b64_tr_b16 a[246:247], v237 offset:2560
    s_add_u32 m0, s74, 131072
    s_add_u32 s23, s78, 131072
    buffer_load_dwordx4 v233, s[44:47], s23 offen offset:0 lds
    v_mfma_f32_32x32x16_bf16 v[48:63], a[220:223], a[60:63], v[48:63]
    ds_read_b64_tr_b16 a[248:249], v238 offset:2048
    ds_read_b64_tr_b16 a[250:251], v238 offset:2560
    v_exp_f32 v138, v138
    v_add_f32_e64 v226, v226, v183
    s_waitcnt lgkmcnt(6)
    v_mfma_f32_32x32x16_bf16 v[0:15], a[224:227], a[64:67], v[0:15]
    ds_read_b64_tr_b16 a[252:253], v239 offset:2048
    ds_read_b64_tr_b16 a[254:255], v239 offset:2560
    buffer_load_dwordx4 v123, s[44:47], s23 offen offset:1024 lds
    v_add_f32 v158, v158, v135
    v_exp_f32 v187, v187
    v_mfma_f32_32x32x16_bf16 v[16:31], a[228:231], a[64:67], v[16:31]
    ds_read_b64_tr_b16 a[208:209], v236 offset:4096
    ds_read_b64_tr_b16 a[210:211], v236 offset:4608
    v_exp_f32 v139, v139
    v_add_f32 v227, v227, v184
    v_mfma_f32_32x32x16_bf16 v[32:47], a[232:235], a[64:67], v[32:47]
    ds_read_b64_tr_b16 a[212:213], v237 offset:4096
    ds_read_b64_tr_b16 a[214:215], v237 offset:4608
    buffer_load_dwordx4 v124, s[44:47], s23 offen offset:2048 lds
    v_add_f32 v159, v159, v136
    v_exp_f32 v188, v188
    v_mfma_f32_32x32x16_bf16 v[48:63], a[236:239], a[64:67], v[48:63]
    ds_read_b64_tr_b16 a[216:217], v238 offset:4096
    ds_read_b64_tr_b16 a[218:219], v238 offset:4608
    v_exp_f32 v140, v140
    v_add_f32 v226, v226, v185
    s_waitcnt lgkmcnt(6)
    v_mfma_f32_32x32x16_bf16 v[0:15], a[240:243], a[68:71], v[0:15]
    ds_read_b64_tr_b16 a[220:221], v239 offset:4096
    ds_read_b64_tr_b16 a[222:223], v239 offset:4608
    buffer_load_dwordx4 v125, s[44:47], s23 offen offset:3072 lds
    v_add_f32 v158, v158, v137
    v_exp_f32_e64 v189, v189
    v_mfma_f32_32x32x16_bf16 v[16:31], a[244:247], a[68:71], v[16:31]
    ds_read_b64_tr_b16 a[224:225], v236 offset:6144
    ds_read_b64_tr_b16 a[226:227], v236 offset:6656
    v_exp_f32 v141, v141
    v_add_f32 v227, v227, v186
    v_mfma_f32_32x32x16_bf16 v[32:47], a[248:251], a[68:71], v[32:47]
    ds_read_b64_tr_b16 a[228:229], v237 offset:6144
    ds_read_b64_tr_b16 a[230:231], v237 offset:6656
    s_add_u32 m0, s74, 135168
    s_add_u32 s23, s78, 163840
    buffer_load_dwordx4 v233, s[44:47], s23 offen offset:0 lds
    v_add_f32 v159, v159, v138
    v_mfma_f32_32x32x16_bf16 v[48:63], a[252:255], a[68:71], v[48:63]
    ds_read_b64_tr_b16 a[232:233], v238 offset:6144
    ds_read_b64_tr_b16 a[234:235], v238 offset:6656
    v_exp_f32_e64 v190, v190
    s_waitcnt lgkmcnt(6)
    v_mfma_f32_32x32x16_bf16 v[0:15], a[208:211], a[72:75], v[0:15]
    ds_read_b64_tr_b16 a[236:237], v239 offset:6144
    ds_read_b64_tr_b16 a[238:239], v239 offset:6656
    buffer_load_dwordx4 v123, s[44:47], s23 offen offset:1024 lds
    v_exp_f32 v142, v142
    v_add_f32 v226, v226, v187
    v_mfma_f32_32x32x16_bf16 v[16:31], a[212:215], a[72:75], v[16:31]
    ds_read_b64_tr_b16 a[240:241], v236 offset:8192
    ds_read_b64_tr_b16 a[242:243], v236 offset:8704
    v_add_f32 v158, v158, v139
    v_exp_f32 v191, v191
    v_mfma_f32_32x32x16_bf16 v[32:47], a[216:219], a[72:75], v[32:47]
    ds_read_b64_tr_b16 a[244:245], v237 offset:8192
    ds_read_b64_tr_b16 a[246:247], v237 offset:8704
    buffer_load_dwordx4 v124, s[44:47], s23 offen offset:2048 lds
    v_exp_f32 v143, v143
    v_add_f32 v227, v227, v188
    v_mfma_f32_32x32x16_bf16 v[48:63], a[220:223], a[72:75], v[48:63]
    ds_read_b64_tr_b16 a[248:249], v238 offset:8192
    ds_read_b64_tr_b16 a[250:251], v238 offset:8704
    v_add_f32 v159, v159, v140
    v_add_f32 v226, v226, v189
    v_add_f32 v158, v158, v141
    s_waitcnt lgkmcnt(6)
    v_mfma_f32_32x32x16_bf16 v[0:15], a[224:227], a[76:79], v[0:15]
    ds_read_b64_tr_b16 a[252:253], v239 offset:8192
    ds_read_b64_tr_b16 a[254:255], v239 offset:8704
    buffer_load_dwordx4 v125, s[44:47], s23 offen offset:3072 lds
    v_add_f32 v227, v227, v190
    v_add_f32 v159, v159, v142
    v_add_f32_e64 v226, v226, v191
    v_mfma_f32_32x32x16_bf16 v[16:31], a[228:231], a[76:79], v[16:31]
    ds_read_b64_tr_b16 a[208:209], v236 offset:10240
    ds_read_b64_tr_b16 a[210:211], v236 offset:10752
    v_add_f32 v158, v158, v143
    v_add_f32 v226, v226, v227
    v_add_f32 v158, v158, v159
    v_mfma_f32_32x32x16_bf16 v[32:47], a[232:235], a[76:79], v[32:47]
    ds_read_b64_tr_b16 a[212:213], v237 offset:10240
    ds_read_b64_tr_b16 a[214:215], v237 offset:10752
    s_add_u32 m0, s74, 65536
    s_nop 0
    buffer_load_dwordx4 v122, s[40:43], s85 offen offset:3072 lds
    v_rcp_f32 v226, v226
    v_mfma_f32_32x32x16_bf16 v[48:63], a[236:239], a[76:79], v[48:63]
    ds_read_b64_tr_b16 a[216:217], v238 offset:10240
    ds_read_b64_tr_b16 a[218:219], v238 offset:10752
    v_rcp_f32 v158, v158
    v_mul_f32 v176, v176, v226
    s_waitcnt vmcnt(12)
    s_barrier
    s_waitcnt lgkmcnt(6)
    v_mfma_f32_32x32x16_bf16 v[0:15], a[240:243], a[80:83], v[0:15]
    ds_read_b64_tr_b16 a[220:221], v239 offset:10240
    ds_read_b64_tr_b16 a[222:223], v239 offset:10752
    v_mul_f32 v128, v128, v158
    v_mul_f32 v177, v177, v226
    v_mul_f32 v129, v129, v158
    v_mul_f32 v178, v178, v226
    v_mfma_f32_32x32x16_bf16 v[16:31], a[244:247], a[80:83], v[16:31]
    ds_read_b64_tr_b16 a[224:225], v236 offset:12288
    ds_read_b64_tr_b16 a[226:227], v236 offset:12800
    s_add_u32 m0, s74, 69632
    s_add_u32 s85, s26, s75
    s_add_u32 s85, s85, 114688
    buffer_load_dwordx4 v231, s[40:43], s85 offen offset:0 lds
    v_mfma_f32_32x32x16_bf16 v[32:47], a[248:251], a[80:83], v[32:47]
    ds_read_b64_tr_b16 a[228:229], v237 offset:12288
    ds_read_b64_tr_b16 a[230:231], v237 offset:12800
    v_mul_f32 v130, v130, v158
    v_mul_f32 v179, v179, v226
    v_mul_f32 v131, v131, v158
    v_cvt_pk_bf16_f32 v192, v176, v177
    v_mfma_f32_32x32x16_bf16 v[48:63], a[252:255], a[80:83], v[48:63]
    ds_read_b64_tr_b16 a[232:233], v238 offset:12288
    ds_read_b64_tr_b16 a[234:235], v238 offset:12800
    buffer_load_dwordx4 v120, s[40:43], s85 offen offset:1024 lds
    v_cvt_pk_bf16_f32 v200, v128, v129
    v_mul_f32 v180, v180, v226
    s_waitcnt lgkmcnt(6)
    v_mfma_f32_32x32x16_bf16 v[0:15], a[208:211], a[84:87], v[0:15]
    ds_read_b64_tr_b16 a[236:237], v239 offset:12288
    ds_read_b64_tr_b16 a[238:239], v239 offset:12800
    buffer_load_dwordx2 v[146:147], v152, s[52:55], s13 offen sc1
    v_mul_f32 v132, v132, v158
    v_mul_f32 v181, v181, v226
    v_mul_f32_e64 v133, v133, v158
    v_mfma_f32_32x32x16_bf16 v[16:31], a[212:215], a[84:87], v[16:31]
    ds_read_b64_tr_b16 a[240:241], v236 offset:14336
    ds_read_b64_tr_b16 a[242:243], v236 offset:14848
    v_cvt_pk_bf16_f32 v193, v178, v179
    v_cvt_pk_bf16_f32 v201, v130, v131
    v_mul_f32 v182, v182, v226
    v_mfma_f32_32x32x16_bf16 v[32:47], a[216:219], a[84:87], v[32:47]
    ds_read_b64_tr_b16 a[244:245], v237 offset:14336
    ds_read_b64_tr_b16 a[246:247], v237 offset:14848
    v_mul_f32 v134, v134, v158
    v_mul_f32 v183, v183, v226
    v_mul_f32 v135, v135, v158
    v_cvt_pk_bf16_f32 v194, v180, v181
    v_mfma_f32_32x32x16_bf16 v[48:63], a[220:223], a[84:87], v[48:63]
    ds_read_b64_tr_b16 a[248:249], v238 offset:14336
    ds_read_b64_tr_b16 a[250:251], v238 offset:14848
    buffer_load_dwordx4 v121, s[40:43], s85 offen offset:2048 lds
    v_cvt_pk_bf16_f32 v202, v132, v133
    v_mul_f32 v184, v184, v226
    s_waitcnt lgkmcnt(6)
    v_mfma_f32_32x32x16_bf16 v[0:15], a[224:227], a[88:91], v[0:15]
    ds_read_b64_tr_b16 a[252:253], v239 offset:14336
    ds_read_b64_tr_b16 a[254:255], v239 offset:14848
    v_mul_f32 v136, v136, v158
    v_mul_f32 v185, v185, v226
    v_mul_f32_e64 v137, v137, v158
    v_cvt_pk_bf16_f32 v195, v182, v183
    v_mfma_f32_32x32x16_bf16 v[16:31], a[228:231], a[88:91], v[16:31]
    ds_read_b64_tr_b16 a[208:209], v236 offset:32768
    ds_read_b64_tr_b16 a[210:211], v236 offset:33280
    buffer_load_dwordx4 v122, s[40:43], s85 offen offset:3072 lds
    v_cvt_pk_bf16_f32 v203, v134, v135
    v_mul_f32_e64 v186, v186, v226
    v_mfma_f32_32x32x16_bf16 v[32:47], a[232:235], a[88:91], v[32:47]
    ds_read_b64_tr_b16 a[212:213], v236 offset:34816
    ds_read_b64_tr_b16 a[214:215], v236 offset:35328
    v_mul_f32_e64 v138, v138, v158
    v_mul_f32_e64 v187, v187, v226
    v_mul_f32_e64 v139, v139, v158
    v_cvt_pk_bf16_f32 v196, v184, v185
    v_mfma_f32_32x32x16_bf16 v[48:63], a[236:239], a[88:91], v[48:63]
    ds_read_b64_tr_b16 a[216:217], v236 offset:36864
    ds_read_b64_tr_b16 a[218:219], v236 offset:37376
    s_add_u32 m0, s74, 98304
    s_add_u32 s85, s27, s75
    buffer_load_dwordx4 v231, s[40:43], s85 offen offset:0 lds
    s_waitcnt lgkmcnt(6)
    v_mfma_f32_32x32x16_bf16 v[0:15], a[240:243], a[92:95], v[0:15]
    ds_read_b64_tr_b16 a[220:221], v236 offset:38912
    ds_read_b64_tr_b16 a[222:223], v236 offset:39424
    v_cvt_pk_bf16_f32 v204, v136, v137
    v_mul_f32_e64 v188, v188, v226
    v_mul_f32_e64 v140, v140, v158
    v_mul_f32_e64 v189, v189, v226
    v_mfma_f32_32x32x16_bf16 v[16:31], a[244:247], a[92:95], v[16:31]
    ds_read_b64_tr_b16 a[224:225], v236 offset:40960
    ds_read_b64_tr_b16 a[226:227], v236 offset:41472
    v_mul_f32 v141, v141, v158
    v_cvt_pk_bf16_f32 v197, v186, v187
    v_cvt_pk_bf16_f32 v205, v138, v139
    v_mfma_f32_32x32x16_bf16 v[32:47], a[248:251], a[92:95], v[32:47]
    ds_read_b64_tr_b16 a[228:229], v236 offset:43008
    ds_read_b64_tr_b16 a[230:231], v236 offset:43520
    buffer_load_dwordx4 v120, s[40:43], s85 offen offset:1024 lds
    s_waitcnt vmcnt(8)
    ds_read_b64_tr_b16 v[64:65], v254 offset:0
    ds_read_b64_tr_b16 v[66:67], v254 offset:1024
    v_mfma_f32_32x32x16_bf16 v[48:63], a[252:255], a[92:95], v[48:63]
    ds_read_b64_tr_b16 a[232:233], v236 offset:45056
    ds_read_b64_tr_b16 a[234:235], v236 offset:45568
    v_mul_f32 v190, v190, v226
    v_mul_f32_e64 v142, v142, v158
    v_mul_f32_e64 v191, v191, v226
    s_waitcnt lgkmcnt(8)
    v_mfma_f32_32x32x16_bf16 v[0:15], a[208:211], a[96:99], v[0:15]
    ds_read_b64_tr_b16 a[236:237], v236 offset:47104
    ds_read_b64_tr_b16 a[238:239], v236 offset:47616
    ds_read_b64_tr_b16 v[68:69], v255 offset:0
    ds_read_b64_tr_b16 v[70:71], v255 offset:1024
    v_mul_f32_e64 v143, v143, v158
    v_cvt_pk_bf16_f32 v198, v188, v189
    v_mfma_f32_32x32x16_bf16 v[0:15], a[212:215], a[100:103], v[0:15]
    ds_read_b64_tr_b16 a[240:241], v237 offset:32768
    ds_read_b64_tr_b16 a[242:243], v237 offset:33280
    buffer_load_dwordx4 v121, s[40:43], s85 offen offset:2048 lds
    ds_read_b64_tr_b16 v[72:73], v254 offset:2048
    ds_read_b64_tr_b16 v[74:75], v254 offset:3072
    v_mfma_f32_32x32x16_bf16 v[0:15], a[216:219], a[104:107], v[0:15]
    ds_read_b64_tr_b16 a[244:245], v237 offset:34816
    ds_read_b64_tr_b16 a[246:247], v237 offset:35328
    v_cvt_pk_bf16_f32 v206, v140, v141
    v_cvt_pk_bf16_f32 v199, v190, v191
    v_cvt_pk_bf16_f32 v207, v142, v143
    v_mfma_f32_32x32x16_bf16 v[0:15], a[220:223], a[108:111], v[0:15]
    ds_read_b64_tr_b16 a[248:249], v237 offset:36864
    ds_read_b64_tr_b16 a[250:251], v237 offset:37376
    ds_read_b64_tr_b16 v[76:77], v255 offset:2048
    s_nop 0
    ds_read_b64_tr_b16 v[78:79], v255 offset:3072
    s_waitcnt lgkmcnt(12)
    v_mfma_f32_32x32x16_bf16 v[0:15], a[224:227], a[112:115], v[0:15]
    ds_read_b64_tr_b16 a[252:253], v237 offset:38912
    ds_read_b64_tr_b16 a[254:255], v237 offset:39424
    buffer_load_dwordx4 v122, s[40:43], s85 offen offset:3072 lds
    ds_read_b64_tr_b16 v[80:81], v254 offset:4096
    ds_read_b64_tr_b16 v[82:83], v254 offset:5120
    v_mfma_f32_32x32x16_bf16 v[0:15], a[228:231], a[116:119], v[0:15]
    ds_read_b64_tr_b16 a[208:209], v237 offset:40960
    ds_read_b64_tr_b16 a[210:211], v237 offset:41472
    ds_read_b64_tr_b16 v[84:85], v255 offset:4096
    ds_read_b64_tr_b16 v[86:87], v255 offset:5120
    v_mfma_f32_32x32x16_bf16 v[0:15], a[232:235], a[120:123], v[0:15]
    ds_read_b64_tr_b16 a[212:213], v237 offset:43008
    ds_read_b64_tr_b16 a[214:215], v237 offset:43520
    ds_read_b64_tr_b16 v[88:89], v254 offset:6144
    ds_read_b64_tr_b16 v[90:91], v254 offset:7168
    v_mfma_f32_32x32x16_bf16 v[0:15], a[236:239], a[124:127], v[0:15]
    ds_read_b64_tr_b16 a[216:217], v237 offset:45056
    ds_read_b64_tr_b16 a[218:219], v237 offset:45568
    s_add_u32 m0, s74, 102400
    s_add_u32 s85, s27, s75
    s_add_u32 s85, s85, 114688
    buffer_load_dwordx4 v231, s[40:43], s85 offen offset:0 lds
    s_waitcnt lgkmcnt(12)
    v_mfma_f32_32x32x16_bf16 v[16:31], a[240:243], a[96:99], v[16:31]
    ds_read_b64_tr_b16 a[220:221], v237 offset:47104
    ds_read_b64_tr_b16 a[222:223], v237 offset:47616
    ds_read_b64_tr_b16 v[92:93], v255 offset:6144
    ds_read_b64_tr_b16 v[94:95], v255 offset:7168
    v_mfma_f32_32x32x16_bf16 v[16:31], a[244:247], a[100:103], v[16:31]
    ds_read_b64_tr_b16 a[224:225], v238 offset:32768
    ds_read_b64_tr_b16 a[226:227], v238 offset:33280
    v_mfma_f32_32x32x16_bf16 v[16:31], a[248:251], a[104:107], v[16:31]
    ds_read_b64_tr_b16 a[228:229], v238 offset:34816
    ds_read_b64_tr_b16 a[230:231], v238 offset:35328
    buffer_load_dwordx4 v120, s[40:43], s85 offen offset:1024 lds
    s_waitcnt lgkmcnt(4)
    v_mfma_f32_32x32x16_bf16 v[16:31], a[252:255], a[108:111], v[16:31]
    ds_read_b64_tr_b16 a[232:233], v238 offset:36864
    ds_read_b64_tr_b16 a[234:235], v238 offset:37376
    v_max_f32 v0, 0, v0
    v_max_f32_e64 v1, 0, v1
    v_max_f32 v2, 0, v2
    v_mfma_f32_32x32x16_bf16 v[16:31], a[208:211], a[112:115], v[16:31]
    ds_read_b64_tr_b16 a[236:237], v238 offset:38912
    ds_read_b64_tr_b16 a[238:239], v238 offset:39424
    s_add_u32 m0, s74, 131072
    s_add_u32 s23, s78, 262144
    buffer_load_dwordx4 v233, s[44:47], s23 offen offset:0 lds
    s_waitcnt vmcnt(9)
    v_cmp_eq_u64 vcc, s[68:69], v[146:147]
    s_mov_b32 s7, 0
    s_cmp_eq_u64 vcc, exec
    s_cbranch_scc1 L_pok_5
L_plp_6:
    buffer_load_dwordx2 v[146:147], v152, s[52:55], s13 offen sc1
    s_waitcnt vmcnt(0)
    v_cmp_eq_u64 vcc, s[68:69], v[146:147]
    s_add_u32 s7, s7, 1
    s_cmp_gt_u32 s7, 0x40000
    s_cbranch_scc1 L_pok_5
    s_cmp_eq_u64 vcc, exec
    s_cbranch_scc0 L_plp_6
L_pok_5:
    v_mfma_f32_32x32x16_bf16 v[16:31], a[212:215], a[116:119], v[16:31]
    ds_read_b64_tr_b16 a[240:241], v238 offset:40960
    ds_read_b64_tr_b16 a[242:243], v238 offset:41472
    buffer_load_dwordx4 v[148:151], v251, s[52:55], s17 offen offset:0 sc1
    v_max_f32 v3, 0, v3
    v_max_f32 v4, 0, v4
    v_mfma_f32_32x32x16_bf16 v[16:31], a[216:219], a[120:123], v[16:31]
    ds_read_b64_tr_b16 a[244:245], v238 offset:43008
    ds_read_b64_tr_b16 a[246:247], v238 offset:43520
    buffer_load_dwordx4 v[152:155], v251, s[52:55], s17 offen offset:2176 sc1
    v_max_f32 v5, 0, v5
    v_max_f32 v6, 0, v6
    v_max_f32 v7, 0, v7
    v_mfma_f32_32x32x16_bf16 v[16:31], a[220:223], a[124:127], v[16:31]
    ds_read_b64_tr_b16 a[248:249], v238 offset:45056
    ds_read_b64_tr_b16 a[250:251], v238 offset:45568
    v_mul_f32 v0, v0, v8
    v_mul_f32 v1, v1, v9
    v_mul_f32_e64 v2, v2, v10
    s_waitcnt vmcnt(9)
    s_barrier
    s_waitcnt lgkmcnt(6)
    v_mfma_f32_32x32x16_bf16 v[32:47], a[224:227], a[96:99], v[32:47]
    ds_read_b64_tr_b16 a[252:253], v238 offset:47104
    ds_read_b64_tr_b16 a[254:255], v238 offset:47616
    buffer_load_dwordx4 v123, s[44:47], s23 offen offset:1024 lds
    v_mul_f32 v3, v3, v11
    v_mul_f32 v4, v4, v12
    v_mul_f32 v5, v5, v13
    v_mfma_f32_32x32x16_bf16 v[32:47], a[228:231], a[100:103], v[32:47]
    ds_read_b64_tr_b16 a[208:209], v239 offset:32768
    ds_read_b64_tr_b16 a[210:211], v239 offset:33280
    v_mul_f32 v6, v6, v14
    v_mul_f32_e64 v7, v7, v15
    v_cvt_pk_bf16_f32 v0, v0, v1
    v_mfma_f32_32x32x16_bf16 v[32:47], a[232:235], a[104:107], v[32:47]
    ds_read_b64_tr_b16 a[212:213], v239 offset:34816
    ds_read_b64_tr_b16 a[214:215], v239 offset:35328
    buffer_load_dwordx4 v124, s[44:47], s23 offen offset:2048 lds
    v_cvt_pk_bf16_f32 v1, v2, v3
    v_cvt_pk_bf16_f32 v2, v4, v5
    v_cvt_pk_bf16_f32 v3, v6, v7
    v_mfma_f32_32x32x16_bf16 v[32:47], a[236:239], a[108:111], v[32:47]
    ds_read_b64_tr_b16 a[216:217], v239 offset:36864
    ds_read_b64_tr_b16 a[218:219], v239 offset:37376
    buffer_store_dwordx4 v[0:3], v230, s[52:55], s80 offen offset:0 sc1
    v_max_f32 v16, 0, v16
    v_max_f32_e64 v17, 0, v17
    s_waitcnt lgkmcnt(6)
    v_mfma_f32_32x32x16_bf16 v[32:47], a[240:243], a[112:115], v[32:47]
    ds_read_b64_tr_b16 a[220:221], v239 offset:38912
    ds_read_b64_tr_b16 a[222:223], v239 offset:39424
    v_max_f32 v18, 0, v18
    v_max_f32 v19, 0, v19
    v_max_f32 v20, 0, v20
    v_max_f32 v21, 0, v21
    v_mfma_f32_32x32x16_bf16 v[32:47], a[244:247], a[116:119], v[32:47]
    ds_read_b64_tr_b16 a[224:225], v239 offset:40960
    ds_read_b64_tr_b16 a[226:227], v239 offset:41472
    buffer_load_dwordx4 v125, s[44:47], s23 offen offset:3072 lds
    v_max_f32 v22, 0, v22
    v_max_f32 v23, 0, v23
    v_mfma_f32_32x32x16_bf16 v[32:47], a[248:251], a[120:123], v[32:47]
    ds_read_b64_tr_b16 a[228:229], v239 offset:43008
    ds_read_b64_tr_b16 a[230:231], v239 offset:43520
    v_mul_f32 v16, v16, v24
    v_mul_f32 v17, v17, v25
    v_mul_f32 v18, v18, v26
    v_mul_f32 v19, v19, v27
    v_mfma_f32_32x32x16_bf16 v[32:47], a[252:255], a[124:127], v[32:47]
    ds_read_b64_tr_b16 a[232:233], v239 offset:45056
    ds_read_b64_tr_b16 a[234:235], v239 offset:45568
    s_add_u32 m0, s74, 135168
    s_add_u32 s23, s78, 294912
    buffer_load_dwordx4 v233, s[44:47], s23 offen offset:0 lds
    s_waitcnt lgkmcnt(6)
    v_mfma_f32_32x32x16_bf16 v[48:63], a[208:211], a[96:99], v[48:63]
    ds_read_b64_tr_b16 a[236:237], v239 offset:47104
    ds_read_b64_tr_b16 a[238:239], v239 offset:47616
    v_mul_f32 v20, v20, v28
    v_mul_f32 v21, v21, v29
    v_mul_f32 v22, v22, v30
    v_mul_f32_e64 v23, v23, v31
    v_mfma_f32_32x32x16_bf16 v[48:63], a[212:215], a[100:103], v[48:63]
    ds_read_b64_tr_b16 a[240:241], v240 offset:0
    ds_read_b64_tr_b16 a[242:243], v240 offset:512
    buffer_load_dwordx4 v123, s[44:47], s23 offen offset:1024 lds
    v_cvt_pk_bf16_f32 v16, v16, v17
    v_cvt_pk_bf16_f32 v17, v18, v19
    v_mfma_f32_32x32x16_bf16 v[48:63], a[216:219], a[104:107], v[48:63]
    ds_read_b64_tr_b16 a[244:245], v240 offset:2048
    ds_read_b64_tr_b16 a[246:247], v240 offset:2560
    v_cvt_pk_bf16_f32 v18, v20, v21
    v_cvt_pk_bf16_f32 v19, v22, v23
    buffer_store_dwordx4 v[16:19], v230, s[52:55], s80 offen offset:1024 sc1
    v_mfma_f32_32x32x16_bf16 v[48:63], a[220:223], a[108:111], v[48:63]
    ds_read_b64_tr_b16 a[248:249], v240 offset:4096
    ds_read_b64_tr_b16 a[250:251], v240 offset:4608
    v_max_f32 v32, 0, v32
    v_max_f32 v33, 0, v33
    v_max_f32_e64 v34, 0, v34
    s_waitcnt lgkmcnt(6)
    v_mfma_f32_32x32x16_bf16 v[48:63], a[224:227], a[112:115], v[48:63]
    ds_read_b64_tr_b16 a[252:253], v240 offset:6144
    ds_read_b64_tr_b16 a[254:255], v240 offset:6656
    s_add_u32 m0, s74, 0
    s_add_u32 s19, s78, 311296
    buffer_load_dwordx4 v233, s[44:47], s19 offen offset:0 lds
    v_max_f32 v35, 0, v35
    v_mfma_f32_32x32x16_bf16 v[48:63], a[228:231], a[116:119], v[48:63]
    ds_read_b64_tr_b16 a[208:209], v240 offset:8192
    ds_read_b64_tr_b16 a[210:211], v240 offset:8704
    v_max_f32 v36, 0, v36
    v_max_f32 v37, 0, v37
    v_max_f32 v38, 0, v38
    v_mfma_f32_32x32x16_bf16 v[48:63], a[232:235], a[120:123], v[48:63]
    ds_read_b64_tr_b16 a[212:213], v240 offset:10240
    ds_read_b64_tr_b16 a[214:215], v240 offset:10752
    s_add_u32 m0, s74, 102400
    s_nop 0
    buffer_load_dwordx4 v121, s[40:43], s85 offen offset:2048 lds
    s_waitcnt vmcnt(9)
    v_cvt_pk_bf16_f32 v148, v148, v149
    v_cvt_pk_bf16_f32 v149, v150, v151
    v_mfma_f32_32x32x16_bf16 v[48:63], a[236:239], a[124:127], v[48:63]
    ds_read_b64_tr_b16 a[216:217], v240 offset:12288
    ds_read_b64_tr_b16 a[218:219], v240 offset:12800
    ds_write_b64 v252, v[148:149] offset:0
    v_max_f32 v39, 0, v39
    v_mul_f32_e64 v32, v32, v40
    s_waitcnt lgkmcnt(7)
    v_mfma_f32_32x32x16_bf16 v[0:15], a[240:243], a[0:3], 0
    ds_read_b64_tr_b16 a[220:221], v240 offset:14336
    ds_read_b64_tr_b16 a[222:223], v240 offset:14848
    v_cvt_pk_bf16_f32 v152, v152, v153
    v_cvt_pk_bf16_f32 v153, v154, v155
    ds_write_b64 v252, v[152:153] offset:16384
    v_mul_f32 v33, v33, v41
    v_mfma_f32_32x32x16_bf16 v[0:15], a[244:247], a[4:7], v[0:15]
    ds_read_b64_tr_b16 a[224:225], v241 offset:0
    ds_read_b64_tr_b16 a[226:227], v241 offset:512
    buffer_load_dwordx4 v122, s[40:43], s85 offen offset:3072 lds
    s_waitcnt lgkmcnt(2)
    v_mul_f32_e64 v34, v34, v42
    v_mfma_f32_32x32x16_bf16 v[0:15], a[248:251], a[8:11], v[0:15]
    ds_read_b64_tr_b16 a[228:229], v241 offset:2048
    ds_read_b64_tr_b16 a[230:231], v241 offset:2560
    v_mul_f32 v35, v35, v43
    v_mul_f32 v36, v36, v44
    v_mul_f32 v37, v37, v45
    v_mul_f32 v38, v38, v46
    v_mfma_f32_32x32x16_bf16 v[0:15], a[252:255], a[12:15], v[0:15]
    ds_read_b64_tr_b16 a[232:233], v241 offset:4096
    ds_read_b64_tr_b16 a[234:235], v241 offset:4608
    s_add_u32 m0, s74, 0
    s_nop 0
    buffer_load_dwordx4 v123, s[44:47], s19 offen offset:1024 lds
    v_mul_f32_e64 v39, v39, v47
    v_cvt_pk_bf16_f32 v32, v32, v33
    v_mfma_f32_32x32x16_bf16 v[0:15], a[208:211], a[16:19], v[0:15]
    ds_read_b64_tr_b16 a[236:237], v241 offset:6144
    ds_read_b64_tr_b16 a[238:239], v241 offset:6656
    v_cvt_pk_bf16_f32 v33, v34, v35
    v_cvt_pk_bf16_f32 v34, v36, v37
    v_cvt_pk_bf16_f32 v35, v38, v39
    buffer_store_dwordx4 v[32:35], v230, s[52:55], s80 offen offset:2048 sc1
    v_max_f32 v48, 0, v48
    v_mfma_f32_32x32x16_bf16 v[0:15], a[212:215], a[20:23], v[0:15]
    ds_read_b64_tr_b16 a[240:241], v241 offset:8192
    ds_read_b64_tr_b16 a[242:243], v241 offset:8704
    v_max_f32 v49, 0, v49
    v_max_f32 v50, 0, v50
    v_max_f32 v51, 0, v51
    v_mfma_f32_32x32x16_bf16 v[0:15], a[216:219], a[24:27], v[0:15]
    ds_read_b64_tr_b16 a[244:245], v241 offset:10240
    ds_read_b64_tr_b16 a[246:247], v241 offset:10752
    buffer_load_dwordx4 v124, s[44:47], s19 offen offset:2048 lds
    v_max_f32 v52, 0, v52
    v_max_f32 v53, 0, v53
    v_max_f32_e64 v54, 0, v54
    v_mfma_f32_32x32x16_bf16 v[0:15], a[220:223], a[28:31], v[0:15]
    ds_read_b64_tr_b16 a[248:249], v241 offset:12288
    ds_read_b64_tr_b16 a[250:251], v241 offset:12800
    v_max_f32 v55, 0, v55
    v_mul_f32 v48, v48, v56
    v_mul_f32 v49, v49, v57
    s_waitcnt lgkmcnt(6)
    v_mfma_f32_32x32x16_bf16 v[16:31], a[224:227], a[0:3], 0
    ds_read_b64_tr_b16 a[252:253], v241 offset:14336
    ds_read_b64_tr_b16 a[254:255], v241 offset:14848
    buffer_load_dwordx4 v125, s[44:47], s19 offen offset:3072 lds
    v_mul_f32 v50, v50, v58
    v_mul_f32 v51, v51, v59
    v_mul_f32 v52, v52, v60
    v_mfma_f32_32x32x16_bf16 v[16:31], a[228:231], a[4:7], v[16:31]
    ds_read_b64_tr_b16 a[208:209], v242 offset:0
    ds_read_b64_tr_b16 a[210:211], v242 offset:512
    v_mul_f32 v53, v53, v61
    v_mul_f32 v54, v54, v62
    v_mul_f32 v55, v55, v63
    v_mfma_f32_32x32x16_bf16 v[16:31], a[232:235], a[8:11], v[16:31]
    ds_read_b64_tr_b16 a[212:213], v242 offset:2048
    ds_read_b64_tr_b16 a[214:215], v242 offset:2560
    s_add_u32 m0, s74, 4096
    s_add_u32 s19, s78, 344064
    buffer_load_dwordx4 v233, s[44:47], s19 offen offset:0 lds
    v_cvt_pk_bf16_f32 v48, v48, v49
    v_mfma_f32_32x32x16_bf16 v[16:31], a[236:239], a[12:15], v[16:31]
    ds_read_b64_tr_b16 a[216:217], v242 offset:4096
    ds_read_b64_tr_b16 a[218:219], v242 offset:4608
    v_cvt_pk_bf16_f32 v49, v50, v51
    v_cvt_pk_bf16_f32 v50, v52, v53
    v_cvt_pk_bf16_f32 v51, v54, v55
    s_waitcnt lgkmcnt(6)
    v_mfma_f32_32x32x16_bf16 v[16:31], a[240:243], a[16:19], v[16:31]
    ds_read_b64_tr_b16 a[220:221], v242 offset:6144
    ds_read_b64_tr_b16 a[222:223], v242 offset:6656
    buffer_load_dwordx4 v123, s[44:47], s19 offen offset:1024 lds
    buffer_store_dwordx4 v[48:51], v230, s[52:55], s80 offen offset:3072 sc1
    s_waitcnt vmcnt(11)
    ds_read_b64_tr_b16 v[96:97], v254 offset:0
    v_mfma_f32_32x32x16_bf16 v[16:31], a[244:247], a[20:23], v[16:31]
    ds_read_b64_tr_b16 a[224:225], v242 offset:8192
    ds_read_b64_tr_b16 a[226:227], v242 offset:8704
    ds_read_b64_tr_b16 v[98:99], v254 offset:1024
    v_mfma_f32_32x32x16_bf16 v[16:31], a[248:251], a[24:27], v[16:31]
    ds_read_b64_tr_b16 a[228:229], v242 offset:10240
    ds_read_b64_tr_b16 a[230:231], v242 offset:10752
    ds_read_b64_tr_b16 v[100:101], v255 offset:0
    ds_read_b64_tr_b16 v[102:103], v255 offset:1024
    v_mfma_f32_32x32x16_bf16 v[16:31], a[252:255], a[28:31], v[16:31]
    ds_read_b64_tr_b16 a[232:233], v242 offset:12288
    ds_read_b64_tr_b16 a[234:235], v242 offset:12800
    buffer_load_dwordx4 v124, s[44:47], s19 offen offset:2048 lds
    ds_read_b64_tr_b16 v[104:105], v254 offset:2048
    ds_read_b64_tr_b16 v[106:107], v254 offset:3072
    s_waitcnt vmcnt(8)
    s_barrier
    s_waitcnt lgkmcnt(12)
    v_mfma_f32_32x32x16_bf16 v[32:47], a[208:211], a[0:3], 0
    ds_read_b64_tr_b16 a[236:237], v242 offset:14336
    ds_read_b64_tr_b16 a[238:239], v242 offset:14848
    ds_read_b128 a[160:163], v253 offset:0
    ds_read_b128 a[164:167], v253 offset:8192
    ds_read_b128 a[168:171], v253 offset:16384
    ds_read_b128 a[172:175], v253 offset:24576
    v_mfma_f32_32x32x16_bf16 v[32:47], a[212:215], a[4:7], v[32:47]
    ds_read_b64_tr_b16 a[240:241], v243 offset:0
    ds_read_b64_tr_b16 a[242:243], v243 offset:512
    s_add_u32 m0, s74, 32768
    s_add_u32 s85, s28, s75
    buffer_load_dwordx4 v231, s[40:43], s85 offen offset:0 lds
    v_mfma_f32_32x32x16_bf16 v[32:47], a[216:219], a[8:11], v[32:47]
    ds_read_b64_tr_b16 a[244:245], v243 offset:2048
    ds_read_b64_tr_b16 a[246:247], v243 offset:2560
    v_mfma_f32_32x32x16_bf16 v[32:47], a[220:223], a[12:15], v[32:47]
    ds_read_b64_tr_b16 a[248:249], v243 offset:4096
    ds_read_b64_tr_b16 a[250:251], v243 offset:4608
    s_waitcnt lgkmcnt(6)
    v_mfma_f32_32x32x16_bf16 v[128:143], a[160:163], v[192:195], 0
    v_mfma_f32_32x32x16_bf16 v[32:47], a[224:227], a[16:19], v[32:47]
    s_nop 0
    ds_read_b64_tr_b16 a[252:253], v243 offset:6144
    ds_read_b64_tr_b16 a[254:255], v243 offset:6656
    buffer_load_dwordx4 v120, s[40:43], s85 offen offset:1024 lds
    v_mfma_f32_32x32x16_bf16 v[144:159], a[168:171], v[200:203], 0
    v_mfma_f32_32x32x16_bf16 v[32:47], a[228:231], a[20:23], v[32:47]
    ds_read_b64_tr_b16 a[208:209], v243 offset:8192
    ds_read_b64_tr_b16 a[210:211], v243 offset:8704
    v_mfma_f32_32x32x16_bf16 v[128:143], a[164:167], v[196:199], v[128:143]
    v_mfma_f32_32x32x16_bf16 v[32:47], a[232:235], a[24:27], v[32:47]
    ds_read_b64_tr_b16 a[212:213], v243 offset:10240
    ds_read_b64_tr_b16 a[214:215], v243 offset:10752
    v_mfma_f32_32x32x16_bf16 v[144:159], a[172:175], v[204:207], v[144:159]
    v_mfma_f32_32x32x16_bf16 v[32:47], a[236:239], a[28:31], v[32:47]
    ds_read_b64_tr_b16 a[216:217], v243 offset:12288
    ds_read_b64_tr_b16 a[218:219], v243 offset:12800
    buffer_load_dwordx4 v121, s[40:43], s85 offen offset:2048 lds
    ds_read_b64_tr_b16 v[108:109], v255 offset:2048
    ds_read_b64_tr_b16 v[110:111], v255 offset:3072
    s_waitcnt lgkmcnt(8)
    v_mfma_f32_32x32x16_bf16 v[48:63], a[240:243], a[0:3], 0
    ds_read_b64_tr_b16 a[220:221], v243 offset:14336
    ds_read_b64_tr_b16 a[222:223], v243 offset:14848
    v_mfma_f32_32x32x16_bf16 v[48:63], a[244:247], a[4:7], v[48:63]
    ds_read_b64_tr_b16 a[224:225], v240 offset:32768
    s_nop 0
    ds_read_b64_tr_b16 a[226:227], v240 offset:33280
    buffer_load_dwordx4 v122, s[40:43], s85 offen offset:3072 lds
    v_add_f32 v136, 0x358637bd, v136
    ds_read_b64_tr_b16 v[112:113], v254 offset:4096
    v_mfma_f32_32x32x16_bf16 v[48:63], a[248:251], a[8:11], v[48:63]
    ds_read_b64_tr_b16 a[228:229], v241 offset:32768
    ds_read_b64_tr_b16 a[230:231], v241 offset:33280
    v_rcp_f32_e64 v136, v136
    v_add_f32 v152, 0x358637bd, v152
    ds_read_b64_tr_b16 v[114:115], v254 offset:5120
    v_mfma_f32_32x32x16_bf16 v[48:63], a[252:255], a[12:15], v[48:63]
    ds_read_b64_tr_b16 a[232:233], v242 offset:32768
    ds_read_b64_tr_b16 a[234:235], v242 offset:33280
    s_add_u32 m0, s74, 36864
    s_add_u32 s85, s28, s75
    s_add_u32 s85, s85, 114688
    buffer_load_dwordx4 v231, s[40:43], s85 offen offset:0 lds
    s_waitcnt lgkmcnt(8)
    v_mfma_f32_32x32x16_bf16 v[48:63], a[208:211], a[16:19], v[48:63]
    ds_read_b64_tr_b16 a[236:237], v243 offset:32768
    ds_read_b64_tr_b16 a[238:239], v243 offset:33280
    v_rcp_f32 v152, v152
    v_mul_f32 v128, v128, v136
    v_mul_f32_e64 v129, v129, v136
    v_mfma_f32_32x32x16_bf16 v[48:63], a[212:215], a[20:23], v[48:63]
    ds_read_b64_tr_b16 a[240:241], v240 offset:34816
    ds_read_b64_tr_b16 a[242:243], v240 offset:35328
    buffer_load_dwordx4 v120, s[40:43], s85 offen offset:1024 lds
    v_mul_f32 v130, v130, v136
    v_mul_f32 v131, v131, v136
    v_mfma_f32_32x32x16_bf16 v[48:63], a[216:219], a[24:27], v[48:63]
    ds_read_b64_tr_b16 a[244:245], v241 offset:34816
    ds_read_b64_tr_b16 a[246:247], v241 offset:35328
    v_mul_f32_e64 v132, v132, v136
    v_mul_f32_e64 v133, v133, v136
    v_mul_f32_e64 v134, v134, v136
    v_mul_f32 v135, v135, v136
    v_mfma_f32_32x32x16_bf16 v[48:63], a[220:223], a[28:31], v[48:63]
    ds_read_b64_tr_b16 a[248:249], v242 offset:34816
    ds_read_b64_tr_b16 a[250:251], v242 offset:35328
    buffer_load_dwordx4 v121, s[40:43], s85 offen offset:2048 lds
    v_cvt_pk_bf16_f32 v128, v128, v129
    v_cvt_pk_bf16_f32 v129, v130, v131
    s_waitcnt lgkmcnt(6)
    v_mfma_f32_32x32x16_bf16 v[0:15], a[224:227], a[32:35], v[0:15]
    ds_read_b64_tr_b16 a[252:253], v243 offset:34816
    ds_read_b64_tr_b16 a[254:255], v243 offset:35328
    v_cvt_pk_bf16_f32 v130, v132, v133
    v_cvt_pk_bf16_f32 v131, v134, v135
    buffer_store_dwordx4 v[128:131], v230, s[52:55], s18 offen offset:0 sc1
    v_mul_f32_e64 v144, v144, v152
    v_mfma_f32_32x32x16_bf16 v[16:31], a[228:231], a[32:35], v[16:31]
    ds_read_b64_tr_b16 a[208:209], v240 offset:36864
    ds_read_b64_tr_b16 a[210:211], v240 offset:37376
    v_mul_f32 v145, v145, v152
    v_mul_f32 v146, v146, v152
    v_mul_f32 v147, v147, v152
    v_mfma_f32_32x32x16_bf16 v[32:47], a[232:235], a[32:35], v[32:47]
    ds_read_b64_tr_b16 a[212:213], v241 offset:36864
    ds_read_b64_tr_b16 a[214:215], v241 offset:37376
    buffer_load_dwordx4 v122, s[40:43], s85 offen offset:3072 lds
    v_mul_f32 v148, v148, v152
    v_mul_f32 v149, v149, v152
    v_mul_f32 v150, v150, v152
    v_mfma_f32_32x32x16_bf16 v[48:63], a[236:239], a[32:35], v[48:63]
    ds_read_b64_tr_b16 a[216:217], v242 offset:36864
    ds_read_b64_tr_b16 a[218:219], v242 offset:37376
    v_mul_f32 v151, v151, v152
    v_cvt_pk_bf16_f32 v144, v144, v145
    v_cvt_pk_bf16_f32 v145, v146, v147
    s_waitcnt lgkmcnt(6)
    v_mfma_f32_32x32x16_bf16 v[0:15], a[240:243], a[36:39], v[0:15]
    ds_read_b64_tr_b16 a[220:221], v243 offset:36864
    ds_read_b64_tr_b16 a[222:223], v243 offset:37376
    s_add_u32 m0, s74, 4096
    s_nop 0
    buffer_load_dwordx4 v125, s[44:47], s19 offen offset:3072 lds
    v_cvt_pk_bf16_f32 v146, v148, v149
    v_cvt_pk_bf16_f32 v147, v150, v151
    buffer_store_dwordx4 v[144:147], v230, s[52:55], s18 offen offset:1024 sc1
    s_nop 0
    v_mfma_f32_32x32x16_bf16 v[16:31], a[244:247], a[36:39], v[16:31]
    ds_read_b64_tr_b16 a[224:225], v240 offset:38912
    ds_read_b64_tr_b16 a[226:227], v240 offset:39424
    v_mfma_f32_32x32x16_bf16 v[32:47], a[248:251], a[36:39], v[32:47]
    ds_read_b64_tr_b16 a[228:229], v241 offset:38912
    ds_read_b64_tr_b16 a[230:231], v241 offset:39424
    ds_read_b64_tr_b16 v[116:117], v255 offset:4096
    ds_read_b64_tr_b16 v[118:119], v255 offset:5120
    v_mfma_f32_32x32x16_bf16 v[48:63], a[252:255], a[36:39], v[48:63]
    ds_read_b64_tr_b16 a[232:233], v242 offset:38912
    ds_read_b64_tr_b16 a[234:235], v242 offset:39424
    s_waitcnt lgkmcnt(8)
    v_mfma_f32_32x32x16_bf16 v[0:15], a[208:211], a[40:43], v[0:15]
    ds_read_b64_tr_b16 a[236:237], v243 offset:38912
    ds_read_b64_tr_b16 a[238:239], v243 offset:39424
    s_waitcnt lgkmcnt(4)
    s_add_u32 m0, s74, 131072
    s_add_u32 s23, s79, 49152
    buffer_load_dwordx4 v233, s[48:51], s23 offen offset:0 lds
    v_mfma_f32_32x32x16_bf16 v[16:31], a[212:215], a[40:43], v[16:31]
    ds_read_b64_tr_b16 a[240:241], v240 offset:40960
    ds_read_b64_tr_b16 a[242:243], v240 offset:41472
    v_mfma_f32_32x32x16_bf16 v[32:47], a[216:219], a[40:43], v[32:47]
    ds_read_b64_tr_b16 a[244:245], v241 offset:40960
    ds_read_b64_tr_b16 a[246:247], v241 offset:41472
    buffer_load_dwordx4 v123, s[48:51], s23 offen offset:1024 lds
    v_mfma_f32_32x32x16_bf16 v[48:63], a[220:223], a[40:43], v[48:63]
    ds_read_b64_tr_b16 a[248:249], v242 offset:40960
    ds_read_b64_tr_b16 a[250:251], v242 offset:41472
    s_waitcnt lgkmcnt(6)
    v_mfma_f32_32x32x16_bf16 v[0:15], a[224:227], a[44:47], v[0:15]
    ds_read_b64_tr_b16 a[252:253], v243 offset:40960
    ds_read_b64_tr_b16 a[254:255], v243 offset:41472
    s_nop 0
    buffer_load_dwordx4 v124, s[48:51], s23 offen offset:2048 lds
    v_mfma_f32_32x32x16_bf16 v[16:31], a[228:231], a[44:47], v[16:31]
    ds_read_b64_tr_b16 a[208:209], v240 offset:43008
    ds_read_b64_tr_b16 a[210:211], v240 offset:43520
    v_mfma_f32_32x32x16_bf16 v[32:47], a[232:235], a[44:47], v[32:47]
    ds_read_b64_tr_b16 a[212:213], v241 offset:43008
    ds_read_b64_tr_b16 a[214:215], v241 offset:43520
    buffer_load_dwordx4 v125, s[48:51], s23 offen offset:3072 lds
    v_mov_b32_e64 v228, s68
    s_waitcnt vmcnt(16)
    buffer_store_dword v228, off, s[52:55], s14 sc1
    v_mfma_f32_32x32x16_bf16 v[48:63], a[236:239], a[44:47], v[48:63]
    ds_read_b64_tr_b16 a[216:217], v242 offset:43008
    ds_read_b64_tr_b16 a[218:219], v242 offset:43520
    s_waitcnt vmcnt(7)
    s_barrier
    s_waitcnt lgkmcnt(6)
    v_mfma_f32_32x32x16_bf16 v[0:15], a[240:243], a[48:51], v[0:15]
    ds_read_b64_tr_b16 a[220:221], v243 offset:43008
    ds_read_b64_tr_b16 a[222:223], v243 offset:43520
    v_mfma_f32_32x32x16_bf16 v[16:31], a[244:247], a[48:51], v[16:31]
    ds_read_b64_tr_b16 a[224:225], v240 offset:45056
    ds_read_b64_tr_b16 a[226:227], v240 offset:45568
    s_add_u32 m0, s74, 65536
    s_add_u32 s85, s29, s75
    buffer_load_dwordx4 v231, s[40:43], s85 offen offset:0 lds
    v_mfma_f32_32x32x16_bf16 v[32:47], a[248:251], a[48:51], v[32:47]
    ds_read_b64_tr_b16 a[228:229], v241 offset:45056
    ds_read_b64_tr_b16 a[230:231], v241 offset:45568
    v_mfma_f32_32x32x16_bf16 v[48:63], a[252:255], a[48:51], v[48:63]
    ds_read_b64_tr_b16 a[232:233], v242 offset:45056
    ds_read_b64_tr_b16 a[234:235], v242 offset:45568
    s_waitcnt lgkmcnt(6)
    v_mfma_f32_32x32x16_bf16 v[0:15], a[208:211], a[52:55], v[0:15]
    ds_read_b64_tr_b16 a[236:237], v243 offset:45056
    ds_read_b64_tr_b16 a[238:239], v243 offset:45568
    v_lshlrev_b32 v224, 6, v230
    v_min_u32 v224, 13312, v224
    s_and_b32 s70, s30, 3
    s_lshl2_add_u32 s70, s31, s70
    s_lshl2_add_u32 s70, s70, s3
    s_mul_i32 s70, s70, 14336
    buffer_load_dword v225, v224, s[44:47], s70 offen offset:384
    v_mfma_f32_32x32x16_bf16 v[16:31], a[212:215], a[52:55], v[16:31]
    ds_read_b64_tr_b16 a[240:241], v240 offset:47104
    ds_read_b64_tr_b16 a[242:243], v240 offset:47616
    v_mfma_f32_32x32x16_bf16 v[32:47], a[216:219], a[52:55], v[32:47]
    ds_read_b64_tr_b16 a[244:245], v241 offset:47104
    ds_read_b64_tr_b16 a[246:247], v241 offset:47616
    s_waitcnt vmcnt(8)
    ds_read_b64_tr_b16 a[176:177], v248 offset:0
    ds_read_b64_tr_b16 a[178:179], v248 offset:1024
    v_mfma_f32_32x32x16_bf16 v[48:63], a[220:223], a[52:55], v[48:63]
    s_nop 0
    ds_read_b64_tr_b16 a[248:249], v242 offset:47104
    ds_read_b64_tr_b16 a[250:251], v242 offset:47616
    ds_read_b64_tr_b16 a[180:181], v249 offset:0
    ds_read_b64_tr_b16 a[182:183], v249 offset:1024
    s_waitcnt lgkmcnt(10)
    v_mfma_f32_32x32x16_bf16 v[0:15], a[224:227], a[56:59], v[0:15]
    ds_read_b64_tr_b16 a[252:253], v243 offset:47104
    ds_read_b64_tr_b16 a[254:255], v243 offset:47616
    s_nop 0
    buffer_load_dwordx4 v120, s[40:43], s85 offen offset:1024 lds
    ds_read_b64_tr_b16 a[184:185], v248 offset:2048
    ds_read_b64_tr_b16 a[186:187], v248 offset:3072
    v_mfma_f32_32x32x16_bf16 v[16:31], a[228:231], a[56:59], v[16:31]
    ds_read_b64_tr_b16 a[208:209], v236 offset:32768
    ds_read_b64_tr_b16 a[210:211], v236 offset:33280
    ds_read_b64_tr_b16 a[188:189], v249 offset:2048
    ds_read_b64_tr_b16 a[190:191], v249 offset:3072
    v_mfma_f32_32x32x16_bf16 v[32:47], a[232:235], a[56:59], v[32:47]
    ds_read_b64_tr_b16 a[212:213], v237 offset:32768
    ds_read_b64_tr_b16 a[214:215], v237 offset:33280
    buffer_load_dwordx4 v121, s[40:43], s85 offen offset:2048 lds
    ds_read_b64_tr_b16 a[192:193], v248 offset:4096
    ds_read_b64_tr_b16 a[194:195], v248 offset:5120
    v_mfma_f32_32x32x16_bf16 v[48:63], a[236:239], a[56:59], v[48:63]
    ds_read_b64_tr_b16 a[216:217], v238 offset:32768
    ds_read_b64_tr_b16 a[218:219], v238 offset:33280
    ds_read_b64_tr_b16 a[196:197], v249 offset:4096
    ds_read_b64_tr_b16 a[198:199], v249 offset:5120
    s_waitcnt lgkmcnt(14)
    v_mfma_f32_32x32x16_bf16 v[0:15], a[240:243], a[60:63], v[0:15]
    ds_read_b64_tr_b16 a[220:221], v239 offset:32768
    ds_read_b64_tr_b16 a[222:223], v239 offset:33280
    buffer_load_dwordx4 v122, s[40:43], s85 offen offset:3072 lds
    s_nop 0
    ds_read_b64_tr_b16 a[200:201], v248 offset:6144
    ds_read_b64_tr_b16 a[202:203], v248 offset:7168
    v_mfma_f32_32x32x16_bf16 v[16:31], a[244:247], a[60:63], v[16:31]
    ds_read_b64_tr_b16 a[224:225], v236 offset:34816
    ds_read_b64_tr_b16 a[226:227], v236 offset:35328
    ds_read_b64_tr_b16 a[204:205], v249 offset:6144
    ds_read_b64_tr_b16 a[206:207], v249 offset:7168
    v_mfma_f32_32x32x16_bf16 v[32:47], a[248:251], a[60:63], v[32:47]
    ds_read_b64_tr_b16 a[228:229], v237 offset:34816
    ds_read_b64_tr_b16 a[230:231], v237 offset:35328
    s_add_u32 m0, s74, 69632
    s_add_u32 s85, s29, s75
    s_add_u32 s85, s85, 114688
    buffer_load_dwordx4 v231, s[40:43], s85 offen offset:0 lds
    v_mfma_f32_32x32x16_bf16 v[48:63], a[252:255], a[60:63], v[48:63]
    ds_read_b64_tr_b16 a[232:233], v238 offset:34816
    ds_read_b64_tr_b16 a[234:235], v238 offset:35328
    s_waitcnt lgkmcnt(4)
    v_mfma_f32_32x32x16_bf16 v[0:15], a[208:211], a[64:67], v[0:15]
    ds_read_b64_tr_b16 a[236:237], v239 offset:34816
    ds_read_b64_tr_b16 a[238:239], v239 offset:35328
    buffer_load_dwordx4 v120, s[40:43], s85 offen offset:1024 lds
    v_mfma_f32_32x32x16_bf16 v[16:31], a[212:215], a[64:67], v[16:31]
    ds_read_b64_tr_b16 a[240:241], v236 offset:36864
    ds_read_b64_tr_b16 a[242:243], v236 offset:37376
    v_mfma_f32_32x32x16_bf16 v[32:47], a[216:219], a[64:67], v[32:47]
    ds_read_b64_tr_b16 a[244:245], v237 offset:36864
    ds_read_b64_tr_b16 a[246:247], v237 offset:37376
    buffer_load_dwordx4 v121, s[40:43], s85 offen offset:2048 lds
    v_mfma_f32_32x32x16_bf16 v[48:63], a[220:223], a[64:67], v[48:63]
    ds_read_b64_tr_b16 a[248:249], v238 offset:36864
    ds_read_b64_tr_b16 a[250:251], v238 offset:37376
    s_waitcnt lgkmcnt(6)
    s_nop 0
    v_mfma_f32_32x32x16_bf16 v[0:15], a[224:227], a[68:71], v[0:15]
    ds_read_b64_tr_b16 a[252:253], v239 offset:36864
    ds_read_b64_tr_b16 a[254:255], v239 offset:37376
    buffer_load_dwordx4 v122, s[40:43], s85 offen offset:3072 lds
    v_mfma_f32_32x32x16_bf16 v[16:31], a[228:231], a[68:71], v[16:31]
    ds_read_b64_tr_b16 a[208:209], v236 offset:38912
    ds_read_b64_tr_b16 a[210:211], v236 offset:39424
    v_mfma_f32_32x32x16_bf16 v[32:47], a[232:235], a[68:71], v[32:47]
    ds_read_b64_tr_b16 a[212:213], v237 offset:38912
    ds_read_b64_tr_b16 a[214:215], v237 offset:39424
    s_add_u32 m0, s74, 135168
    s_add_u32 s23, s79, 81920
    buffer_load_dwordx4 v233, s[48:51], s23 offen offset:0 lds
    v_mfma_f32_32x32x16_bf16 v[48:63], a[236:239], a[68:71], v[48:63]
    ds_read_b64_tr_b16 a[216:217], v238 offset:38912
    s_nop 0
    ds_read_b64_tr_b16 a[218:219], v238 offset:39424
    s_waitcnt lgkmcnt(6)
    v_mfma_f32_32x32x16_bf16 v[0:15], a[240:243], a[72:75], v[0:15]
    ds_read_b64_tr_b16 a[220:221], v239 offset:38912
    ds_read_b64_tr_b16 a[222:223], v239 offset:39424
    buffer_load_dwordx4 v123, s[48:51], s23 offen offset:1024 lds
    v_mfma_f32_32x32x16_bf16 v[16:31], a[244:247], a[72:75], v[16:31]
    ds_read_b64_tr_b16 a[224:225], v236 offset:40960
    ds_read_b64_tr_b16 a[226:227], v236 offset:41472
    v_mfma_f32_32x32x16_bf16 v[32:47], a[248:251], a[72:75], v[32:47]
    ds_read_b64_tr_b16 a[228:229], v237 offset:40960
    ds_read_b64_tr_b16 a[230:231], v237 offset:41472
    s_add_u32 m0, s74, 0
    s_add_u32 s19, s78, 376832
    buffer_load_dwordx4 v233, s[44:47], s19 offen offset:0 lds
    v_mfma_f32_32x32x16_bf16 v[48:63], a[252:255], a[72:75], v[48:63]
    ds_read_b64_tr_b16 a[232:233], v238 offset:40960
    ds_read_b64_tr_b16 a[234:235], v238 offset:41472
    s_waitcnt lgkmcnt(6)
    v_mfma_f32_32x32x16_bf16 v[0:15], a[208:211], a[76:79], v[0:15]
    ds_read_b64_tr_b16 a[236:237], v239 offset:40960
    ds_read_b64_tr_b16 a[238:239], v239 offset:41472
    buffer_load_dwordx4 v123, s[44:47], s19 offen offset:1024 lds
    v_mfma_f32_32x32x16_bf16 v[16:31], a[212:215], a[76:79], v[16:31]
    ds_read_b64_tr_b16 a[240:241], v236 offset:43008
    ds_read_b64_tr_b16 a[242:243], v236 offset:43520
    v_mfma_f32_32x32x16_bf16 v[32:47], a[216:219], a[76:79], v[32:47]
    ds_read_b64_tr_b16 a[244:245], v237 offset:43008
    ds_read_b64_tr_b16 a[246:247], v237 offset:43520
    s_add_u32 s19, s79, 0
    s_add_u32 m0, s74, 2048
    s_nop 0
    buffer_load_dwordx4 v233, s[48:51], s19 offen offset:0 lds
    v_mov_b32 v228, s68
    s_waitcnt vmcnt(19)
    buffer_store_dword v228, off, s[52:55], s24 sc1
    v_mfma_f32_32x32x16_bf16 v[48:63], a[220:223], a[76:79], v[48:63]
    ds_read_b64_tr_b16 a[248:249], v238 offset:43008
    ds_read_b64_tr_b16 a[250:251], v238 offset:43520
    s_waitcnt vmcnt(6)
    s_barrier
    s_waitcnt lgkmcnt(6)
    v_mfma_f32_32x32x16_bf16 v[0:15], a[224:227], a[80:83], v[0:15]
    ds_read_b64_tr_b16 a[252:253], v239 offset:43008
    ds_read_b64_tr_b16 a[254:255], v239 offset:43520
    s_nop 0
    v_mfma_f32_32x32x16_bf16 v[16:31], a[228:231], a[80:83], v[16:31]
    ds_read_b64_tr_b16 a[208:209], v236 offset:45056
    ds_read_b64_tr_b16 a[210:211], v236 offset:45568
    buffer_load_dwordx4 v123, s[48:51], s19 offen offset:1024 lds
    v_mfma_f32_32x32x16_bf16 v[32:47], a[232:235], a[80:83], v[32:47]
    ds_read_b64_tr_b16 a[212:213], v237 offset:45056
    ds_read_b64_tr_b16 a[214:215], v237 offset:45568
    v_mfma_f32_32x32x16_bf16 v[48:63], a[236:239], a[80:83], v[48:63]
    ds_read_b64_tr_b16 a[216:217], v238 offset:45056
    ds_read_b64_tr_b16 a[218:219], v238 offset:45568
    s_add_u32 m0, s74, 4096
    s_add_u32 s19, s79, 16384
    buffer_load_dwordx4 v233, s[48:51], s19 offen offset:0 lds
    s_waitcnt lgkmcnt(6)
    v_mfma_f32_32x32x16_bf16 v[0:15], a[240:243], a[84:87], v[0:15]
    ds_read_b64_tr_b16 a[220:221], v239 offset:45056
    s_nop 0
    ds_read_b64_tr_b16 a[222:223], v239 offset:45568
    v_mfma_f32_32x32x16_bf16 v[16:31], a[244:247], a[84:87], v[16:31]
    ds_read_b64_tr_b16 a[224:225], v236 offset:47104
    ds_read_b64_tr_b16 a[226:227], v236 offset:47616
    buffer_load_dwordx4 v123, s[48:51], s19 offen offset:1024 lds
    v_mfma_f32_32x32x16_bf16 v[32:47], a[248:251], a[84:87], v[32:47]
    ds_read_b64_tr_b16 a[228:229], v237 offset:47104
    ds_read_b64_tr_b16 a[230:231], v237 offset:47616
    v_mfma_f32_32x32x16_bf16 v[48:63], a[252:255], a[84:87], v[48:63]
    ds_read_b64_tr_b16 a[232:233], v238 offset:47104
    ds_read_b64_tr_b16 a[234:235], v238 offset:47616
    buffer_load_dwordx4 v124, s[48:51], s19 offen offset:2048 lds
    s_waitcnt lgkmcnt(6)
    v_mfma_f32_32x32x16_bf16 v[0:15], a[208:211], a[88:91], v[0:15]
    ds_read_b64_tr_b16 a[236:237], v239 offset:47104
    ds_read_b64_tr_b16 a[238:239], v239 offset:47616
    s_nop 0
    v_mfma_f32_32x32x16_bf16 v[16:31], a[212:215], a[88:91], v[16:31]
    ds_read_b64_tr_b16 a[240:241], v240 offset:0
    ds_read_b64_tr_b16 a[242:243], v240 offset:512
    buffer_load_dwordx4 v125, s[48:51], s19 offen offset:3072 lds
    v_mfma_f32_32x32x16_bf16 v[32:47], a[216:219], a[88:91], v[32:47]
    ds_read_b64_tr_b16 a[244:245], v240 offset:2048
    ds_read_b64_tr_b16 a[246:247], v240 offset:2560
    v_mfma_f32_32x32x16_bf16 v[48:63], a[220:223], a[88:91], v[48:63]
    ds_read_b64_tr_b16 a[248:249], v240 offset:4096
    ds_read_b64_tr_b16 a[250:251], v240 offset:4608
    s_add_u32 m0, s74, 98304
    s_add_u32 s0, s79, 98304
    buffer_load_dwordx4 v233, s[48:51], s0 offen offset:0 lds
    s_waitcnt lgkmcnt(6)
    v_mfma_f32_32x32x16_bf16 v[0:15], a[224:227], a[92:95], v[0:15]
    ds_read_b64_tr_b16 a[252:253], v240 offset:6144
    s_nop 0
    ds_read_b64_tr_b16 a[254:255], v240 offset:6656
    v_mfma_f32_32x32x16_bf16 v[16:31], a[228:231], a[92:95], v[16:31]
    ds_read_b64_tr_b16 a[208:209], v240 offset:8192
    ds_read_b64_tr_b16 a[210:211], v240 offset:8704
    v_mfma_f32_32x32x16_bf16 v[32:47], a[232:235], a[92:95], v[32:47]
    ds_read_b64_tr_b16 a[212:213], v240 offset:10240
    ds_read_b64_tr_b16 a[214:215], v240 offset:10752
    buffer_load_dwordx4 v123, s[48:51], s0 offen offset:1024 lds
    v_mfma_f32_32x32x16_bf16 v[48:63], a[236:239], a[92:95], v[48:63]
    ds_read_b64_tr_b16 a[216:217], v240 offset:12288
    ds_read_b64_tr_b16 a[218:219], v240 offset:12800
    s_waitcnt lgkmcnt(6)
    v_mfma_f32_32x32x16_bf16 v[0:15], a[240:243], a[96:99], v[0:15]
    ds_read_b64_tr_b16 a[220:221], v240 offset:14336
    ds_read_b64_tr_b16 a[222:223], v240 offset:14848
    v_mfma_f32_32x32x16_bf16 v[0:15], a[244:247], a[100:103], v[0:15]
    s_nop 0
    ds_read_b64_tr_b16 a[224:225], v241 offset:0
    ds_read_b64_tr_b16 a[226:227], v241 offset:512
    buffer_load_dwordx4 v124, s[48:51], s0 offen offset:2048 lds
    v_mfma_f32_32x32x16_bf16 v[0:15], a[248:251], a[104:107], v[0:15]
    ds_read_b64_tr_b16 a[228:229], v241 offset:2048
    ds_read_b64_tr_b16 a[230:231], v241 offset:2560
    s_load_dwordx8 s[60:67], s[52:53], s8 glc
    v_mfma_f32_32x32x16_bf16 v[0:15], a[252:255], a[108:111], v[0:15]
    ds_read_b64_tr_b16 a[232:233], v241 offset:4096
    ds_read_b64_tr_b16 a[234:235], v241 offset:4608
    s_waitcnt lgkmcnt(6)
    v_mfma_f32_32x32x16_bf16 v[0:15], a[208:211], a[112:115], v[0:15]
    ds_read_b64_tr_b16 a[236:237], v241 offset:6144
    ds_read_b64_tr_b16 a[238:239], v241 offset:6656
    buffer_load_dwordx4 v125, s[48:51], s0 offen offset:3072 lds
    v_mfma_f32_32x32x16_bf16 v[0:15], a[212:215], a[116:119], v[0:15]
    s_nop 0
    ds_read_b64_tr_b16 a[240:241], v241 offset:8192
    ds_read_b64_tr_b16 a[242:243], v241 offset:8704
    v_mfma_f32_32x32x16_bf16 v[0:15], a[216:219], a[120:123], v[0:15]
    ds_read_b64_tr_b16 a[244:245], v241 offset:10240
    ds_read_b64_tr_b16 a[246:247], v241 offset:10752
    v_mfma_f32_32x32x16_bf16 v[0:15], a[220:223], a[124:127], v[0:15]
    ds_read_b64_tr_b16 a[248:249], v241 offset:12288
    ds_read_b64_tr_b16 a[250:251], v241 offset:12800
    s_add_u32 m0, s74, 102400
    s_add_u32 s0, s78, 196608
    buffer_load_dwordx4 v233, s[44:47], s0 offen offset:0 lds
    s_waitcnt lgkmcnt(6)
    v_mfma_f32_32x32x16_bf16 v[16:31], a[224:227], a[96:99], v[16:31]
    ds_read_b64_tr_b16 a[252:253], v241 offset:14336
    ds_read_b64_tr_b16 a[254:255], v241 offset:14848
    v_mfma_f32_32x32x16_bf16 v[16:31], a[228:231], a[100:103], v[16:31]
    s_nop 0
    ds_read_b64_tr_b16 a[208:209], v242 offset:0
    ds_read_b64_tr_b16 a[210:211], v242 offset:512
    v_mfma_f32_32x32x16_bf16 v[16:31], a[232:235], a[104:107], v[16:31]
    ds_read_b64_tr_b16 a[212:213], v242 offset:2048
    ds_read_b64_tr_b16 a[214:215], v242 offset:2560
    buffer_load_dwordx4 v123, s[44:47], s0 offen offset:1024 lds
    v_mfma_f32_32x32x16_bf16 v[16:31], a[236:239], a[108:111], v[16:31]
    ds_read_b64_tr_b16 a[216:217], v242 offset:4096
    ds_read_b64_tr_b16 a[218:219], v242 offset:4608
    v_max_f32 v0, 0, v0
    v_max_f32 v1, 0, v1
    v_max_f32 v2, 0, v2
    s_waitcnt lgkmcnt(6)
    v_mfma_f32_32x32x16_bf16 v[16:31], a[240:243], a[112:115], v[16:31]
    ds_read_b64_tr_b16 a[220:221], v242 offset:6144
    ds_read_b64_tr_b16 a[222:223], v242 offset:6656
    v_max_f32 v3, 0, v3
    v_max_f32 v4, 0, v4
    v_max_f32 v5, 0, v5
    v_max_f32 v6, 0, v6
    v_mfma_f32_32x32x16_bf16 v[16:31], a[244:247], a[116:119], v[16:31]
    ds_read_b64_tr_b16 a[224:225], v242 offset:8192
    ds_read_b64_tr_b16 a[226:227], v242 offset:8704
    buffer_load_dwordx4 v124, s[44:47], s0 offen offset:2048 lds
    v_max_f32 v7, 0, v7
    v_mul_f32 v0, v0, v8
    v_mfma_f32_32x32x16_bf16 v[16:31], a[248:251], a[120:123], v[16:31]
    ds_read_b64_tr_b16 a[228:229], v242 offset:10240
    ds_read_b64_tr_b16 a[230:231], v242 offset:10752
    v_mul_f32 v1, v1, v9
    v_mul_f32 v2, v2, v10
    v_mul_f32 v3, v3, v11
    v_mul_f32 v4, v4, v12
    v_mfma_f32_32x32x16_bf16 v[16:31], a[252:255], a[124:127], v[16:31]
    ds_read_b64_tr_b16 a[232:233], v242 offset:12288
    ds_read_b64_tr_b16 a[234:235], v242 offset:12800
    v_mul_f32 v5, v5, v13
    v_mul_f32 v6, v6, v14
    v_mul_f32_e64 v7, v7, v15
    s_barrier
    s_waitcnt lgkmcnt(6)
    v_mfma_f32_32x32x16_bf16 v[32:47], a[208:211], a[96:99], v[32:47]
    ds_read_b64_tr_b16 a[236:237], v242 offset:14336
    ds_read_b64_tr_b16 a[238:239], v242 offset:14848
    buffer_load_dwordx4 v125, s[44:47], s0 offen offset:3072 lds
    v_cvt_pk_bf16_f32 v0, v0, v1
    v_cvt_pk_bf16_f32 v1, v2, v3
    v_cvt_pk_bf16_f32 v2, v4, v5
    v_mfma_f32_32x32x16_bf16 v[32:47], a[212:215], a[100:103], v[32:47]
    ds_read_b64_tr_b16 a[240:241], v243 offset:0
    ds_read_b64_tr_b16 a[242:243], v243 offset:512
    v_cvt_pk_bf16_f32 v3, v6, v7
    buffer_store_dwordx4 v[0:3], v230, s[52:55], s81 offen offset:0 sc1
    s_mov_b32 s7, 0
L_sck_9:
    s_waitcnt lgkmcnt(0)
    s_cmp_eq_u64 s[60:61], s[86:87]
    s_cbranch_scc0 L_slp_8
    s_cmp_eq_u64 s[62:63], s[86:87]
    s_cbranch_scc0 L_slp_8
    s_cmp_eq_u64 s[64:65], s[86:87]
    s_cbranch_scc0 L_slp_8
    s_cmp_eq_u64 s[66:67], s[86:87]
    s_cbranch_scc1 L_sok_7
L_slp_8:
    s_add_u32 s7, s7, 1
    s_cmp_gt_u32 s7, 0x40000
    s_cbranch_scc1 L_sok_7
    s_load_dwordx8 s[60:67], s[52:53], s8 glc
    s_branch L_sck_9
L_sok_7:
    v_mfma_f32_32x32x16_bf16 v[32:47], a[216:219], a[104:107], v[32:47]
    ds_read_b64_tr_b16 a[244:245], v243 offset:2048
    ds_read_b64_tr_b16 a[246:247], v243 offset:2560
    s_add_u32 s25, s82, 0
    buffer_load_dwordx4 a[0:3], v230, s[52:55], s25 offen offset:0 sc1
    s_add_u32 s20, s21, 0
    buffer_load_dwordx4 a[4:7], v230, s[52:55], s20 offen offset:0 sc1
    v_mfma_f32_32x32x16_bf16 v[32:47], a[220:223], a[108:111], v[32:47]
    ds_read_b64_tr_b16 a[248:249], v243 offset:4096
    ds_read_b64_tr_b16 a[250:251], v243 offset:4608
    v_max_f32 v16, 0, v16
    v_max_f32 v17, 0, v17
    v_max_f32 v18, 0, v18
    v_mfma_f32_32x32x16_bf16 v[32:47], a[224:227], a[112:115], v[32:47]
    ds_read_b64_tr_b16 a[252:253], v243 offset:6144
    ds_read_b64_tr_b16 a[254:255], v243 offset:6656
    v_max_f32 v19, 0, v19
    v_max_f32 v20, 0, v20
    v_max_f32 v21, 0, v21
    v_max_f32 v22, 0, v22
    v_mfma_f32_32x32x16_bf16 v[32:47], a[228:231], a[116:119], v[32:47]
    ds_read_b64_tr_b16 a[208:209], v243 offset:8192
    ds_read_b64_tr_b16 a[210:211], v243 offset:8704
    v_max_f32 v23, 0, v23
    v_mul_f32 v16, v16, v24
    v_mul_f32_e64 v17, v17, v25
    v_mfma_f32_32x32x16_bf16 v[32:47], a[232:235], a[120:123], v[32:47]
    ds_read_b64_tr_b16 a[212:213], v243 offset:10240
    ds_read_b64_tr_b16 a[214:215], v243 offset:10752
    v_mul_f32 v18, v18, v26
    v_mul_f32 v19, v19, v27
    v_mul_f32 v20, v20, v28
    v_mul_f32 v21, v21, v29
    v_mfma_f32_32x32x16_bf16 v[32:47], a[236:239], a[124:127], v[32:47]
    ds_read_b64_tr_b16 a[216:217], v243 offset:12288
    ds_read_b64_tr_b16 a[218:219], v243 offset:12800
    v_mul_f32 v22, v22, v30
    v_mul_f32_e64 v23, v23, v31
    v_cvt_pk_bf16_f32 v16, v16, v17
    s_waitcnt lgkmcnt(6)
    v_mfma_f32_32x32x16_bf16 v[48:63], a[240:243], a[96:99], v[48:63]
    ds_read_b64_tr_b16 a[220:221], v243 offset:14336
    ds_read_b64_tr_b16 a[222:223], v243 offset:14848
    v_cvt_pk_bf16_f32 v17, v18, v19
    v_cvt_pk_bf16_f32 v18, v20, v21
    v_cvt_pk_bf16_f32 v19, v22, v23
    buffer_store_dwordx4 v[16:19], v230, s[52:55], s81 offen offset:1024 sc1
    v_mfma_f32_32x32x16_bf16 v[48:63], a[244:247], a[100:103], v[48:63]
    buffer_load_dwordx4 a[8:11], v230, s[52:55], s25 offen offset:1024 sc1
    buffer_load_dwordx4 a[12:15], v230, s[52:55], s20 offen offset:1024 sc1
    buffer_load_dwordx4 a[16:19], v230, s[52:55], s25 offen offset:2048 sc1
    v_mfma_f32_32x32x16_bf16 v[48:63], a[248:251], a[104:107], v[48:63]
    buffer_load_dwordx4 a[20:23], v230, s[52:55], s20 offen offset:2048 sc1
    v_mfma_f32_32x32x16_bf16 v[48:63], a[252:255], a[108:111], v[48:63]
    v_max_f32 v32, 0, v32
    v_max_f32 v33, 0, v33
    v_max_f32 v34, 0, v34
    s_waitcnt lgkmcnt(0)
    v_mfma_f32_32x32x16_bf16 v[48:63], a[208:211], a[112:115], v[48:63]
    v_max_f32 v35, 0, v35
    v_max_f32 v36, 0, v36
    v_max_f32 v37, 0, v37
    v_max_f32 v38, 0, v38
    v_mfma_f32_32x32x16_bf16 v[48:63], a[212:215], a[116:119], v[48:63]
    v_max_f32 v39, 0, v39
    v_mul_f32 v32, v32, v40
    v_mul_f32 v33, v33, v41
    v_mfma_f32_32x32x16_bf16 v[48:63], a[216:219], a[120:123], v[48:63]
    v_mul_f32 v34, v34, v42
    v_mul_f32 v35, v35, v43
    v_mul_f32 v36, v36, v44
    v_mul_f32 v37, v37, v45
    v_mfma_f32_32x32x16_bf16 v[48:63], a[220:223], a[124:127], v[48:63]
    v_mul_f32 v38, v38, v46
    v_mul_f32_e64 v39, v39, v47
    v_cvt_pk_bf16_f32 v32, v32, v33
    s_add_u32 s8, s9, 16384
    s_load_dwordx8 s[60:67], s[52:53], s8 glc
    v_cvt_pk_bf16_f32 v33, v34, v35
    v_cvt_pk_bf16_f32 v34, v36, v37
    v_cvt_pk_bf16_f32 v35, v38, v39
    buffer_store_dwordx4 v[32:35], v230, s[52:55], s81 offen offset:2048 sc1
    s_nop 2
    v_max_f32 v48, 0, v48
    v_max_f32 v49, 0, v49
    v_max_f32 v50, 0, v50
    v_max_f32 v51, 0, v51
    v_max_f32 v52, 0, v52
    v_max_f32 v53, 0, v53
    v_max_f32 v54, 0, v54
    v_max_f32 v55, 0, v55
    v_mul_f32 v48, v48, v56
    v_mul_f32 v49, v49, v57
    v_mul_f32 v50, v50, v58
    v_mul_f32 v51, v51, v59
    v_mul_f32 v52, v52, v60
    v_mul_f32 v53, v53, v61
    v_mul_f32 v54, v54, v62
    v_mul_f32_e64 v55, v55, v63
    v_cvt_pk_bf16_f32 v48, v48, v49
    v_cvt_pk_bf16_f32 v49, v50, v51
    v_cvt_pk_bf16_f32 v50, v52, v53
    v_cvt_pk_bf16_f32 v51, v54, v55
    buffer_store_dwordx4 v[48:51], v230, s[52:55], s81 offen offset:3072 sc1
    buffer_load_dwordx4 a[24:27], v230, s[52:55], s25 offen offset:3072 sc1
    buffer_load_dwordx4 a[28:31], v230, s[52:55], s20 offen offset:3072 sc1
    v_subrev_u32 v237, 65536, v254
    v_subrev_u32 v238, 65536, v255
    s_branch L_phase2
.p2align 6
L_var6:
    s_waitcnt vmcnt(9)
    s_barrier
    ds_read_b64_tr_b16 a[208:209], v234 offset:0
    ds_read_b64_tr_b16 a[210:211], v234 offset:256
    ds_read_b64_tr_b16 a[212:213], v234 offset:1024
    ds_read_b64_tr_b16 a[214:215], v234 offset:1280
    ds_read_b64_tr_b16 a[216:217], v234 offset:2048
    ds_read_b64_tr_b16 a[218:219], v234 offset:2304
    ds_read_b64_tr_b16 a[220:221], v234 offset:3072
    ds_read_b64_tr_b16 a[222:223], v234 offset:3328
    ds_read_b64_tr_b16 a[224:225], v234 offset:4096
    ds_read_b64_tr_b16 a[226:227], v234 offset:4352
    ds_read_b64_tr_b16 a[228:229], v234 offset:5120
    ds_read_b64_tr_b16 a[230:231], v234 offset:5376
    ds_read_b64_tr_b16 a[232:233], v234 offset:6144
    s_nop 0
    ds_read_b64_tr_b16 a[234:235], v234 offset:6400
    s_waitcnt lgkmcnt(6)
    v_mfma_f32_32x32x16_bf16 v[128:143], a[208:211], a[0:3], 0
    ds_read_b64_tr_b16 a[236:237], v234 offset:7168
    ds_read_b64_tr_b16 a[238:239], v234 offset:7424
    s_add_u32 m0, s74, 32768
    s_add_u32 s1, s84, 0
    buffer_load_dwordx4 v244, s[36:39], s1 offen offset:0 lds
    v_lshl_add_u32 v200, v195, 2, v197
    v_lshlrev_b32 v200, 5, v200
    v_mfma_f32_32x32x16_bf16 v[128:143], a[212:215], a[4:7], v[128:143]
    ds_read_b64_tr_b16 a[240:241], v234 offset:8192
    ds_read_b64_tr_b16 a[242:243], v234 offset:8448
    v_lshrrev_b32 v201, 1, v198
    v_lshl_add_u32 v201, v196, 1, v201
    v_lshl_add_u32 v200, v201, 3, v200
    s_lshl_b32 s19, s3, 10
    s_add_u32 s19, s19, 131072
    v_mfma_f32_32x32x16_bf16 v[128:143], a[216:219], a[8:11], v[128:143]
    ds_read_b64_tr_b16 a[244:245], v234 offset:9216
    ds_read_b64_tr_b16 a[246:247], v234 offset:9472
    v_add_u32 v254, s19, v200
    v_and_b32_e64 v200, 1, v197
    v_mov_b32 v201, 0x80008000
    v_mul_lo_u32 v255, v200, v201
    s_lshl_b32 s19, s4, 2
    v_mfma_f32_32x32x16_bf16 v[128:143], a[220:223], a[12:15], v[128:143]
    ds_read_b64_tr_b16 a[248:249], v234 offset:10240
    ds_read_b64_tr_b16 a[250:251], v234 offset:10496
    s_add_u32 s19, s19, s3
    s_lshl4_add_u32 s23, s4, s3
    s_lshl_b32 s13, s5, 11
    s_add_u32 s13, s13, 10878976
    s_lshl3_add_u32 s12, s23, s13
    s_lshr_b32 s19, s19, 1
    s_waitcnt lgkmcnt(6)
    v_mfma_f32_32x32x16_bf16 v[128:143], a[224:227], a[16:19], v[128:143]
    ds_read_b64_tr_b16 a[252:253], v234 offset:11264
    ds_read_b64_tr_b16 a[254:255], v234 offset:11520
    s_add_u32 s1, s84, 48128
    buffer_load_dwordx4 v244, s[36:39], s1 offen offset:1024 lds
    s_lshr_b32 s23, s5, 2
    s_lshl2_add_u32 s19, s19, s23
    s_lshl_b32 s19, s19, 5
    v_mfma_f32_32x32x16_bf16 v[128:143], a[228:231], a[20:23], v[128:143]
    ds_read_b64_tr_b16 a[208:209], v234 offset:12288
    ds_read_b64_tr_b16 a[210:211], v234 offset:12544
    s_and_b32 s23, s3, 1
    s_lshl2_add_u32 s19, s23, s19
    s_and_b32 s23, s5, 3
    s_add_u32 s19, s19, s23
    s_lshl_b32 s19, s19, 2
    v_mfma_f32_32x32x16_bf16 v[128:143], a[232:235], a[24:27], v[128:143]
    ds_read_b64_tr_b16 a[212:213], v234 offset:13312
    ds_read_b64_tr_b16 a[214:215], v234 offset:13568
    s_add_u32 s14, s19, 10813440
    s_add_u32 s15, s19, 10829824
    s_mov_b32 s73, 1069066811
    s_and_b32 s19, s3, 1
    s_nop 0
    s_mul_i32 s23, s19, 229376
    v_mfma_f32_32x32x16_bf16 v[128:143], a[236:239], a[28:31], v[128:143]
    ds_read_b64_tr_b16 a[216:217], v234 offset:14336
    ds_read_b64_tr_b16 a[218:219], v234 offset:14592
    s_xor_b32 vcc_lo, s87, 0
    s_mul_i32 vcc_lo, vcc_lo, 458752
    s_add_u32 s26, vcc_lo, s23
    s_xor_b32 vcc_lo, s87, 1
    s_mul_i32 vcc_lo, vcc_lo, 458752
    s_waitcnt lgkmcnt(6)
    v_mfma_f32_32x32x16_bf16 v[128:143], a[240:243], a[32:35], v[128:143]
    ds_read_b64_tr_b16 a[220:221], v234 offset:15360
    ds_read_b64_tr_b16 a[222:223], v234 offset:15616
    s_add_u32 s1, s84, 96256
    buffer_load_dwordx4 v244, s[36:39], s1 offen offset:2048 lds
    s_add_u32 s27, vcc_lo, s23
    s_xor_b32 vcc_lo, s87, 2
    s_mul_i32 vcc_lo, vcc_lo, 458752
    v_mfma_f32_32x32x16_bf16 v[128:143], a[244:247], a[36:39], v[128:143]
    ds_read_b64_tr_b16 a[224:225], v234 offset:16384
    ds_read_b64_tr_b16 a[226:227], v234 offset:16640
    s_add_u32 s28, vcc_lo, s23
    s_xor_b32 vcc_lo, s87, 3
    s_mul_i32 vcc_lo, vcc_lo, 458752
    s_add_u32 s29, vcc_lo, s23
    s_xor_b32 vcc_lo, s87, s19
    v_mfma_f32_32x32x16_bf16 v[128:143], a[248:251], a[40:43], v[128:143]
    ds_read_b64_tr_b16 a[228:229], v234 offset:17408
    ds_read_b64_tr_b16 a[230:231], v234 offset:17664
    s_mul_i32 s75, vcc_lo, 458752
    s_xor_b32 vcc_lo, vcc_lo, 2
    s_mul_i32 s76, vcc_lo, 458752
    s_and_b32 s19, s5, 3
    s_lshl_b32 s19, s19, 2
    v_mfma_f32_32x32x16_bf16 v[128:143], a[252:255], a[44:47], v[128:143]
    ds_read_b64_tr_b16 a[232:233], v234 offset:18432
    ds_read_b64_tr_b16 a[234:235], v234 offset:18688
    s_lshr_b32 s80, 0x6280, s19
    s_and_b32 s80, s80, 15
    s_lshr_b32 s81, 0xa0c4, s19
    s_and_b32 s81, s81, 15
    s_lshr_b32 s19, s5, 1
    s_waitcnt lgkmcnt(6)
    v_mfma_f32_32x32x16_bf16 v[128:143], a[208:211], a[48:51], v[128:143]
    ds_read_b64_tr_b16 a[236:237], v234 offset:19456
    ds_read_b64_tr_b16 a[238:239], v234 offset:19712
    s_add_u32 s1, s84, 144384
    buffer_load_dwordx4 v244, s[36:39], s1 offen offset:3072 lds
    s_mul_i32 s19, s19, 14
    s_add_u32 s80, s80, s19
    s_add_u32 s81, s81, s19
    v_mfma_f32_32x32x16_bf16 v[128:143], a[212:215], a[52:55], v[128:143]
    ds_read_b64_tr_b16 a[240:241], v234 offset:20480
    ds_read_b64_tr_b16 a[242:243], v234 offset:20736
    v_lshrrev_b32 v200, 3, v206
    v_mul_u32_u24 v200, 3584, v200
    v_lshlrev_b32 v201, 1, v196
    v_add_u32 v201, s86, v201
    v_lshlrev_b32 v201, 1, v201
    v_mfma_f32_32x32x16_bf16 v[128:143], a[216:219], a[56:59], v[128:143]
    ds_read_b64_tr_b16 a[244:245], v234 offset:21504
    ds_read_b64_tr_b16 a[246:247], v234 offset:21760
    v_and_b32 v202, 7, v206
    v_xor_b32_e64 v201, v201, v202
    v_lshl_add_u32 v200, v201, 4, v200
    s_lshl_b32 s19, s80, 5
    v_add_u32_e64 v231, s19, v200
    v_mfma_f32_32x32x16_bf16 v[128:143], a[220:223], a[60:63], v[128:143]
    ds_read_b64_tr_b16 a[248:249], v234 offset:22528
    ds_read_b64_tr_b16 a[250:251], v234 offset:22784
    v_add_u32 v120, 27648, v231
    v_add_u32 v121, 55296, v231
    v_add_u32 v122, 82944, v231
    v_lshrrev_b32 v201, 2, v206
    v_mul_u32_u24 v201, 3584, v201
    s_waitcnt vmcnt(5)
    s_barrier
    s_lshl_b32 s70, s3, 10
    s_add_u32 s70, s70, 131072
    v_add_u32_e64 v224, s70, v230
    ds_write_b128 v224, v[216:219]
    s_waitcnt lgkmcnt(7)
    v_mfma_f32_32x32x16_bf16 v[128:143], a[224:227], a[64:67], v[128:143]
    ds_read_b64_tr_b16 a[252:253], v234 offset:23552
    ds_read_b64_tr_b16 a[254:255], v234 offset:23808
    s_add_u32 m0, s74, 36864
    s_add_u32 s1, s84, 196608
    buffer_load_dwordx4 v244, s[36:39], s1 offen offset:0 lds
    s_lshl_b32 s19, s86, 1
    v_xor_b32 v203, s19, v198
    v_mfma_f32_32x32x16_bf16 v[128:143], a[228:231], a[68:71], v[128:143]
    ds_read_b64_tr_b16 a[208:209], v234 offset:24576
    ds_read_b64_tr_b16 a[210:211], v234 offset:24832
    v_lshl_add_u32 v201, v203, 4, v201
    s_lshl_b32 s19, s81, 5
    v_add_u32_e64 v232, s19, v201
    s_cmp_lg_u32 s6, 0
    s_cselect_b32 s75, s75, 128
    s_lshl_b32 s19, s3, 8
    v_mfma_f32_32x32x16_bf16 v[128:143], a[232:235], a[72:75], v[128:143]
    ds_read_b64_tr_b16 a[212:213], v234 offset:25600
    ds_read_b64_tr_b16 a[214:215], v234 offset:25856
    ds_read_b64_tr_b16 v[216:217], v254 offset:0
    ds_read_b64_tr_b16 v[218:219], v254 offset:256
    ds_read_b64_tr_b16 v[220:221], v254 offset:512
    ds_read_b64_tr_b16 v[222:223], v254 offset:768
    v_lshl_add_u32 v200, v194, 3, s19
    v_mfma_f32_32x32x16_bf16 v[128:143], a[236:239], a[76:79], v[128:143]
    ds_read_b64_tr_b16 a[216:217], v234 offset:26624
    ds_read_b64_tr_b16 a[218:219], v234 offset:26880
    v_mul_u32_u24 v201, 4352, v195
    v_add3_u32 v246, v200, v201, 0
    v_add_u32 v246, 135168, v246
    v_mul_u32_u24 v201, 1088, v195
    v_add_u32 v201, 152576, v201
    s_waitcnt lgkmcnt(10)
    v_mfma_f32_32x32x16_bf16 v[128:143], a[240:243], a[80:83], v[128:143]
    ds_read_b64_tr_b16 a[220:221], v234 offset:27648
    ds_read_b64_tr_b16 a[222:223], v234 offset:27904
    s_add_u32 s1, s84, 244736
    buffer_load_dwordx4 v244, s[36:39], s1 offen offset:1024 lds
    v_add_u32 v247, v200, v201
    v_mul_u32_u24 v200, 1088, v198
    v_lshrrev_b32_e64 v201, 2, v206
    v_mfma_f32_32x32x16_bf16 v[128:143], a[244:247], a[84:87], v[128:143]
    ds_read_b64_tr_b16 a[224:225], v234 offset:28672
    ds_read_b64_tr_b16 a[226:227], v234 offset:28928
    v_lshl_add_u32 v200, v201, 3, v200
    s_mul_i32 s19, s3, 4352
    s_add_u32 s19, s19, 135168
    v_add_u32_e64 v248, s19, v200
    s_mul_i32 s19, s86, 4352
    v_mfma_f32_32x32x16_bf16 v[128:143], a[248:251], a[88:91], v[128:143]
    ds_read_b64_tr_b16 a[228:229], v234 offset:29696
    ds_read_b64_tr_b16 a[230:231], v234 offset:29952
    s_waitcnt lgkmcnt(8)
    v_xor_b32 v216, v216, v255
    v_xor_b32 v217, v217, v255
    v_xor_b32 v218, v218, v255
    v_xor_b32_e64 v219, v219, v255
    v_mfma_f32_32x32x16_bf16 v[128:143], a[252:255], a[92:95], v[128:143]
    ds_read_b64_tr_b16 a[232:233], v234 offset:30720
    ds_read_b64_tr_b16 a[234:235], v234 offset:30976
    v_xor_b32 v220, v220, v255
    v_xor_b32 v221, v221, v255
    v_xor_b32 v222, v222, v255
    v_xor_b32 v223, v223, v255
    s_waitcnt vmcnt(6)
    v_readfirstlane_b32 s68, v228
    v_readfirstlane_b32 s69, v229
    s_mov_b32 s7, 0
    s_cmp_lg_u32 s68, 0
    s_cbranch_scc1 L_epok_11
L_ep_10:
    buffer_load_dwordx2 v[228:229], off, s[60:63], 0 sc1
    s_waitcnt vmcnt(0)
    v_readfirstlane_b32 s68, v228
    v_readfirstlane_b32 s69, v229
    s_add_u32 s7, s7, 1
    s_cmp_gt_u32 s7, 0x40000
    s_cbranch_scc1 L_epok_11
    s_cmp_eq_u32 s68, 0
    s_cbranch_scc1 L_ep_10
L_epok_11:
    s_waitcnt lgkmcnt(6)
    v_mfma_f32_32x32x16_bf16 v[128:143], a[208:211], a[96:99], v[128:143]
    ds_read_b64_tr_b16 a[236:237], v234 offset:31744
    ds_read_b64_tr_b16 a[238:239], v234 offset:32000
    s_add_u32 s1, s84, 292864
    buffer_load_dwordx4 v244, s[36:39], s1 offen offset:2048 lds
    s_add_u32 s70, s12, 32768
    v_mov_b32 v228, s68
    v_mov_b32 v229, s69
    buffer_store_dwordx2 v[228:229], off, s[52:55], s70 sc1
    v_mfma_f32_32x32x16_bf16 v[128:143], a[212:215], a[100:103], v[128:143]
    ds_read_b64_tr_b16 a[240:241], v235 offset:0
    ds_read_b64_tr_b16 a[242:243], v235 offset:256
    s_add_u32 s19, s19, 152576
    v_add_u32 v249, s19, v200
    v_lshlrev_b32 v200, 8, v192
    v_lshl_add_u32 v200, v193, 2, v200
    s_and_b32 s19, s3, 1
    v_mfma_f32_32x32x16_bf16 v[128:143], a[216:219], a[104:107], v[128:143]
    ds_read_b64_tr_b16 a[244:245], v235 offset:1024
    ds_read_b64_tr_b16 a[246:247], v235 offset:1280
    s_mul_i32 s19, s19, 1088
    v_add_u32 v250, s19, v200
    v_min_u32_e64 v200, 16, v194
    v_lshlrev_b32 v200, 6, v200
    v_mul_u32_u24 v201, 1088, v195
    v_mfma_f32_32x32x16_bf16 v[128:143], a[220:223], a[108:111], v[128:143]
    ds_read_b64_tr_b16 a[248:249], v235 offset:2048
    ds_read_b64_tr_b16 a[250:251], v235 offset:2304
    s_lshl_b32 s19, s3, 4
    v_add3_u32 v251, v200, v201, s19
    s_lshl_b32 s19, s86, 13
    s_and_b32 s23, s3, 1
    s_lshl_b32 s23, s23, 3
    s_waitcnt lgkmcnt(6)
    v_mfma_f32_32x32x16_bf16 v[128:143], a[224:227], a[112:115], v[128:143]
    ds_read_b64_tr_b16 a[252:253], v235 offset:3072
    ds_read_b64_tr_b16 a[254:255], v235 offset:3328
    s_add_u32 s19, s19, s23
    s_add_u32 s19, s19, 138240
    v_add_u32 v252, s19, v230
    v_add_u32 v253, 138240, v230
    v_lshlrev_b32_e64 v200, 7, v199
    v_mfma_f32_32x32x16_bf16 v[128:143], a[228:231], a[116:119], v[128:143]
    ds_read_b64_tr_b16 a[208:209], v235 offset:4096
    ds_read_b64_tr_b16 a[210:211], v235 offset:4352
    s_add_u32 s1, s84, 340992
    buffer_load_dwordx4 v244, s[36:39], s1 offen offset:3072 lds
    v_lshl_add_u32 v200, v196, 14, v200
    v_lshl_add_u32 v200, v198, 3, v200
    v_lshrrev_b32_e64 v201, 1, v197
    v_mfma_f32_32x32x16_bf16 v[128:143], a[232:235], a[120:123], v[128:143]
    ds_read_b64_tr_b16 a[212:213], v235 offset:5120
    ds_read_b64_tr_b16 a[214:215], v235 offset:5376
    v_lshl_add_u32 v201, v201, 1, v196
    v_xor_b32 v202, 0, v201
    v_lshl_add_u32 v236, v202, 5, v200
    v_add_u32 v240, 65536, v236
    v_xor_b32 v202, 1, v201
    v_mfma_f32_32x32x16_bf16 v[128:143], a[236:239], a[124:127], v[128:143]
    ds_read_b64_tr_b16 a[216:217], v235 offset:6144
    ds_read_b64_tr_b16 a[218:219], v235 offset:6400
    v_lshl_add_u32 v237, v202, 5, v200
    v_add_u32 v241, 65536, v237
    v_xor_b32 v202, 2, v201
    v_lshl_add_u32 v238, v202, 5, v200
    v_add_u32 v242, 65536, v238
    s_waitcnt lgkmcnt(6)
    v_mfma_f32_32x32x16_bf16 v[144:159], a[240:243], a[0:3], 0
    ds_read_b64_tr_b16 a[220:221], v235 offset:7168
    ds_read_b64_tr_b16 a[222:223], v235 offset:7424
    v_xor_b32_e64 v202, 3, v201
    v_lshl_add_u32 v239, v202, 5, v200
    v_add_u32 v243, 65536, v239
    v_and_b32_e64 v202, 7, v206
    v_lshlrev_b32_e64 v201, 2, v196
    v_mfma_f32_32x32x16_bf16 v[144:159], a[244:247], a[4:7], v[144:159]
    ds_read_b64_tr_b16 a[224:225], v235 offset:8192
    ds_read_b64_tr_b16 a[226:227], v235 offset:8448
    s_add_u32 m0, s74, 65536
    s_add_u32 s85, s26, 0
    buffer_load_dwordx4 v231, s[40:43], s85 offen offset:0 lds
    v_xor_b32 v201, v201, v202
    v_lshlrev_b32_e64 v201, 4, v201
    v_mfma_f32_32x32x16_bf16 v[144:159], a[248:251], a[8:11], v[144:159]
    ds_read_b64_tr_b16 a[228:229], v235 offset:9216
    ds_read_b64_tr_b16 a[230:231], v235 offset:9472
    v_lshrrev_b32 v200, 3, v206
    v_lshl_add_u32 v200, v200, 10, v201
    s_lshl_b32 s19, s31, 7
    v_add_u32_e64 v233, s19, v200
    v_add_u32 v123, 7168, v233
    v_add_u32 v124, 14336, v233
    v_mfma_f32_32x32x16_bf16 v[144:159], a[252:255], a[12:15], v[144:159]
    ds_read_b64_tr_b16 a[232:233], v235 offset:10240
    ds_read_b64_tr_b16 a[234:235], v235 offset:10496
    buffer_load_dwordx4 v120, s[40:43], s85 offen offset:1024 lds
    v_cvt_pk_bf16_f32 v208, v128, v129
    v_cvt_pk_bf16_f32 v209, v130, v131
    v_cvt_pk_bf16_f32 v210, v132, v133
    v_cvt_pk_bf16_f32 v211, v134, v135
    s_waitcnt lgkmcnt(6)
    v_mfma_f32_32x32x16_bf16 v[144:159], a[208:211], a[16:19], v[144:159]
    s_nop 0
    ds_read_b64_tr_b16 a[236:237], v235 offset:11264
    ds_read_b64_tr_b16 a[238:239], v235 offset:11520
    v_cvt_pk_bf16_f32 v212, v136, v137
    v_cvt_pk_bf16_f32 v213, v138, v139
    v_cvt_pk_bf16_f32 v214, v140, v141
    v_cvt_pk_bf16_f32 v215, v142, v143
    v_mfma_f32_32x32x16_bf16 v[176:191], v[216:219], v[208:211], 0
    v_mfma_f32_32x32x16_bf16 v[144:159], a[212:215], a[20:23], v[144:159]
    ds_read_b64_tr_b16 a[240:241], v235 offset:12288
    ds_read_b64_tr_b16 a[242:243], v235 offset:12544
    buffer_load_dwordx4 v121, s[40:43], s85 offen offset:2048 lds
    v_mfma_f32_32x32x16_bf16 v[128:143], v[220:223], v[212:215], 0
    v_mfma_f32_32x32x16_bf16 v[144:159], a[216:219], a[24:27], v[144:159]
    ds_read_b64_tr_b16 a[244:245], v235 offset:13312
    ds_read_b64_tr_b16 a[246:247], v235 offset:13568
    v_add_u32 v125, 21504, v233
    s_mul_i32 s78, s3, 458752
    s_lshl_b32 s79, s3, 17
    s_lshl_b32 s77, s4, 2
    s_add_u32 s77, s77, s3
    s_mul_i32 s77, s77, 147456
    v_mfma_f32_32x32x16_bf16 v[144:159], a[220:223], a[28:31], v[144:159]
    ds_read_b64_tr_b16 a[248:249], v235 offset:14336
    ds_read_b64_tr_b16 a[250:251], v235 offset:14592
    buffer_load_dwordx4 v122, s[40:43], s85 offen offset:3072 lds
    s_nop 0
    v_max3_f32 v224, v176, v177, v178
    v_max3_f32 v64, v128, v129, v130
    v_max3_f32 v225, v179, v180, v181
    v_max3_f32 v65, v131, v132, v133
    s_waitcnt lgkmcnt(6)
    v_mfma_f32_32x32x16_bf16 v[144:159], a[224:227], a[32:35], v[144:159]
    ds_read_b64_tr_b16 a[252:253], v235 offset:15360
    ds_read_b64_tr_b16 a[254:255], v235 offset:15616
    s_nop 0
    v_max3_f32 v224, v224, v182, v183
    v_max3_f32 v64, v64, v134, v135
    v_max3_f32 v225, v225, v184, v185
    v_max3_f32 v65, v65, v136, v137
    v_max3_f32 v224, v224, v186, v187
    v_max3_f32 v64, v64, v138, v139
    v_mfma_f32_32x32x16_bf16 v[144:159], a[228:231], a[36:39], v[144:159]
    ds_read_b64_tr_b16 a[208:209], v235 offset:16384
    ds_read_b64_tr_b16 a[210:211], v235 offset:16640
    s_add_u32 m0, s74, 69632
    s_add_u32 s85, s26, 114688
    buffer_load_dwordx4 v231, s[40:43], s85 offen offset:0 lds
    v_max3_f32 v225, v225, v188, v189
    v_max3_f32 v65, v65, v140, v141
    v_mfma_f32_32x32x16_bf16 v[144:159], a[232:235], a[40:43], v[144:159]
    ds_read_b64_tr_b16 a[212:213], v235 offset:17408
    ds_read_b64_tr_b16 a[214:215], v235 offset:17664
    v_max3_f32 v224, v224, v190, v191
    v_max3_f32 v64, v64, v142, v143
    v_max_f32_e64 v224, v224, v225
    v_max_f32_e64 v64, v64, v65
    v_mul_f32 v225, 0xbfb8aa3b, v224
    v_mul_f32 v65, 0xbfb8aa3b, v64
    v_mfma_f32_32x32x16_bf16 v[144:159], a[236:239], a[44:47], v[144:159]
    ds_read_b64_tr_b16 a[216:217], v235 offset:18432
    ds_read_b64_tr_b16 a[218:219], v235 offset:18688
    buffer_load_dwordx4 v120, s[40:43], s85 offen offset:1024 lds
    v_fma_f32 v176, v176, s73, v225
    v_fma_f32 v128, v128, s73, v65
    v_fma_f32 v177, v177, s73, v225
    v_fma_f32 v129, v129, s73, v65
    s_waitcnt lgkmcnt(6)
    s_nop 0
    v_mfma_f32_32x32x16_bf16 v[144:159], a[240:243], a[48:51], v[144:159]
    ds_read_b64_tr_b16 a[220:221], v235 offset:19456
    ds_read_b64_tr_b16 a[222:223], v235 offset:19712
    v_fma_f32 v178, v178, s73, v225
    v_fma_f32 v130, v130, s73, v65
    v_fma_f32 v179, v179, s73, v225
    v_fma_f32 v131, v131, s73, v65
    v_fma_f32 v180, v180, s73, v225
    v_fma_f32 v132, v132, s73, v65
    v_mfma_f32_32x32x16_bf16 v[144:159], a[244:247], a[52:55], v[144:159]
    ds_read_b64_tr_b16 a[224:225], v235 offset:20480
    ds_read_b64_tr_b16 a[226:227], v235 offset:20736
    buffer_load_dwordx4 v121, s[40:43], s85 offen offset:2048 lds
    v_fma_f32 v181, v181, s73, v225
    v_fma_f32 v133, v133, s73, v65
    v_fma_f32 v182, v182, s73, v225
    v_fma_f32 v134, v134, s73, v65
    v_mfma_f32_32x32x16_bf16 v[144:159], a[248:251], a[56:59], v[144:159]
    ds_read_b64_tr_b16 a[228:229], v235 offset:21504
    ds_read_b64_tr_b16 a[230:231], v235 offset:21760
    v_fma_f32 v183, v183, s73, v225
    v_fma_f32 v135, v135, s73, v65
    v_fma_f32 v184, v184, s73, v225
    v_fma_f32 v136, v136, s73, v65
    v_fma_f32 v185, v185, s73, v225
    v_fma_f32 v137, v137, s73, v65
    v_mfma_f32_32x32x16_bf16 v[144:159], a[252:255], a[60:63], v[144:159]
    ds_read_b64_tr_b16 a[232:233], v235 offset:22528
    ds_read_b64_tr_b16 a[234:235], v235 offset:22784
    buffer_load_dwordx4 v122, s[40:43], s85 offen offset:3072 lds
    v_fma_f32 v186, v186, s73, v225
    v_fma_f32 v138, v138, s73, v65
    v_fma_f32 v187, v187, s73, v225
    v_fma_f32 v139, v139, s73, v65
    s_waitcnt vmcnt(8)
    s_barrier
    s_waitcnt lgkmcnt(6)
    v_mfma_f32_32x32x16_bf16 v[144:159], a[208:211], a[64:67], v[144:159]
    ds_read_b64_tr_b16 a[236:237], v235 offset:23552
    ds_read_b64_tr_b16 a[238:239], v235 offset:23808
    v_fma_f32 v188, v188, s73, v225
    s_nop 0
    v_fma_f32 v140, v140, s73, v65
    v_fma_f32 v189, v189, s73, v225
    v_fma_f32 v141, v141, s73, v65
    v_fma_f32 v190, v190, s73, v225
    v_fma_f32 v142, v142, s73, v65
    v_mfma_f32_32x32x16_bf16 v[144:159], a[212:215], a[68:71], v[144:159]
    ds_read_b64_tr_b16 a[240:241], v235 offset:24576
    ds_read_b64_tr_b16 a[242:243], v235 offset:24832
    s_add_u32 m0, s74, 98304
    s_add_u32 s85, s27, 0
    buffer_load_dwordx4 v231, s[40:43], s85 offen offset:0 lds
    v_fma_f32 v191, v191, s73, v225
    v_fma_f32 v143, v143, s73, v65
    v_mfma_f32_32x32x16_bf16 v[144:159], a[216:219], a[72:75], v[144:159]
    ds_read_b64_tr_b16 a[244:245], v235 offset:25600
    ds_read_b64_tr_b16 a[246:247], v235 offset:25856
    v_exp_f32 v176, v176
    v_exp_f32 v128, v128
    v_exp_f32 v177, v177
    v_mfma_f32_32x32x16_bf16 v[144:159], a[220:223], a[76:79], v[144:159]
    ds_read_b64_tr_b16 a[248:249], v235 offset:26624
    ds_read_b64_tr_b16 a[250:251], v235 offset:26880
    v_exp_f32 v129, v129
    v_exp_f32 v178, v178
    s_lshl_b32 s80, s80, 10
    s_waitcnt lgkmcnt(6)
    v_mfma_f32_32x32x16_bf16 v[144:159], a[224:227], a[80:83], v[144:159]
    ds_read_b64_tr_b16 a[252:253], v235 offset:27648
    ds_read_b64_tr_b16 a[254:255], v235 offset:27904
    buffer_load_dwordx4 v120, s[40:43], s85 offen offset:1024 lds
    v_exp_f32 v130, v130
    v_exp_f32 v179, v179
    s_add_u32 s80, s80, s77
    v_mfma_f32_32x32x16_bf16 v[144:159], a[228:231], a[84:87], v[144:159]
    ds_read_b64_tr_b16 a[208:209], v235 offset:28672
    ds_read_b64_tr_b16 a[210:211], v235 offset:28928
    v_exp_f32 v131, v131
    v_exp_f32 v180, v180
    s_lshl_b32 s81, s81, 10
    v_mfma_f32_32x32x16_bf16 v[144:159], a[232:235], a[88:91], v[144:159]
    ds_read_b64_tr_b16 a[212:213], v235 offset:29696
    ds_read_b64_tr_b16 a[214:215], v235 offset:29952
    v_exp_f32 v132, v132
    v_add_f32 v226, v176, v177
    v_add_f32 v66, v128, v129
    v_exp_f32 v181, v181
    v_mfma_f32_32x32x16_bf16 v[144:159], a[236:239], a[92:95], v[144:159]
    ds_read_b64_tr_b16 a[216:217], v235 offset:30720
    ds_read_b64_tr_b16 a[218:219], v235 offset:30976
    buffer_load_dwordx4 v121, s[40:43], s85 offen offset:2048 lds
    v_exp_f32 v133, v133
    v_exp_f32 v182, v182
    s_waitcnt lgkmcnt(6)
    v_mfma_f32_32x32x16_bf16 v[144:159], a[240:243], a[96:99], v[144:159]
    ds_read_b64_tr_b16 a[220:221], v235 offset:31744
    ds_read_b64_tr_b16 a[222:223], v235 offset:32000
    v_exp_f32 v134, v134
    v_add_f32 v227, v178, v179
    v_add_f32 v67, v130, v131
    v_exp_f32_e64 v183, v183
    v_mfma_f32_32x32x16_bf16 v[144:159], a[244:247], a[100:103], v[144:159]
    ds_read_b64_tr_b16 a[224:225], v235 offset:32768
    ds_read_b64_tr_b16 a[226:227], v235 offset:33024
    v_bfe_u32 v112, v230, 4, 3
    v_min_u32 v112, 5, v112
    v_lshlrev_b32 v112, 21, v112
    buffer_load_dword a172, v112, s[52:55], 0 offen
    buffer_load_dword a172, off, s[56:59], 0
    v_mfma_f32_32x32x16_bf16 v[144:159], a[248:251], a[104:107], v[144:159]
    ds_read_b64_tr_b16 a[228:229], v235 offset:33792
    ds_read_b64_tr_b16 a[230:231], v235 offset:34048
    v_exp_f32 v135, v135
    v_add_f32 v227, v227, v180
    v_add_f32 v67, v67, v132
    v_exp_f32 v184, v184
    v_mfma_f32_32x32x16_bf16 v[144:159], a[252:255], a[108:111], v[144:159]
    ds_read_b64_tr_b16 a[232:233], v235 offset:34816
    ds_read_b64_tr_b16 a[234:235], v235 offset:35072
    buffer_load_dwordx4 v122, s[40:43], s85 offen offset:3072 lds
    v_exp_f32 v136, v136
    v_add_f32 v226, v226, v181
    v_add_f32 v66, v66, v133
    s_waitcnt lgkmcnt(6)
    v_mfma_f32_32x32x16_bf16 v[144:159], a[208:211], a[112:115], v[144:159]
    ds_read_b64_tr_b16 a[236:237], v235 offset:35840
    ds_read_b64_tr_b16 a[238:239], v235 offset:36096
    v_exp_f32 v185, v185
    v_exp_f32 v137, v137
    v_add_f32 v227, v227, v182
    v_add_f32 v67, v67, v134
    v_mfma_f32_32x32x16_bf16 v[144:159], a[212:215], a[116:119], v[144:159]
    ds_read_b64_tr_b16 a[240:241], v235 offset:36864
    ds_read_b64_tr_b16 a[242:243], v235 offset:37120
    v_lshlrev_b32 v113, 3, v230
    v_and_b32 v114, 0x1ff, v113
    v_and_b32 v113, 0x7ff, v113
    s_lshl_b32 s70, s2, 2
    s_add_u32 s70, s70, s3
    s_mul_i32 s0, s70, 1792
    s_lshl_b32 s72, s70, 9
    buffer_load_dword a172, v113, s[44:47], s0 offen
    buffer_load_dword a172, v114, s[48:51], s72 offen
    v_mfma_f32_32x32x16_bf16 v[144:159], a[216:219], a[120:123], v[144:159]
    ds_read_b64_tr_b16 a[244:245], v235 offset:37888
    ds_read_b64_tr_b16 a[246:247], v235 offset:38144
    v_exp_f32 v186, v186
    v_exp_f32 v138, v138
    v_add_f32 v226, v226, v183
    v_add_f32 v66, v66, v135
    v_mfma_f32_32x32x16_bf16 v[144:159], a[220:223], a[124:127], v[144:159]
    ds_read_b64_tr_b16 a[248:249], v235 offset:38912
    ds_read_b64_tr_b16 a[250:251], v235 offset:39168
    v_exp_f32 v187, v187
    v_exp_f32 v139, v139
    v_add_f32 v227, v227, v184
    s_waitcnt lgkmcnt(6)
    v_mfma_f32_32x32x16_bf16 v[160:175], a[224:227], a[0:3], 0
    ds_read_b64_tr_b16 a[252:253], v235 offset:39936
    ds_read_b64_tr_b16 a[254:255], v235 offset:40192
    v_add_f32 v67, v67, v136
    v_exp_f32 v188, v188
    v_exp_f32 v140, v140
    v_add_f32 v226, v226, v185
    v_mfma_f32_32x32x16_bf16 v[160:175], a[228:231], a[4:7], v[160:175]
    ds_read_b64_tr_b16 a[208:209], v235 offset:40960
    ds_read_b64_tr_b16 a[210:211], v235 offset:41216
    v_add_f32 v66, v66, v137
    v_exp_f32 v189, v189
    v_exp_f32 v141, v141
    v_mfma_f32_32x32x16_bf16 v[160:175], a[232:235], a[8:11], v[160:175]
    ds_read_b64_tr_b16 a[212:213], v235 offset:41984
    ds_read_b64_tr_b16 a[214:215], v235 offset:42240
    v_add_f32 v227, v227, v186
    v_add_f32 v67, v67, v138
    v_exp_f32 v190, v190
    v_exp_f32 v142, v142
    v_mfma_f32_32x32x16_bf16 v[160:175], a[236:239], a[12:15], v[160:175]
    ds_read_b64_tr_b16 a[216:217], v235 offset:43008
    ds_read_b64_tr_b16 a[218:219], v235 offset:43264
    v_lshlrev_b32 v113, 6, v230
    v_and_b32 v114, 0xfff, v113
    v_min_u32 v113, 13312, v113
    s_lshr_b32 s70, s2, 3
    s_lshl2_add_u32 s70, s70, s3
    s_mul_i32 s0, s70, 14336
    s_lshl_b32 s72, s70, 12
    buffer_load_dword a172, v113, s[44:47], s0 offen offset:384
    buffer_load_dword a172, v114, s[48:51], s72 offen offset:384
    s_waitcnt lgkmcnt(6)
    v_mfma_f32_32x32x16_bf16 v[160:175], a[240:243], a[16:19], v[160:175]
    ds_read_b64_tr_b16 a[220:221], v235 offset:44032
    ds_read_b64_tr_b16 a[222:223], v235 offset:44288
    v_add_f32 v226, v226, v187
    v_add_f32 v66, v66, v139
    v_exp_f32_e64 v191, v191
    v_exp_f32_e64 v143, v143
    v_mfma_f32_32x32x16_bf16 v[160:175], a[244:247], a[20:23], v[160:175]
    ds_read_b64_tr_b16 a[224:225], v235 offset:45056
    ds_read_b64_tr_b16 a[226:227], v235 offset:45312
    v_add_f32_e64 v227, v227, v188
    v_add_f32_e64 v67, v67, v140
    v_add_f32_e64 v226, v226, v189
    v_add_f32_e64 v66, v66, v141
    v_add_f32_e64 v227, v227, v190
    v_mfma_f32_32x32x16_bf16 v[160:175], a[248:251], a[24:27], v[160:175]
    ds_read_b64_tr_b16 a[228:229], v235 offset:46080
    ds_read_b64_tr_b16 a[230:231], v235 offset:46336
    v_add_f32_e64 v67, v67, v142
    v_add_f32_e64 v226, v226, v191
    v_add_f32_e64 v66, v66, v143
    v_cvt_pk_bf16_f32 v144, v144, v145
    v_cvt_pk_bf16_f32 v145, v146, v147
    v_cvt_pk_bf16_f32 v146, v148, v149
    v_mfma_f32_32x32x16_bf16 v[160:175], a[252:255], a[28:31], v[160:175]
    ds_read_b64_tr_b16 a[232:233], v235 offset:47104
    ds_read_b64_tr_b16 a[234:235], v235 offset:47360
    v_cvt_pk_bf16_f32 v147, v150, v151
    v_cvt_pk_bf16_f32 v148, v152, v153
    v_cvt_pk_bf16_f32 v149, v154, v155
    v_cvt_pk_bf16_f32 v150, v156, v157
    v_cvt_pk_bf16_f32 v151, v158, v159
    s_waitcnt lgkmcnt(6)
    v_mfma_f32_32x32x16_bf16 v[160:175], a[208:211], a[32:35], v[160:175]
    ds_read_b64_tr_b16 a[236:237], v235 offset:48128
    ds_read_b64_tr_b16 a[238:239], v235 offset:48384
    v_add_f32 v226, v226, v227
    v_add_f32_e64 v66, v66, v67
    v_rcp_f32_e64 v226, v226
    v_rcp_f32 v66, v66
    v_mfma_f32_32x32x16_bf16 v[160:175], a[212:215], a[36:39], v[160:175]
    ds_read_b64_tr_b16 a[240:241], v235 offset:49152
    ds_read_b64_tr_b16 a[242:243], v235 offset:49408
    s_add_u32 m0, s74, 102400
    s_add_u32 s85, s27, 114688
    buffer_load_dwordx4 v231, s[40:43], s85 offen offset:0 lds
    ds_write_b64 v247, v[144:145] offset:0
    s_add_u32 s81, s81, s77
    v_mfma_f32_32x32x16_bf16 v[160:175], a[216:219], a[40:43], v[160:175]
    ds_read_b64_tr_b16 a[244:245], v235 offset:50176
    ds_read_b64_tr_b16 a[246:247], v235 offset:50432
    v_mul_f32_e64 v176, v176, v226
    v_mul_f32_e64 v128, v128, v66
    v_mul_f32_e64 v177, v177, v226
    v_mul_f32_e64 v129, v129, v66
    ds_write_b64 v247, v[146:147] offset:2176
    s_mul_i32 s19, s86, 2176
    v_mfma_f32_32x32x16_bf16 v[160:175], a[220:223], a[44:47], v[160:175]
    ds_read_b64_tr_b16 a[248:249], v235 offset:51200
    ds_read_b64_tr_b16 a[250:251], v235 offset:51456
    v_mul_f32_e64 v178, v178, v226
    v_mul_f32_e64 v130, v130, v66
    v_mul_f32_e64 v179, v179, v226
    v_mul_f32_e64 v131, v131, v66
    ds_write_b64 v247, v[148:149] offset:4352
    s_waitcnt lgkmcnt(9)
    v_mfma_f32_32x32x16_bf16 v[160:175], a[224:227], a[48:51], v[160:175]
    ds_read_b64_tr_b16 a[252:253], v235 offset:52224
    ds_read_b64_tr_b16 a[254:255], v235 offset:52480
    buffer_load_dwordx4 v120, s[40:43], s85 offen offset:1024 lds
    s_add_u32 s16, s19, s17
    s_lshl_b32 s18, s5, 11
    s_add_u32 s18, s18, s77
    s_add_u32 s18, s18, 114688
    s_mul_i32 vcc_lo, s30, 294912
    v_mfma_f32_32x32x16_bf16 v[160:175], a[228:231], a[52:55], v[160:175]
    ds_read_b64_tr_b16 a[208:209], v235 offset:53248
    ds_read_b64_tr_b16 a[210:211], v235 offset:53504
    v_cvt_pk_bf16_f32 v208, v176, v177
    v_cvt_pk_bf16_f32 v72, v128, v129
    v_mul_f32_e64 v180, v180, v226
    v_mul_f32_e64 v132, v132, v66
    ds_write_b64 v247, v[150:151] offset:6528
    v_mfma_f32_32x32x16_bf16 v[160:175], a[232:235], a[56:59], v[160:175]
    ds_read_b64_tr_b16 a[212:213], v235 offset:54272
    ds_read_b64_tr_b16 a[214:215], v235 offset:54528
    s_mul_i32 s23, s3, 28672
    s_add_u32 s82, vcc_lo, s23
    s_mul_i32 vcc_hi, s86, 147456
    s_sub_u32 s21, s82, vcc_hi
    s_add_u32 s21, s21, 147456
    s_add_u32 s82, s82, vcc_hi
    v_mfma_f32_32x32x16_bf16 v[160:175], a[236:239], a[60:63], v[160:175]
    ds_read_b64_tr_b16 a[216:217], v235 offset:55296
    ds_read_b64_tr_b16 a[218:219], v235 offset:55552
    buffer_load_dwordx4 v121, s[40:43], s85 offen offset:2048 lds
    v_mul_f32 v181, v181, v226
    v_mul_f32 v133, v133, v66
    v_cvt_pk_bf16_f32 v209, v178, v179
    v_cvt_pk_bf16_f32 v73, v130, v131
    v_mul_f32 v182, v182, v226
    v_mul_f32 v134, v134, v66
    v_mul_f32 v183, v183, v226
    v_mul_f32 v135, v135, v66
    v_cvt_pk_bf16_f32 v210, v180, v181
    v_cvt_pk_bf16_f32 v74, v132, v133
    v_mul_f32 v184, v184, v226
    v_mul_f32 v136, v136, v66
    v_mul_f32 v185, v185, v226
    v_mul_f32 v137, v137, v66
    v_cvt_pk_bf16_f32 v211, v182, v183
    v_cvt_pk_bf16_f32 v75, v134, v135
    v_mul_f32 v186, v186, v226
    v_mul_f32 v138, v138, v66
    v_mul_f32 v187, v187, v226
    v_mul_f32 v139, v139, v66
    v_cvt_pk_bf16_f32 v212, v184, v185
    v_cvt_pk_bf16_f32 v76, v136, v137
    v_mul_f32 v188, v188, v226
    v_mul_f32 v140, v140, v66
    v_mul_f32 v189, v189, v226
    v_mul_f32 v141, v141, v66
    v_cvt_pk_bf16_f32 v213, v186, v187
    v_cvt_pk_bf16_f32 v77, v138, v139
    v_mul_f32 v190, v190, v226
    v_mul_f32_e64 v142, v142, v66
    v_mul_f32_e64 v191, v191, v226
    v_mul_f32_e64 v143, v143, v66
    v_cvt_pk_bf16_f32 v214, v188, v189
    v_cvt_pk_bf16_f32 v78, v140, v141
    v_cvt_pk_bf16_f32 v215, v190, v191
    v_cvt_pk_bf16_f32 v79, v142, v143
    ds_write_b64 v246, v[208:209] offset:0
    ds_write_b64 v246, v[72:73] offset:8704
    ds_write_b64 v246, v[210:211] offset:1088
    ds_write_b64 v246, v[74:75] offset:9792
    ds_write_b64 v246, v[212:213] offset:2176
    ds_write_b64 v246, v[76:77] offset:10880
    ds_write_b64 v246, v[214:215] offset:3264
    ds_write_b64 v246, v[78:79] offset:11968
    s_waitcnt lgkmcnt(0)
    s_waitcnt vmcnt(13)
    s_barrier
    v_mfma_f32_32x32x16_bf16 v[160:175], a[240:243], a[64:67], v[160:175]
    ds_read_b64_tr_b16 a[220:221], v235 offset:56320
    ds_read_b64_tr_b16 a[222:223], v235 offset:56576
    v_lshrrev_b32 v152, 6, v230
    v_bfe_u32 v153, v230, 4, 2
    v_lshlrev_b32_e64 v153, 3, v153
    v_lshl_add_u32 v152, v152, 7, v153
    s_add_u32 s71, s13, 32768
    buffer_load_dwordx2 v[154:155], v152, s[52:55], s71 offen sc1
    v_mfma_f32_32x32x16_bf16 v[160:175], a[244:247], a[68:71], v[160:175]
    ds_read_b64_tr_b16 a[224:225], v235 offset:57344
    ds_read_b64_tr_b16 a[226:227], v235 offset:57600
    ds_read_b64_tr_b16 a[176:177], v248 offset:0
    ds_read_b64_tr_b16 a[192:193], v249 offset:0
    v_and_b32 v156, 0x100, v230
    v_mfma_f32_32x32x16_bf16 v[160:175], a[248:251], a[72:75], v[160:175]
    ds_read_b64_tr_b16 a[228:229], v235 offset:58368
    ds_read_b64_tr_b16 a[230:231], v235 offset:58624
    ds_read_b64_tr_b16 a[178:179], v248 offset:128
    ds_read_b64_tr_b16 a[194:195], v249 offset:128
    v_xor_b32 v246, 65536, v235
    v_lshl_add_u32 v246, v156, 6, v246
    v_mfma_f32_32x32x16_bf16 v[160:175], a[252:255], a[76:79], v[160:175]
    ds_read_b64_tr_b16 a[232:233], v235 offset:59392
    ds_read_b64_tr_b16 a[234:235], v235 offset:59648
    buffer_load_dwordx4 v122, s[40:43], s85 offen offset:3072 lds
    ds_read_b64_tr_b16 a[180:181], v248 offset:256
    ds_read_b64_tr_b16 a[196:197], v249 offset:256
    s_waitcnt lgkmcnt(12)
    v_mfma_f32_32x32x16_bf16 v[160:175], a[208:211], a[80:83], v[160:175]
    ds_read_b64_tr_b16 a[236:237], v235 offset:60416
    ds_read_b64_tr_b16 a[238:239], v235 offset:60672
    v_xor_b32 v247, 32, v246
    v_lshrrev_b32_e64 v156, 9, v230
    v_bfe_u32 v157, v230, 6, 2
    v_lshl_add_u32 v156, v156, 2, v157
    v_mfma_f32_32x32x16_bf16 v[160:175], a[212:215], a[84:87], v[160:175]
    ds_read_b64_tr_b16 a[240:241], v235 offset:61440
    ds_read_b64_tr_b16 a[242:243], v235 offset:61696
    s_add_u32 m0, s74, 0
    s_add_u32 s85, s28, 0
    buffer_load_dwordx4 v231, s[40:43], s85 offen offset:0 lds
    v_mfma_f32_32x32x16_bf16 v[160:175], a[216:219], a[88:91], v[160:175]
    ds_read_b64_tr_b16 a[244:245], v235 offset:62464
    ds_read_b64_tr_b16 a[246:247], v235 offset:62720
    ds_read_b64_tr_b16 a[182:183], v248 offset:384
    ds_read_b64_tr_b16 a[198:199], v249 offset:384
    v_lshlrev_b32_e64 v156, 7, v156
    v_lshrrev_b32_e64 v157, 1, v157
    v_mfma_f32_32x32x16_bf16 v[160:175], a[220:223], a[92:95], v[160:175]
    ds_read_b64_tr_b16 a[248:249], v235 offset:63488
    ds_read_b64_tr_b16 a[250:251], v235 offset:63744
    ds_read_b64_tr_b16 a[184:185], v248 offset:512
    ds_read_b64_tr_b16 a[200:201], v249 offset:512
    v_lshl_add_u32 v156, v157, 6, v156
    s_waitcnt lgkmcnt(10)
    v_mfma_f32_32x32x16_bf16 v[160:175], a[224:227], a[96:99], v[160:175]
    s_nop 0
    ds_read_b64_tr_b16 a[252:253], v235 offset:64512
    ds_read_b64_tr_b16 a[254:255], v235 offset:64768
    buffer_load_dwordx4 v120, s[40:43], s85 offen offset:1024 lds
    ds_read_b64_tr_b16 a[186:187], v248 offset:640
    ds_read_b64_tr_b16 a[202:203], v249 offset:640
    v_bfe_u32 v157, v230, 8, 1
    v_mfma_f32_32x32x16_bf16 v[160:175], a[228:231], a[100:103], v[160:175]
    ds_read_b64_tr_b16 a[208:209], v240 offset:0
    ds_read_b64_tr_b16 a[210:211], v240 offset:512
    ds_read_b64_tr_b16 a[188:189], v248 offset:768
    ds_read_b64_tr_b16 a[204:205], v249 offset:768
    v_lshl_add_u32 v156, v157, 5, v156
    v_mfma_f32_32x32x16_bf16 v[160:175], a[232:235], a[104:107], v[160:175]
    ds_read_b64_tr_b16 a[212:213], v241 offset:0
    ds_read_b64_tr_b16 a[214:215], v241 offset:512
    ds_read_b64_tr_b16 a[190:191], v248 offset:896
    ds_read_b64_tr_b16 a[206:207], v249 offset:896
    v_bfe_u32 v157, v230, 4, 2
    v_lshl_add_u32 v156, v157, 3, v156
    v_mfma_f32_32x32x16_bf16 v[160:175], a[236:239], a[108:111], v[160:175]
    ds_read_b64_tr_b16 a[216:217], v242 offset:0
    ds_read_b64_tr_b16 a[218:219], v242 offset:512
    buffer_load_dwordx4 v121, s[40:43], s85 offen offset:2048 lds
    s_nop 0
    v_mfma_f32_16x16x32_bf16 a[164:167], a[192:195], a[176:179], 0
    s_waitcnt lgkmcnt(12)
    v_mfma_f32_32x32x16_bf16 v[160:175], a[240:243], a[112:115], v[160:175]
    ds_read_b64_tr_b16 a[220:221], v243 offset:0
    ds_read_b64_tr_b16 a[222:223], v243 offset:512
    v_mfma_f32_16x16x32_bf16 a[168:171], a[160:163], a[176:179], 0
    v_mfma_f32_32x32x16_bf16 v[160:175], a[244:247], a[116:119], v[160:175]
    ds_read_b64_tr_b16 a[224:225], v240 offset:2048
    ds_read_b64_tr_b16 a[226:227], v240 offset:2560
    v_mfma_f32_16x16x32_bf16 a[164:167], a[196:199], a[180:183], a[164:167]
    v_mfma_f32_32x32x16_bf16 v[160:175], a[248:251], a[120:123], v[160:175]
    ds_read_b64_tr_b16 a[228:229], v241 offset:2048
    ds_read_b64_tr_b16 a[230:231], v241 offset:2560
    buffer_load_dwordx4 v122, s[40:43], s85 offen offset:3072 lds
    v_mfma_f32_16x16x32_bf16 a[168:171], a[160:163], a[180:183], a[168:171]
    s_waitcnt lgkmcnt(15)
    v_mfma_f32_32x32x16_bf16 v[160:175], a[252:255], a[124:127], v[160:175]
    s_nop 0
    ds_read_b64_tr_b16 a[232:233], v242 offset:2048
    ds_read_b64_tr_b16 a[234:235], v242 offset:2560
    v_mfma_f32_16x16x32_bf16 a[164:167], a[200:203], a[184:187], a[164:167]
    s_waitcnt lgkmcnt(6)
    v_mfma_f32_32x32x16_bf16 v[0:15], a[208:211], a[0:3], 0
    ds_read_b64_tr_b16 a[236:237], v243 offset:2048
    ds_read_b64_tr_b16 a[238:239], v243 offset:2560
    s_nop 0
    v_mfma_f32_16x16x32_bf16 a[168:171], a[160:163], a[184:187], a[168:171]
    s_lshl_b32 s23, s3, 13
    s_add_u32 s83, vcc_lo, s23
    s_add_u32 s83, s83, 114688
    s_sub_u32 s22, s83, vcc_hi
    s_add_u32 s22, s22, 147456
    s_add_u32 s83, s83, vcc_hi
    s_lshl2_add_u32 vcc_hi, s30, s3
    s_lshl_b32 vcc_hi, vcc_hi, 7
    s_add_u32 s8, vcc_hi, 10813440
    s_add_u32 s9, vcc_hi, 10829824
    s_lshl_b32 vcc_lo, s30, 1
    s_add_u32 vcc_lo, vcc_lo, s86
    s_lshl_b32 vcc_lo, vcc_lo, 15
    s_lshl_b32 vcc_hi, s31, 7
    s_add_u32 vcc_lo, vcc_lo, vcc_hi
    s_and_b32 s19, s3, 1
    s_lshl_b32 s23, s19, 6
    s_add_u32 s10, vcc_lo, s23
    s_add_u32 s24, s15, 16384
    s_mov_b32 s11, s86
    s_mov_b32 s6, s2
    v_mfma_f32_32x32x16_bf16 v[16:31], a[212:215], a[0:3], 0
    ds_read_b64_tr_b16 a[240:241], v240 offset:4096
    ds_read_b64_tr_b16 a[242:243], v240 offset:4608
    s_add_u32 m0, s74, 4096
    s_add_u32 s85, s28, 114688
    buffer_load_dwordx4 v231, s[40:43], s85 offen offset:0 lds
    v_mfma_f32_32x32x16_bf16 v[32:47], a[216:219], a[0:3], 0
    ds_read_b64_tr_b16 a[244:245], v241 offset:4096
    ds_read_b64_tr_b16 a[246:247], v241 offset:4608
    v_mfma_f32_16x16x32_bf16 a[164:167], a[204:207], a[188:191], a[164:167]
    v_mfma_f32_32x32x16_bf16 v[48:63], a[220:223], a[0:3], 0
    ds_read_b64_tr_b16 a[248:249], v242 offset:4096
    ds_read_b64_tr_b16 a[250:251], v242 offset:4608
    v_mfma_f32_16x16x32_bf16 a[168:171], a[160:163], a[188:191], a[168:171]
    s_waitcnt lgkmcnt(6)
    v_mfma_f32_32x32x16_bf16 v[0:15], a[224:227], a[4:7], v[0:15]
    ds_read_b64_tr_b16 a[252:253], v243 offset:4096
    ds_read_b64_tr_b16 a[254:255], v243 offset:4608
    buffer_load_dwordx4 v120, s[40:43], s85 offen offset:1024 lds
    s_waitcnt vmcnt(7)
    v_cmp_eq_u64 vcc, s[68:69], v[154:155]
    s_mov_b32 s7, 0
    s_cmp_eq_u64 vcc, exec
    s_cbranch_scc1 L_pok_12
L_plp_13:
    buffer_load_dwordx2 v[154:155], v152, s[52:55], s71 offen sc1
    s_waitcnt vmcnt(0)
    v_cmp_eq_u64 vcc, s[68:69], v[154:155]
    s_add_u32 s7, s7, 1
    s_cmp_gt_u32 s7, 0x40000
    s_cbranch_scc1 L_pok_12
    s_cmp_eq_u64 vcc, exec
    s_cbranch_scc0 L_plp_13
L_pok_12:
    v_mfma_f32_32x32x16_bf16 v[16:31], a[228:231], a[4:7], v[16:31]
    ds_read_b64_tr_b16 a[208:209], v240 offset:6144
    ds_read_b64_tr_b16 a[210:211], v240 offset:6656
    buffer_atomic_add_f32 a164, v250, s[52:55], s16 offen offset:0 sc1
    s_and_b32 s70, s3, 1
    s_lshl_b32 s70, s70, 6
    v_xor_b32_e64 v156, s70, v156
    v_mfma_f32_32x32x16_bf16 v[32:47], a[232:235], a[4:7], v[32:47]
    ds_read_b64_tr_b16 a[212:213], v241 offset:6144
    ds_read_b64_tr_b16 a[214:215], v241 offset:6656
    buffer_atomic_add_f32 a165, v250, s[52:55], s16 offen offset:64 sc1
    s_add_u32 s70, s74, 131072
    v_add_u32 v254, s70, v156
    v_xor_b32_e64 v255, 64, v254
    v_mfma_f32_32x32x16_bf16 v[48:63], a[236:239], a[4:7], v[48:63]
    ds_read_b64_tr_b16 a[216:217], v242 offset:6144
    ds_read_b64_tr_b16 a[218:219], v242 offset:6656
    buffer_atomic_add_f32 a166, v250, s[52:55], s16 offen offset:128 sc1
    s_mov_b32 s86, s68
    s_mov_b32 s87, s68
    s_waitcnt lgkmcnt(6)
    v_mfma_f32_32x32x16_bf16 v[0:15], a[240:243], a[8:11], v[0:15]
    ds_read_b64_tr_b16 a[220:221], v243 offset:6144
    ds_read_b64_tr_b16 a[222:223], v243 offset:6656
    buffer_atomic_add_f32 a167, v250, s[52:55], s16 offen offset:192 sc1
    v_subrev_u32 v248, 131072, v254
    v_subrev_u32 v249, 131072, v255
    v_cvt_pk_bf16_f32 v208, v160, v161
    v_mfma_f32_32x32x16_bf16 v[16:31], a[244:247], a[8:11], v[16:31]
    ds_read_b64_tr_b16 a[224:225], v240 offset:8192
    ds_read_b64_tr_b16 a[226:227], v240 offset:8704
    s_mov_b64 exec, 0xffff
    buffer_atomic_add_f32 a168, v250, s[52:55], s16 offen offset:1024 sc1
    s_mov_b64 exec, -1
    v_mfma_f32_32x32x16_bf16 v[32:47], a[248:251], a[8:11], v[32:47]
    ds_read_b64_tr_b16 a[228:229], v241 offset:8192
    s_nop 0
    ds_read_b64_tr_b16 a[230:231], v241 offset:8704
    v_cvt_pk_bf16_f32 v209, v162, v163
    v_cvt_pk_bf16_f32 v210, v164, v165
    v_cvt_pk_bf16_f32 v211, v166, v167
    v_cvt_pk_bf16_f32 v212, v168, v169
    v_mfma_f32_32x32x16_bf16 v[48:63], a[252:255], a[8:11], v[48:63]
    ds_read_b64_tr_b16 a[232:233], v242 offset:8192
    ds_read_b64_tr_b16 a[234:235], v242 offset:8704
    buffer_load_dwordx4 v121, s[40:43], s85 offen offset:2048 lds
    v_cvt_pk_bf16_f32 v213, v170, v171
    v_cvt_pk_bf16_f32 v214, v172, v173
    s_waitcnt lgkmcnt(6)
    v_mfma_f32_32x32x16_bf16 v[0:15], a[208:211], a[12:15], v[0:15]
    ds_read_b64_tr_b16 a[236:237], v243 offset:8192
    ds_read_b64_tr_b16 a[238:239], v243 offset:8704
    v_cvt_pk_bf16_f32 v215, v174, v175
    s_nop 0
    v_mfma_f32_32x32x16_bf16 v[176:191], v[216:219], v[208:211], 0
    v_mfma_f32_32x32x16_bf16 v[16:31], a[212:215], a[12:15], v[16:31]
    ds_read_b64_tr_b16 a[240:241], v240 offset:10240
    ds_read_b64_tr_b16 a[242:243], v240 offset:10752
    v_mfma_f32_32x32x16_bf16 v[128:143], v[220:223], v[212:215], 0
    v_mfma_f32_32x32x16_bf16 v[32:47], a[216:219], a[12:15], v[32:47]
    ds_read_b64_tr_b16 a[244:245], v241 offset:10240
    ds_read_b64_tr_b16 a[246:247], v241 offset:10752
    buffer_load_dwordx4 v122, s[40:43], s85 offen offset:3072 lds
    v_mfma_f32_32x32x16_bf16 v[48:63], a[220:223], a[12:15], v[48:63]
    ds_read_b64_tr_b16 a[248:249], v242 offset:10240
    ds_read_b64_tr_b16 a[250:251], v242 offset:10752
    s_nop 0
    v_max3_f32 v224, v176, v177, v178
    s_nop 2
    v_max3_f32 v156, v128, v129, v130
    v_max3_f32 v225, v179, v180, v181
    s_waitcnt vmcnt(13)
    s_barrier
    s_waitcnt lgkmcnt(6)
    v_mfma_f32_32x32x16_bf16 v[0:15], a[224:227], a[16:19], v[0:15]
    ds_read_b64_tr_b16 a[252:253], v243 offset:10240
    ds_read_b64_tr_b16 a[254:255], v243 offset:10752
    s_add_u32 m0, s74, 131072
    s_add_u32 s23, s78, 0
    buffer_load_dwordx4 v233, s[44:47], s23 offen offset:0 lds
    v_max3_f32 v157, v131, v132, v133
    v_mfma_f32_32x32x16_bf16 v[16:31], a[228:231], a[16:19], v[16:31]
    ds_read_b64_tr_b16 a[208:209], v240 offset:12288
    ds_read_b64_tr_b16 a[210:211], v240 offset:12800
    v_max3_f32 v224, v224, v182, v183
    v_max3_f32 v156, v156, v134, v135
    v_max3_f32 v225, v225, v184, v185
    v_mfma_f32_32x32x16_bf16 v[32:47], a[232:235], a[16:19], v[32:47]
    ds_read_b64_tr_b16 a[212:213], v241 offset:12288
    ds_read_b64_tr_b16 a[214:215], v241 offset:12800
    buffer_load_dwordx4 v123, s[44:47], s23 offen offset:1024 lds
    v_max3_f32 v157, v157, v136, v137
    v_max3_f32 v224, v224, v186, v187
    v_max3_f32 v156, v156, v138, v139
    v_mfma_f32_32x32x16_bf16 v[48:63], a[236:239], a[16:19], v[48:63]
    ds_read_b64_tr_b16 a[216:217], v242 offset:12288
    ds_read_b64_tr_b16 a[218:219], v242 offset:12800
    v_max3_f32 v225, v225, v188, v189
    v_max3_f32 v157, v157, v140, v141
    v_max3_f32 v224, v224, v190, v191
    s_waitcnt lgkmcnt(6)
    v_mfma_f32_32x32x16_bf16 v[0:15], a[240:243], a[20:23], v[0:15]
    ds_read_b64_tr_b16 a[220:221], v243 offset:12288
    ds_read_b64_tr_b16 a[222:223], v243 offset:12800
    buffer_load_dwordx4 v124, s[44:47], s23 offen offset:2048 lds
    v_max3_f32 v156, v156, v142, v143
    v_max_f32 v224, v224, v225
    v_max_f32_e64 v156, v156, v157
    v_mfma_f32_32x32x16_bf16 v[16:31], a[244:247], a[20:23], v[16:31]
    ds_read_b64_tr_b16 a[224:225], v240 offset:14336
    ds_read_b64_tr_b16 a[226:227], v240 offset:14848
    v_mul_f32 v225, 0xbfb8aa3b, v224
    v_mul_f32 v157, 0xbfb8aa3b, v156
    v_fma_f32 v176, v176, s73, v225
    v_mfma_f32_32x32x16_bf16 v[32:47], a[248:251], a[20:23], v[32:47]
    ds_read_b64_tr_b16 a[228:229], v241 offset:14336
    ds_read_b64_tr_b16 a[230:231], v241 offset:14848
    buffer_load_dwordx4 v125, s[44:47], s23 offen offset:3072 lds
    v_fma_f32 v128, v128, s73, v157
    v_fma_f32 v177, v177, s73, v225
    v_fma_f32 v129, v129, s73, v157
    v_mfma_f32_32x32x16_bf16 v[48:63], a[252:255], a[20:23], v[48:63]
    ds_read_b64_tr_b16 a[232:233], v242 offset:14336
    ds_read_b64_tr_b16 a[234:235], v242 offset:14848
    v_fma_f32 v178, v178, s73, v225
    v_fma_f32 v130, v130, s73, v157
    v_fma_f32 v179, v179, s73, v225
    s_waitcnt lgkmcnt(6)
    v_mfma_f32_32x32x16_bf16 v[0:15], a[208:211], a[24:27], v[0:15]
    ds_read_b64_tr_b16 a[236:237], v243 offset:14336
    s_nop 0
    ds_read_b64_tr_b16 a[238:239], v243 offset:14848
    s_add_u32 m0, s74, 135168
    s_add_u32 s23, s78, 32768
    buffer_load_dwordx4 v233, s[44:47], s23 offen offset:0 lds
    v_fma_f32 v131, v131, s73, v157
    v_mfma_f32_32x32x16_bf16 v[16:31], a[212:215], a[24:27], v[16:31]
    ds_read_b64_tr_b16 a[240:241], v240 offset:32768
    ds_read_b64_tr_b16 a[242:243], v240 offset:33280
    v_fma_f32 v180, v180, s73, v225
    v_fma_f32 v132, v132, s73, v157
    v_fma_f32 v181, v181, s73, v225
    v_mfma_f32_32x32x16_bf16 v[32:47], a[216:219], a[24:27], v[32:47]
    ds_read_b64_tr_b16 a[244:245], v241 offset:32768
    ds_read_b64_tr_b16 a[246:247], v241 offset:33280
    buffer_load_dwordx4 v123, s[44:47], s23 offen offset:1024 lds
    v_fma_f32 v133, v133, s73, v157
    v_fma_f32 v182, v182, s73, v225
    v_fma_f32 v134, v134, s73, v157
    v_mfma_f32_32x32x16_bf16 v[48:63], a[220:223], a[24:27], v[48:63]
    ds_read_b64_tr_b16 a[248:249], v242 offset:32768
    ds_read_b64_tr_b16 a[250:251], v242 offset:33280
    v_fma_f32 v183, v183, s73, v225
    v_fma_f32 v135, v135, s73, v157
    s_nop 0
    v_fma_f32 v184, v184, s73, v225
    s_waitcnt lgkmcnt(6)
    v_mfma_f32_32x32x16_bf16 v[0:15], a[224:227], a[28:31], v[0:15]
    ds_read_b64_tr_b16 a[252:253], v243 offset:32768
    ds_read_b64_tr_b16 a[254:255], v243 offset:33280
    buffer_load_dwordx4 v124, s[44:47], s23 offen offset:2048 lds
    v_fma_f32 v136, v136, s73, v157
    v_fma_f32 v185, v185, s73, v225
    v_fma_f32 v137, v137, s73, v157
    v_mfma_f32_32x32x16_bf16 v[16:31], a[228:231], a[28:31], v[16:31]
    ds_read_b64_tr_b16 a[208:209], v240 offset:34816
    ds_read_b64_tr_b16 a[210:211], v240 offset:35328
    v_fma_f32 v186, v186, s73, v225
    v_fma_f32 v138, v138, s73, v157
    v_fma_f32 v187, v187, s73, v225
    v_mfma_f32_32x32x16_bf16 v[32:47], a[232:235], a[28:31], v[32:47]
    ds_read_b64_tr_b16 a[212:213], v241 offset:34816
    ds_read_b64_tr_b16 a[214:215], v241 offset:35328
    buffer_load_dwordx4 v125, s[44:47], s23 offen offset:3072 lds
    v_fma_f32 v139, v139, s73, v157
    v_fma_f32 v188, v188, s73, v225
    v_fma_f32 v140, v140, s73, v157
    v_mfma_f32_32x32x16_bf16 v[48:63], a[236:239], a[28:31], v[48:63]
    ds_read_b64_tr_b16 a[216:217], v242 offset:34816
    ds_read_b64_tr_b16 a[218:219], v242 offset:35328
    v_fma_f32 v189, v189, s73, v225
    v_fma_f32 v141, v141, s73, v157
    v_fma_f32 v190, v190, s73, v225
    s_waitcnt lgkmcnt(6)
    v_mfma_f32_32x32x16_bf16 v[0:15], a[240:243], a[32:35], v[0:15]
    ds_read_b64_tr_b16 a[220:221], v243 offset:34816
    ds_read_b64_tr_b16 a[222:223], v243 offset:35328
    s_add_u32 m0, s74, 32768
    s_add_u32 s85, s29, 0
    buffer_load_dwordx4 v231, s[40:43], s85 offen offset:0 lds
    v_fma_f32 v142, v142, s73, v157
    v_mfma_f32_32x32x16_bf16 v[16:31], a[244:247], a[32:35], v[16:31]
    ds_read_b64_tr_b16 a[224:225], v240 offset:36864
    ds_read_b64_tr_b16 a[226:227], v240 offset:37376
    v_fma_f32 v191, v191, s73, v225
    v_fma_f32 v143, v143, s73, v157
    v_mfma_f32_32x32x16_bf16 v[32:47], a[248:251], a[32:35], v[32:47]
    ds_read_b64_tr_b16 a[228:229], v241 offset:36864
    ds_read_b64_tr_b16 a[230:231], v241 offset:37376
    v_exp_f32 v176, v176
    v_exp_f32 v128, v128
    v_mfma_f32_32x32x16_bf16 v[48:63], a[252:255], a[32:35], v[48:63]
    ds_read_b64_tr_b16 a[232:233], v242 offset:36864
    ds_read_b64_tr_b16 a[234:235], v242 offset:37376
    buffer_load_dwordx4 v120, s[40:43], s85 offen offset:1024 lds
    v_exp_f32 v177, v177
    s_waitcnt lgkmcnt(6)
    v_mfma_f32_32x32x16_bf16 v[0:15], a[208:211], a[36:39], v[0:15]
    ds_read_b64_tr_b16 a[236:237], v243 offset:36864
    ds_read_b64_tr_b16 a[238:239], v243 offset:37376
    v_exp_f32 v129, v129
    v_exp_f32 v178, v178
    v_mfma_f32_32x32x16_bf16 v[16:31], a[212:215], a[36:39], v[16:31]
    ds_read_b64_tr_b16 a[240:241], v240 offset:38912
    ds_read_b64_tr_b16 a[242:243], v240 offset:39424
    v_exp_f32_e64 v130, v130
    v_mfma_f32_32x32x16_bf16 v[32:47], a[216:219], a[36:39], v[32:47]
    ds_read_b64_tr_b16 a[244:245], v241 offset:38912
    ds_read_b64_tr_b16 a[246:247], v241 offset:39424
    buffer_load_dwordx4 v121, s[40:43], s85 offen offset:2048 lds
    v_exp_f32 v179, v179
    v_mfma_f32_32x32x16_bf16 v[48:63], a[220:223], a[36:39], v[48:63]
    ds_read_b64_tr_b16 a[248:249], v242 offset:38912
    ds_read_b64_tr_b16 a[250:251], v242 offset:39424
    v_exp_f32_e64 v131, v131
    s_waitcnt lgkmcnt(6)
    v_mfma_f32_32x32x16_bf16 v[0:15], a[224:227], a[40:43], v[0:15]
    ds_read_b64_tr_b16 a[252:253], v243 offset:38912
    ds_read_b64_tr_b16 a[254:255], v243 offset:39424
    v_exp_f32 v180, v180
    v_exp_f32 v132, v132
    v_mfma_f32_32x32x16_bf16 v[16:31], a[228:231], a[40:43], v[16:31]
    ds_read_b64_tr_b16 a[208:209], v240 offset:40960
    ds_read_b64_tr_b16 a[210:211], v240 offset:41472
    buffer_load_dwordx4 v122, s[40:43], s85 offen offset:3072 lds
    v_add_f32 v226, v176, v177
    v_add_f32 v158, v128, v129
    v_mfma_f32_32x32x16_bf16 v[32:47], a[232:235], a[40:43], v[32:47]
    ds_read_b64_tr_b16 a[212:213], v241 offset:40960
    ds_read_b64_tr_b16 a[214:215], v241 offset:41472
    v_exp_f32 v181, v181
    v_exp_f32 v133, v133
    v_mfma_f32_32x32x16_bf16 v[48:63], a[236:239], a[40:43], v[48:63]
    ds_read_b64_tr_b16 a[216:217], v242 offset:40960
    ds_read_b64_tr_b16 a[218:219], v242 offset:41472
    v_exp_f32 v182, v182
    s_waitcnt lgkmcnt(6)
    v_mfma_f32_32x32x16_bf16 v[0:15], a[240:243], a[44:47], v[0:15]
    ds_read_b64_tr_b16 a[220:221], v243 offset:40960
    ds_read_b64_tr_b16 a[222:223], v243 offset:41472
    s_add_u32 m0, s74, 36864
    s_add_u32 s85, s29, 114688
    buffer_load_dwordx4 v231, s[40:43], s85 offen offset:0 lds
    v_mfma_f32_32x32x16_bf16 v[16:31], a[244:247], a[44:47], v[16:31]
    ds_read_b64_tr_b16 a[224:225], v240 offset:43008
    ds_read_b64_tr_b16 a[226:227], v240 offset:43520
    v_exp_f32 v134, v134
    v_add_f32 v227, v178, v179
    v_mfma_f32_32x32x16_bf16 v[32:47], a[248:251], a[44:47], v[32:47]
    ds_read_b64_tr_b16 a[228:229], v241 offset:43008
    ds_read_b64_tr_b16 a[230:231], v241 offset:43520
    v_add_f32_e64 v159, v130, v131
    v_exp_f32_e64 v183, v183
    v_mfma_f32_32x32x16_bf16 v[48:63], a[252:255], a[44:47], v[48:63]
    ds_read_b64_tr_b16 a[232:233], v242 offset:43008
    ds_read_b64_tr_b16 a[234:235], v242 offset:43520
    buffer_load_dwordx4 v120, s[40:43], s85 offen offset:1024 lds
    v_exp_f32 v135, v135
    s_waitcnt vmcnt(14)
    s_barrier
    s_waitcnt lgkmcnt(6)
    v_mfma_f32_32x32x16_bf16 v[0:15], a[208:211], a[48:51], v[0:15]
    ds_read_b64_tr_b16 a[236:237], v243 offset:43008
    ds_read_b64_tr_b16 a[238:239], v243 offset:43520
    s_waitcnt vmcnt(6)
    ds_read_b64_tr_b16 a[128:129], v254 offset:0
    ds_read_b64_tr_b16 a[130:131], v254 offset:1024
    v_add_f32 v227, v227, v180
    v_mfma_f32_32x32x16_bf16 v[16:31], a[212:215], a[48:51], v[16:31]
    ds_read_b64_tr_b16 a[240:241], v240 offset:45056
    ds_read_b64_tr_b16 a[242:243], v240 offset:45568
    v_mov_b32_e64 v228, s68
    v_mov_b32_e64 v229, s69
    buffer_store_dwordx2 v[228:229], off, s[52:55], s12 sc1
    v_mfma_f32_32x32x16_bf16 v[32:47], a[216:219], a[48:51], v[32:47]
    ds_read_b64_tr_b16 a[244:245], v241 offset:45056
    ds_read_b64_tr_b16 a[246:247], v241 offset:45568
    buffer_load_dwordx4 v121, s[40:43], s85 offen offset:2048 lds
    ds_read_b64_tr_b16 a[132:133], v255 offset:0
    ds_read_b64_tr_b16 a[134:135], v255 offset:1024
    v_add_f32 v159, v159, v132
    v_mfma_f32_32x32x16_bf16 v[48:63], a[220:223], a[48:51], v[48:63]
    ds_read_b64_tr_b16 a[248:249], v242 offset:45056
    ds_read_b64_tr_b16 a[250:251], v242 offset:45568
    ds_read_b64_tr_b16 a[136:137], v254 offset:2048
    ds_read_b64_tr_b16 a[138:139], v254 offset:3072
    s_waitcnt lgkmcnt(12)
    v_mfma_f32_32x32x16_bf16 v[0:15], a[224:227], a[52:55], v[0:15]
    ds_read_b64_tr_b16 a[252:253], v243 offset:45056
    ds_read_b64_tr_b16 a[254:255], v243 offset:45568
    buffer_load_dwordx4 v122, s[40:43], s85 offen offset:3072 lds
    ds_read_b64_tr_b16 a[140:141], v255 offset:2048
    ds_read_b64_tr_b16 a[142:143], v255 offset:3072
    v_mfma_f32_32x32x16_bf16 v[16:31], a[228:231], a[52:55], v[16:31]
    ds_read_b64_tr_b16 a[208:209], v240 offset:47104
    ds_read_b64_tr_b16 a[210:211], v240 offset:47616
    ds_read_b64_tr_b16 a[144:145], v254 offset:4096
    ds_read_b64_tr_b16 a[146:147], v254 offset:5120
    v_mfma_f32_32x32x16_bf16 v[32:47], a[232:235], a[52:55], v[32:47]
    ds_read_b64_tr_b16 a[212:213], v241 offset:47104
    ds_read_b64_tr_b16 a[214:215], v241 offset:47616
    s_add_u32 m0, s74, 65536
    s_add_u32 s1, s75, 0
    buffer_load_dwordx4 v232, s[40:43], s1 offen offset:0 lds
    s_nop 0
    ds_read_b64_tr_b16 a[148:149], v255 offset:4096
    v_mfma_f32_32x32x16_bf16 v[48:63], a[236:239], a[52:55], v[48:63]
    ds_read_b64_tr_b16 a[216:217], v242 offset:47104
    ds_read_b64_tr_b16 a[218:219], v242 offset:47616
    ds_read_b64_tr_b16 a[150:151], v255 offset:5120
    v_exp_f32 v184, v184
    s_waitcnt lgkmcnt(12)
    v_mfma_f32_32x32x16_bf16 v[0:15], a[240:243], a[56:59], v[0:15]
    ds_read_b64_tr_b16 a[220:221], v243 offset:47104
    ds_read_b64_tr_b16 a[222:223], v243 offset:47616
    ds_read_b64_tr_b16 a[152:153], v254 offset:6144
    ds_read_b64_tr_b16 a[154:155], v254 offset:7168
    v_exp_f32 v136, v136
    v_mfma_f32_32x32x16_bf16 v[16:31], a[244:247], a[56:59], v[16:31]
    ds_read_b64_tr_b16 a[224:225], v236 offset:0
    ds_read_b64_tr_b16 a[226:227], v236 offset:512
    ds_read_b64_tr_b16 a[156:157], v255 offset:6144
    ds_read_b64_tr_b16 a[158:159], v255 offset:7168
    v_add_f32 v226, v226, v181
    v_mfma_f32_32x32x16_bf16 v[32:47], a[248:251], a[56:59], v[32:47]
    ds_read_b64_tr_b16 a[228:229], v237 offset:0
    ds_read_b64_tr_b16 a[230:231], v237 offset:512
    s_add_u32 s1, s75, 56320
    buffer_load_dwordx4 v232, s[40:43], s1 offen offset:1024 lds
    v_add_f32_e64 v158, v158, v133
    v_mfma_f32_32x32x16_bf16 v[48:63], a[252:255], a[56:59], v[48:63]
    ds_read_b64_tr_b16 a[232:233], v238 offset:0
    ds_read_b64_tr_b16 a[234:235], v238 offset:512
    s_waitcnt lgkmcnt(4)
    v_exp_f32 v185, v185
    v_mfma_f32_32x32x16_bf16 v[0:15], a[208:211], a[60:63], v[0:15]
    ds_read_b64_tr_b16 a[236:237], v239 offset:0
    ds_read_b64_tr_b16 a[238:239], v239 offset:512
    v_exp_f32 v137, v137
    v_add_f32 v227, v227, v182
    v_add_f32_e64 v159, v159, v134
    v_mfma_f32_32x32x16_bf16 v[16:31], a[212:215], a[60:63], v[16:31]
    ds_read_b64_tr_b16 a[240:241], v236 offset:2048
    ds_read_b64_tr_b16 a[242:243], v236 offset:2560
    v_exp_f32_e64 v186, v186
    v_mfma_f32_32x32x16_bf16 v[32:47], a[216:219], a[60:63], v[32:47]
    ds_read_b64_tr_b16 a[244:245], v237 offset:2048
    ds_read_b64_tr_b16 a[246:247], v237 offset:2560
    s_add_u32 m0, s74, 131072
    s_add_u32 s23, s78, 262144
    buffer_load_dwordx4 v233, s[44:47], s23 offen offset:0 lds
    v_mfma_f32_32x32x16_bf16 v[48:63], a[220:223], a[60:63], v[48:63]
    ds_read_b64_tr_b16 a[248:249], v238 offset:2048
    ds_read_b64_tr_b16 a[250:251], v238 offset:2560
    v_exp_f32 v138, v138
    v_add_f32_e64 v226, v226, v183
    s_waitcnt lgkmcnt(6)
    v_mfma_f32_32x32x16_bf16 v[0:15], a[224:227], a[64:67], v[0:15]
    ds_read_b64_tr_b16 a[252:253], v239 offset:2048
    ds_read_b64_tr_b16 a[254:255], v239 offset:2560
    buffer_load_dwordx4 v123, s[44:47], s23 offen offset:1024 lds
    v_add_f32 v158, v158, v135
    v_exp_f32 v187, v187
    v_mfma_f32_32x32x16_bf16 v[16:31], a[228:231], a[64:67], v[16:31]
    ds_read_b64_tr_b16 a[208:209], v236 offset:4096
    ds_read_b64_tr_b16 a[210:211], v236 offset:4608
    v_exp_f32 v139, v139
    v_add_f32 v227, v227, v184
    v_mfma_f32_32x32x16_bf16 v[32:47], a[232:235], a[64:67], v[32:47]
    ds_read_b64_tr_b16 a[212:213], v237 offset:4096
    ds_read_b64_tr_b16 a[214:215], v237 offset:4608
    buffer_load_dwordx4 v124, s[44:47], s23 offen offset:2048 lds
    v_add_f32 v159, v159, v136
    v_exp_f32 v188, v188
    v_mfma_f32_32x32x16_bf16 v[48:63], a[236:239], a[64:67], v[48:63]
    ds_read_b64_tr_b16 a[216:217], v238 offset:4096
    ds_read_b64_tr_b16 a[218:219], v238 offset:4608
    v_exp_f32 v140, v140
    v_add_f32 v226, v226, v185
    s_waitcnt lgkmcnt(6)
    v_mfma_f32_32x32x16_bf16 v[0:15], a[240:243], a[68:71], v[0:15]
    ds_read_b64_tr_b16 a[220:221], v239 offset:4096
    ds_read_b64_tr_b16 a[222:223], v239 offset:4608
    buffer_load_dwordx4 v125, s[44:47], s23 offen offset:3072 lds
    v_add_f32 v158, v158, v137
    v_exp_f32_e64 v189, v189
    v_mfma_f32_32x32x16_bf16 v[16:31], a[244:247], a[68:71], v[16:31]
    ds_read_b64_tr_b16 a[224:225], v236 offset:6144
    ds_read_b64_tr_b16 a[226:227], v236 offset:6656
    v_exp_f32 v141, v141
    v_add_f32 v227, v227, v186
    v_mfma_f32_32x32x16_bf16 v[32:47], a[248:251], a[68:71], v[32:47]
    ds_read_b64_tr_b16 a[228:229], v237 offset:6144
    ds_read_b64_tr_b16 a[230:231], v237 offset:6656
    s_add_u32 m0, s74, 135168
    s_add_u32 s23, s78, 294912
    buffer_load_dwordx4 v233, s[44:47], s23 offen offset:0 lds
    v_add_f32 v159, v159, v138
    v_mfma_f32_32x32x16_bf16 v[48:63], a[252:255], a[68:71], v[48:63]
    ds_read_b64_tr_b16 a[232:233], v238 offset:6144
    ds_read_b64_tr_b16 a[234:235], v238 offset:6656
    v_exp_f32_e64 v190, v190
    s_waitcnt lgkmcnt(6)
    v_mfma_f32_32x32x16_bf16 v[0:15], a[208:211], a[72:75], v[0:15]
    ds_read_b64_tr_b16 a[236:237], v239 offset:6144
    ds_read_b64_tr_b16 a[238:239], v239 offset:6656
    buffer_load_dwordx4 v123, s[44:47], s23 offen offset:1024 lds
    v_exp_f32 v142, v142
    v_add_f32 v226, v226, v187
    v_mfma_f32_32x32x16_bf16 v[16:31], a[212:215], a[72:75], v[16:31]
    ds_read_b64_tr_b16 a[240:241], v236 offset:8192
    ds_read_b64_tr_b16 a[242:243], v236 offset:8704
    v_add_f32 v158, v158, v139
    v_exp_f32 v191, v191
    v_mfma_f32_32x32x16_bf16 v[32:47], a[216:219], a[72:75], v[32:47]
    ds_read_b64_tr_b16 a[244:245], v237 offset:8192
    ds_read_b64_tr_b16 a[246:247], v237 offset:8704
    s_add_u32 m0, s74, 65536
    s_add_u32 s1, s75, 112640
    buffer_load_dwordx4 v232, s[40:43], s1 offen offset:2048 lds
    v_exp_f32 v143, v143
    v_mfma_f32_32x32x16_bf16 v[48:63], a[220:223], a[72:75], v[48:63]
    ds_read_b64_tr_b16 a[248:249], v238 offset:8192
    ds_read_b64_tr_b16 a[250:251], v238 offset:8704
    v_add_f32 v227, v227, v188
    v_add_f32 v159, v159, v140
    v_add_f32 v226, v226, v189
    s_waitcnt lgkmcnt(6)
    v_mfma_f32_32x32x16_bf16 v[0:15], a[224:227], a[76:79], v[0:15]
    ds_read_b64_tr_b16 a[252:253], v239 offset:8192
    ds_read_b64_tr_b16 a[254:255], v239 offset:8704
    v_add_f32 v158, v158, v141
    v_add_f32 v227, v227, v190
    v_add_f32 v159, v159, v142
    v_add_f32_e64 v226, v226, v191
    v_mfma_f32_32x32x16_bf16 v[16:31], a[228:231], a[76:79], v[16:31]
    ds_read_b64_tr_b16 a[208:209], v236 offset:10240
    ds_read_b64_tr_b16 a[210:211], v236 offset:10752
    v_add_f32 v158, v158, v143
    v_add_f32 v226, v226, v227
    v_add_f32_e64 v158, v158, v159
    v_mfma_f32_32x32x16_bf16 v[32:47], a[232:235], a[76:79], v[32:47]
    ds_read_b64_tr_b16 a[212:213], v237 offset:10240
    ds_read_b64_tr_b16 a[214:215], v237 offset:10752
    s_add_u32 s1, s75, 168960
    buffer_load_dwordx4 v232, s[40:43], s1 offen offset:3072 lds
    v_rcp_f32 v226, v226
    v_mfma_f32_32x32x16_bf16 v[48:63], a[236:239], a[76:79], v[48:63]
    ds_read_b64_tr_b16 a[216:217], v238 offset:10240
    ds_read_b64_tr_b16 a[218:219], v238 offset:10752
    v_rcp_f32 v158, v158
    v_mul_f32 v176, v176, v226
    s_waitcnt vmcnt(10)
    s_barrier
    s_waitcnt lgkmcnt(6)
    v_mfma_f32_32x32x16_bf16 v[0:15], a[240:243], a[80:83], v[0:15]
    ds_read_b64_tr_b16 a[220:221], v239 offset:10240
    ds_read_b64_tr_b16 a[222:223], v239 offset:10752
    v_mul_f32 v128, v128, v158
    v_mul_f32 v177, v177, v226
    v_mul_f32 v129, v129, v158
    v_mul_f32 v178, v178, v226
    v_mfma_f32_32x32x16_bf16 v[16:31], a[244:247], a[80:83], v[16:31]
    ds_read_b64_tr_b16 a[224:225], v236 offset:12288
    ds_read_b64_tr_b16 a[226:227], v236 offset:12800
    v_mul_f32 v130, v130, v158
    v_mul_f32 v179, v179, v226
    v_mul_f32_e64 v131, v131, v158
    v_mfma_f32_32x32x16_bf16 v[32:47], a[248:251], a[80:83], v[32:47]
    ds_read_b64_tr_b16 a[228:229], v237 offset:12288
    ds_read_b64_tr_b16 a[230:231], v237 offset:12800
    s_add_u32 m0, s74, 69632
    s_add_u32 s1, s75, 229376
    buffer_load_dwordx4 v232, s[40:43], s1 offen offset:0 lds
    v_cvt_pk_bf16_f32 v192, v176, v177
    v_mfma_f32_32x32x16_bf16 v[48:63], a[252:255], a[80:83], v[48:63]
    ds_read_b64_tr_b16 a[232:233], v238 offset:12288
    ds_read_b64_tr_b16 a[234:235], v238 offset:12800
    v_cvt_pk_bf16_f32 v200, v128, v129
    v_mul_f32 v180, v180, v226
    v_mul_f32_e64 v132, v132, v158
    s_waitcnt lgkmcnt(6)
    v_mfma_f32_32x32x16_bf16 v[0:15], a[208:211], a[84:87], v[0:15]
    ds_read_b64_tr_b16 a[236:237], v239 offset:12288
    ds_read_b64_tr_b16 a[238:239], v239 offset:12800
    buffer_load_dwordx2 v[146:147], v152, s[52:55], s13 offen sc1
    v_mul_f32 v181, v181, v226
    v_mul_f32 v133, v133, v158
    v_cvt_pk_bf16_f32 v193, v178, v179
    v_mfma_f32_32x32x16_bf16 v[16:31], a[212:215], a[84:87], v[16:31]
    ds_read_b64_tr_b16 a[240:241], v236 offset:14336
    ds_read_b64_tr_b16 a[242:243], v236 offset:14848
    v_cvt_pk_bf16_f32 v201, v130, v131
    v_mul_f32 v182, v182, v226
    v_mul_f32 v134, v134, v158
    v_mfma_f32_32x32x16_bf16 v[32:47], a[216:219], a[84:87], v[32:47]
    ds_read_b64_tr_b16 a[244:245], v237 offset:14336
    ds_read_b64_tr_b16 a[246:247], v237 offset:14848
    v_mul_f32_e64 v183, v183, v226
    v_mul_f32_e64 v135, v135, v158
    v_cvt_pk_bf16_f32 v194, v180, v181
    v_cvt_pk_bf16_f32 v202, v132, v133
    v_mfma_f32_32x32x16_bf16 v[48:63], a[220:223], a[84:87], v[48:63]
    ds_read_b64_tr_b16 a[248:249], v238 offset:14336
    ds_read_b64_tr_b16 a[250:251], v238 offset:14848
    v_mul_f32 v184, v184, v226
    v_mul_f32_e64 v136, v136, v158
    v_mul_f32_e64 v185, v185, v226
    s_waitcnt lgkmcnt(6)
    v_mfma_f32_32x32x16_bf16 v[0:15], a[224:227], a[88:91], v[0:15]
    ds_read_b64_tr_b16 a[252:253], v239 offset:14336
    ds_read_b64_tr_b16 a[254:255], v239 offset:14848
    s_add_u32 s1, s75, 285696
    buffer_load_dwordx4 v232, s[40:43], s1 offen offset:1024 lds
    v_mul_f32_e64 v137, v137, v158
    v_cvt_pk_bf16_f32 v195, v182, v183
    v_mfma_f32_32x32x16_bf16 v[16:31], a[228:231], a[88:91], v[16:31]
    ds_read_b64_tr_b16 a[208:209], v236 offset:32768
    ds_read_b64_tr_b16 a[210:211], v236 offset:33280
    v_cvt_pk_bf16_f32 v203, v134, v135
    v_mul_f32 v186, v186, v226
    v_mul_f32_e64 v138, v138, v158
    v_mfma_f32_32x32x16_bf16 v[32:47], a[232:235], a[88:91], v[32:47]
    ds_read_b64_tr_b16 a[212:213], v236 offset:34816
    ds_read_b64_tr_b16 a[214:215], v236 offset:35328
    s_waitcnt vmcnt(5)
    ds_read_b64_tr_b16 v[96:97], v254 offset:0
    ds_read_b64_tr_b16 v[98:99], v254 offset:1024
    v_mul_f32 v187, v187, v226
    v_mfma_f32_32x32x16_bf16 v[48:63], a[236:239], a[88:91], v[48:63]
    ds_read_b64_tr_b16 a[216:217], v236 offset:36864
    ds_read_b64_tr_b16 a[218:219], v236 offset:37376
    ds_read_b64_tr_b16 v[100:101], v255 offset:0
    ds_read_b64_tr_b16 v[102:103], v255 offset:1024
    v_mul_f32_e64 v139, v139, v158
    s_waitcnt lgkmcnt(10)
    v_mfma_f32_32x32x16_bf16 v[0:15], a[240:243], a[92:95], v[0:15]
    ds_read_b64_tr_b16 a[220:221], v236 offset:38912
    ds_read_b64_tr_b16 a[222:223], v236 offset:39424
    s_add_u32 s1, s75, 342016
    buffer_load_dwordx4 v232, s[40:43], s1 offen offset:2048 lds
    ds_read_b64_tr_b16 v[104:105], v254 offset:2048
    ds_read_b64_tr_b16 v[106:107], v254 offset:3072
    v_mfma_f32_32x32x16_bf16 v[16:31], a[244:247], a[92:95], v[16:31]
    ds_read_b64_tr_b16 a[224:225], v236 offset:40960
    ds_read_b64_tr_b16 a[226:227], v236 offset:41472
    v_cvt_pk_bf16_f32 v196, v184, v185
    v_cvt_pk_bf16_f32 v204, v136, v137
    v_mul_f32_e64 v188, v188, v226
    v_mfma_f32_32x32x16_bf16 v[32:47], a[248:251], a[92:95], v[32:47]
    ds_read_b64_tr_b16 a[228:229], v236 offset:43008
    ds_read_b64_tr_b16 a[230:231], v236 offset:43520
    ds_read_b64_tr_b16 v[108:109], v255 offset:2048
    ds_read_b64_tr_b16 v[110:111], v255 offset:3072
    v_mul_f32_e64 v140, v140, v158
    v_mul_f32_e64 v189, v189, v226
    v_mfma_f32_32x32x16_bf16 v[48:63], a[252:255], a[92:95], v[48:63]
    ds_read_b64_tr_b16 a[232:233], v236 offset:45056
    ds_read_b64_tr_b16 a[234:235], v236 offset:45568
    ds_read_b64_tr_b16 v[112:113], v254 offset:4096
    ds_read_b64_tr_b16 v[114:115], v254 offset:5120
    v_mul_f32 v141, v141, v158
    s_waitcnt lgkmcnt(12)
    v_mfma_f32_32x32x16_bf16 v[0:15], a[208:211], a[96:99], v[0:15]
    ds_read_b64_tr_b16 a[236:237], v236 offset:47104
    ds_read_b64_tr_b16 a[238:239], v236 offset:47616
    s_add_u32 s1, s75, 398336
    buffer_load_dwordx4 v232, s[40:43], s1 offen offset:3072 lds
    ds_read_b64_tr_b16 v[116:117], v255 offset:4096
    ds_read_b64_tr_b16 v[118:119], v255 offset:5120
    v_mfma_f32_32x32x16_bf16 v[0:15], a[212:215], a[100:103], v[0:15]
    ds_read_b64_tr_b16 a[240:241], v237 offset:32768
    ds_read_b64_tr_b16 a[242:243], v237 offset:33280
    v_cvt_pk_bf16_f32 v197, v186, v187
    v_cvt_pk_bf16_f32 v205, v138, v139
    v_mul_f32_e64 v190, v190, v226
    v_mfma_f32_32x32x16_bf16 v[0:15], a[216:219], a[104:107], v[0:15]
    ds_read_b64_tr_b16 a[244:245], v237 offset:34816
    ds_read_b64_tr_b16 a[246:247], v237 offset:35328
    v_mul_f32_e64 v142, v142, v158
    v_mul_f32_e64 v191, v191, v226
    v_mul_f32_e64 v143, v143, v158
    v_cvt_pk_bf16_f32 v198, v188, v189
    v_mfma_f32_32x32x16_bf16 v[0:15], a[220:223], a[108:111], v[0:15]
    ds_read_b64_tr_b16 a[248:249], v237 offset:36864
    ds_read_b64_tr_b16 a[250:251], v237 offset:37376
    s_waitcnt lgkmcnt(6)
    v_cvt_pk_bf16_f32 v206, v140, v141
    v_cvt_pk_bf16_f32 v199, v190, v191
    v_mfma_f32_32x32x16_bf16 v[0:15], a[224:227], a[112:115], v[0:15]
    ds_read_b64_tr_b16 a[252:253], v237 offset:38912
    ds_read_b64_tr_b16 a[254:255], v237 offset:39424
    s_add_u32 m0, s74, 98304
    s_add_u32 s1, s76, 0
    buffer_load_dwordx4 v232, s[40:43], s1 offen offset:0 lds
    v_cvt_pk_bf16_f32 v207, v142, v143
    v_mfma_f32_32x32x16_bf16 v[0:15], a[228:231], a[116:119], v[0:15]
    ds_read_b64_tr_b16 a[208:209], v237 offset:40960
    ds_read_b64_tr_b16 a[210:211], v237 offset:41472
    v_mfma_f32_32x32x16_bf16 v[0:15], a[232:235], a[120:123], v[0:15]
    ds_read_b64_tr_b16 a[212:213], v237 offset:43008
    ds_read_b64_tr_b16 a[214:215], v237 offset:43520
    v_mfma_f32_32x32x16_bf16 v[0:15], a[236:239], a[124:127], v[0:15]
    ds_read_b64_tr_b16 a[216:217], v237 offset:45056
    ds_read_b64_tr_b16 a[218:219], v237 offset:45568
    s_waitcnt lgkmcnt(6)
    v_mfma_f32_32x32x16_bf16 v[16:31], a[240:243], a[96:99], v[16:31]
    ds_read_b64_tr_b16 a[220:221], v237 offset:47104
    ds_read_b64_tr_b16 a[222:223], v237 offset:47616
    s_add_u32 s1, s76, 56320
    s_nop 0
    buffer_load_dwordx4 v232, s[40:43], s1 offen offset:1024 lds
    v_mfma_f32_32x32x16_bf16 v[16:31], a[244:247], a[100:103], v[16:31]
    ds_read_b64_tr_b16 a[224:225], v238 offset:32768
    ds_read_b64_tr_b16 a[226:227], v238 offset:33280
    v_mfma_f32_32x32x16_bf16 v[16:31], a[248:251], a[104:107], v[16:31]
    ds_read_b64_tr_b16 a[228:229], v238 offset:34816
    ds_read_b64_tr_b16 a[230:231], v238 offset:35328
    v_mfma_f32_32x32x16_bf16 v[16:31], a[252:255], a[108:111], v[16:31]
    ds_read_b64_tr_b16 a[232:233], v238 offset:36864
    ds_read_b64_tr_b16 a[234:235], v238 offset:37376
    v_max_f32 v0, 0, v0
    v_max_f32_e64 v1, 0, v1
    v_max_f32_e64 v2, 0, v2
    s_waitcnt lgkmcnt(6)
    v_mfma_f32_32x32x16_bf16 v[16:31], a[208:211], a[112:115], v[16:31]
    ds_read_b64_tr_b16 a[236:237], v238 offset:38912
    ds_read_b64_tr_b16 a[238:239], v238 offset:39424
    s_add_u32 s1, s76, 112640
    buffer_load_dwordx4 v232, s[40:43], s1 offen offset:2048 lds
    s_waitcnt vmcnt(6)
    v_cmp_eq_u64 vcc, s[68:69], v[146:147]
    s_mov_b32 s7, 0
    s_cmp_eq_u64 vcc, exec
    s_cbranch_scc1 L_pok_14
L_plp_15:
    buffer_load_dwordx2 v[146:147], v152, s[52:55], s13 offen sc1
    s_waitcnt vmcnt(0)
    v_cmp_eq_u64 vcc, s[68:69], v[146:147]
    s_add_u32 s7, s7, 1
    s_cmp_gt_u32 s7, 0x40000
    s_cbranch_scc1 L_pok_14
    s_cmp_eq_u64 vcc, exec
    s_cbranch_scc0 L_plp_15
L_pok_14:
    v_mfma_f32_32x32x16_bf16 v[16:31], a[212:215], a[116:119], v[16:31]
    ds_read_b64_tr_b16 a[240:241], v238 offset:40960
    ds_read_b64_tr_b16 a[242:243], v238 offset:41472
    buffer_load_dwordx4 v[148:151], v251, s[52:55], s17 offen offset:0 sc1
    v_max_f32 v3, 0, v3
    v_max_f32_e64 v4, 0, v4
    v_mfma_f32_32x32x16_bf16 v[16:31], a[216:219], a[120:123], v[16:31]
    ds_read_b64_tr_b16 a[244:245], v238 offset:43008
    ds_read_b64_tr_b16 a[246:247], v238 offset:43520
    buffer_load_dwordx4 v[152:155], v251, s[52:55], s17 offen offset:2176 sc1
    v_max_f32 v5, 0, v5
    v_max_f32 v6, 0, v6
    v_max_f32 v7, 0, v7
    v_mfma_f32_32x32x16_bf16 v[16:31], a[220:223], a[124:127], v[16:31]
    ds_read_b64_tr_b16 a[248:249], v238 offset:45056
    ds_read_b64_tr_b16 a[250:251], v238 offset:45568
    v_mul_f32 v0, v0, v8
    v_mul_f32 v1, v1, v9
    v_mul_f32 v2, v2, v10
    s_waitcnt vmcnt(5)
    s_barrier
    s_waitcnt lgkmcnt(6)
    v_mfma_f32_32x32x16_bf16 v[32:47], a[224:227], a[96:99], v[32:47]
    ds_read_b64_tr_b16 a[252:253], v238 offset:47104
    ds_read_b64_tr_b16 a[254:255], v238 offset:47616
    v_mul_f32 v3, v3, v11
    v_mul_f32 v4, v4, v12
    v_mul_f32 v5, v5, v13
    v_mul_f32_e64 v6, v6, v14
    v_mfma_f32_32x32x16_bf16 v[32:47], a[228:231], a[100:103], v[32:47]
    ds_read_b64_tr_b16 a[208:209], v239 offset:32768
    ds_read_b64_tr_b16 a[210:211], v239 offset:33280
    v_mul_f32_e64 v7, v7, v15
    v_cvt_pk_bf16_f32 v0, v0, v1
    v_cvt_pk_bf16_f32 v1, v2, v3
    v_mfma_f32_32x32x16_bf16 v[32:47], a[232:235], a[104:107], v[32:47]
    ds_read_b64_tr_b16 a[212:213], v239 offset:34816
    ds_read_b64_tr_b16 a[214:215], v239 offset:35328
    s_add_u32 s1, s76, 168960
    buffer_load_dwordx4 v232, s[40:43], s1 offen offset:3072 lds
    v_cvt_pk_bf16_f32 v2, v4, v5
    v_cvt_pk_bf16_f32 v3, v6, v7
    v_mfma_f32_32x32x16_bf16 v[32:47], a[236:239], a[108:111], v[32:47]
    ds_read_b64_tr_b16 a[216:217], v239 offset:36864
    ds_read_b64_tr_b16 a[218:219], v239 offset:37376
    buffer_store_dwordx4 v[0:3], v230, s[52:55], s80 offen offset:0 sc1
    v_max_f32 v16, 0, v16
    v_max_f32 v17, 0, v17
    s_waitcnt lgkmcnt(6)
    v_mfma_f32_32x32x16_bf16 v[32:47], a[240:243], a[112:115], v[32:47]
    ds_read_b64_tr_b16 a[220:221], v239 offset:38912
    ds_read_b64_tr_b16 a[222:223], v239 offset:39424
    v_max_f32 v18, 0, v18
    v_max_f32 v19, 0, v19
    v_max_f32 v20, 0, v20
    v_max_f32_e64 v21, 0, v21
    v_mfma_f32_32x32x16_bf16 v[32:47], a[244:247], a[116:119], v[32:47]
    ds_read_b64_tr_b16 a[224:225], v239 offset:40960
    ds_read_b64_tr_b16 a[226:227], v239 offset:41472
    v_max_f32 v22, 0, v22
    v_max_f32 v23, 0, v23
    v_mul_f32 v16, v16, v24
    v_mfma_f32_32x32x16_bf16 v[32:47], a[248:251], a[120:123], v[32:47]
    ds_read_b64_tr_b16 a[228:229], v239 offset:43008
    ds_read_b64_tr_b16 a[230:231], v239 offset:43520
    v_mul_f32 v17, v17, v25
    v_mul_f32 v18, v18, v26
    v_mul_f32 v19, v19, v27
    v_mul_f32 v20, v20, v28
    v_mfma_f32_32x32x16_bf16 v[32:47], a[252:255], a[124:127], v[32:47]
    ds_read_b64_tr_b16 a[232:233], v239 offset:45056
    ds_read_b64_tr_b16 a[234:235], v239 offset:45568
    s_add_u32 m0, s74, 102400
    s_add_u32 s1, s76, 229376
    buffer_load_dwordx4 v232, s[40:43], s1 offen offset:0 lds
    s_waitcnt lgkmcnt(6)
    v_mfma_f32_32x32x16_bf16 v[48:63], a[208:211], a[96:99], v[48:63]
    ds_read_b64_tr_b16 a[236:237], v239 offset:47104
    ds_read_b64_tr_b16 a[238:239], v239 offset:47616
    v_mul_f32 v21, v21, v29
    v_mul_f32 v22, v22, v30
    v_mul_f32_e64 v23, v23, v31
    v_cvt_pk_bf16_f32 v16, v16, v17
    v_mfma_f32_32x32x16_bf16 v[48:63], a[212:215], a[100:103], v[48:63]
    ds_read_b64_tr_b16 a[240:241], v246 offset:0
    ds_read_b64_tr_b16 a[242:243], v246 offset:256
    v_cvt_pk_bf16_f32 v17, v18, v19
    v_cvt_pk_bf16_f32 v18, v20, v21
    v_cvt_pk_bf16_f32 v19, v22, v23
    v_mfma_f32_32x32x16_bf16 v[48:63], a[216:219], a[104:107], v[48:63]
    ds_read_b64_tr_b16 a[244:245], v246 offset:1024
    ds_read_b64_tr_b16 a[246:247], v246 offset:1280
    buffer_store_dwordx4 v[16:19], v230, s[52:55], s80 offen offset:1024 sc1
    v_mfma_f32_32x32x16_bf16 v[48:63], a[220:223], a[108:111], v[48:63]
    ds_read_b64_tr_b16 a[248:249], v246 offset:2048
    ds_read_b64_tr_b16 a[250:251], v246 offset:2304
    v_max_f32 v32, 0, v32
    v_max_f32 v33, 0, v33
    v_max_f32 v34, 0, v34
    s_waitcnt lgkmcnt(6)
    v_mfma_f32_32x32x16_bf16 v[48:63], a[224:227], a[112:115], v[48:63]
    ds_read_b64_tr_b16 a[252:253], v246 offset:3072
    ds_read_b64_tr_b16 a[254:255], v246 offset:3328
    s_add_u32 s1, s76, 285696
    buffer_load_dwordx4 v232, s[40:43], s1 offen offset:1024 lds
    v_max_f32_e64 v35, 0, v35
    v_max_f32_e64 v36, 0, v36
    v_mfma_f32_32x32x16_bf16 v[48:63], a[228:231], a[116:119], v[48:63]
    ds_read_b64_tr_b16 a[208:209], v246 offset:4096
    ds_read_b64_tr_b16 a[210:211], v246 offset:4352
    v_max_f32_e64 v37, 0, v37
    v_max_f32_e64 v38, 0, v38
    v_max_f32 v39, 0, v39
    v_mfma_f32_32x32x16_bf16 v[48:63], a[232:235], a[120:123], v[48:63]
    ds_read_b64_tr_b16 a[212:213], v246 offset:5120
    ds_read_b64_tr_b16 a[214:215], v246 offset:5376
    s_waitcnt vmcnt(5)
    v_cvt_pk_bf16_f32 v148, v148, v149
    v_cvt_pk_bf16_f32 v149, v150, v151
    ds_write_b64 v252, v[148:149] offset:0
    v_mfma_f32_32x32x16_bf16 v[48:63], a[236:239], a[124:127], v[48:63]
    ds_read_b64_tr_b16 a[216:217], v246 offset:6144
    ds_read_b64_tr_b16 a[218:219], v246 offset:6400
    v_mul_f32 v32, v32, v40
    v_mul_f32 v33, v33, v41
    v_mul_f32 v34, v34, v42
    s_waitcnt lgkmcnt(7)
    v_mfma_f32_32x32x16_bf16 v[0:15], a[240:243], a[0:3], 0
    ds_read_b64_tr_b16 a[220:221], v246 offset:7168
    ds_read_b64_tr_b16 a[222:223], v246 offset:7424
    s_add_u32 s1, s76, 342016
    buffer_load_dwordx4 v232, s[40:43], s1 offen offset:2048 lds
    v_cvt_pk_bf16_f32 v152, v152, v153
    v_cvt_pk_bf16_f32 v153, v154, v155
    v_mfma_f32_32x32x16_bf16 v[0:15], a[244:247], a[4:7], v[0:15]
    ds_read_b64_tr_b16 a[224:225], v246 offset:8192
    ds_read_b64_tr_b16 a[226:227], v246 offset:8448
    ds_write_b64 v252, v[152:153] offset:16384
    v_mul_f32 v35, v35, v43
    v_mul_f32 v36, v36, v44
    v_mfma_f32_32x32x16_bf16 v[0:15], a[248:251], a[8:11], v[0:15]
    ds_read_b64_tr_b16 a[228:229], v246 offset:9216
    ds_read_b64_tr_b16 a[230:231], v246 offset:9472
    s_waitcnt lgkmcnt(2)
    v_mul_f32 v37, v37, v45
    v_mul_f32 v38, v38, v46
    v_mul_f32 v39, v39, v47
    v_mfma_f32_32x32x16_bf16 v[0:15], a[252:255], a[12:15], v[0:15]
    ds_read_b64_tr_b16 a[232:233], v246 offset:10240
    ds_read_b64_tr_b16 a[234:235], v246 offset:10496
    v_cvt_pk_bf16_f32 v32, v32, v33
    v_cvt_pk_bf16_f32 v33, v34, v35
    v_cvt_pk_bf16_f32 v34, v36, v37
    v_mfma_f32_32x32x16_bf16 v[0:15], a[208:211], a[16:19], v[0:15]
    ds_read_b64_tr_b16 a[236:237], v246 offset:11264
    ds_read_b64_tr_b16 a[238:239], v246 offset:11520
    s_add_u32 s1, s76, 398336
    buffer_load_dwordx4 v232, s[40:43], s1 offen offset:3072 lds
    v_cvt_pk_bf16_f32 v35, v38, v39
    buffer_store_dwordx4 v[32:35], v230, s[52:55], s80 offen offset:2048 sc1
    v_mfma_f32_32x32x16_bf16 v[0:15], a[212:215], a[20:23], v[0:15]
    ds_read_b64_tr_b16 a[240:241], v246 offset:12288
    ds_read_b64_tr_b16 a[242:243], v246 offset:12544
    v_max_f32 v48, 0, v48
    v_max_f32 v49, 0, v49
    v_max_f32_e64 v50, 0, v50
    v_mfma_f32_32x32x16_bf16 v[0:15], a[216:219], a[24:27], v[0:15]
    ds_read_b64_tr_b16 a[244:245], v246 offset:13312
    ds_read_b64_tr_b16 a[246:247], v246 offset:13568
    v_max_f32_e64 v51, 0, v51
    v_max_f32_e64 v52, 0, v52
    v_max_f32_e64 v53, 0, v53
    v_max_f32_e64 v54, 0, v54
    v_mfma_f32_32x32x16_bf16 v[0:15], a[220:223], a[28:31], v[0:15]
    ds_read_b64_tr_b16 a[248:249], v246 offset:14336
    ds_read_b64_tr_b16 a[250:251], v246 offset:14592
    v_max_f32 v55, 0, v55
    v_mul_f32_e64 v48, v48, v56
    v_mul_f32_e64 v49, v49, v57
    s_waitcnt lgkmcnt(6)
    v_mfma_f32_32x32x16_bf16 v[0:15], a[224:227], a[32:35], v[0:15]
    ds_read_b64_tr_b16 a[252:253], v246 offset:15360
    ds_read_b64_tr_b16 a[254:255], v246 offset:15616
    v_mul_f32_e64 v50, v50, v58
    v_mul_f32_e64 v51, v51, v59
    v_mul_f32_e64 v52, v52, v60
    v_mul_f32_e64 v53, v53, v61
    v_mfma_f32_32x32x16_bf16 v[0:15], a[228:231], a[36:39], v[0:15]
    ds_read_b64_tr_b16 a[208:209], v247 offset:0
    ds_read_b64_tr_b16 a[210:211], v247 offset:256
    s_add_u32 m0, s74, 131072
    s_add_u32 s23, s79, 49152
    buffer_load_dwordx4 v233, s[48:51], s23 offen offset:0 lds
    v_mfma_f32_32x32x16_bf16 v[0:15], a[232:235], a[40:43], v[0:15]
    ds_read_b64_tr_b16 a[212:213], v247 offset:1024
    ds_read_b64_tr_b16 a[214:215], v247 offset:1280
    v_mul_f32_e64 v54, v54, v62
    v_mul_f32_e64 v55, v55, v63
    v_cvt_pk_bf16_f32 v48, v48, v49
    v_cvt_pk_bf16_f32 v49, v50, v51
    v_mfma_f32_32x32x16_bf16 v[0:15], a[236:239], a[44:47], v[0:15]
    ds_read_b64_tr_b16 a[216:217], v247 offset:2048
    ds_read_b64_tr_b16 a[218:219], v247 offset:2304
    buffer_load_dwordx4 v123, s[48:51], s23 offen offset:1024 lds
    v_cvt_pk_bf16_f32 v50, v52, v53
    v_cvt_pk_bf16_f32 v51, v54, v55
    s_waitcnt lgkmcnt(6)
    s_nop 0
    v_mfma_f32_32x32x16_bf16 v[0:15], a[240:243], a[48:51], v[0:15]
    ds_read_b64_tr_b16 a[220:221], v247 offset:3072
    ds_read_b64_tr_b16 a[222:223], v247 offset:3328
    buffer_store_dwordx4 v[48:51], v230, s[52:55], s80 offen offset:3072 sc1
    v_mfma_f32_32x32x16_bf16 v[0:15], a[244:247], a[52:55], v[0:15]
    ds_read_b64_tr_b16 a[224:225], v247 offset:4096
    ds_read_b64_tr_b16 a[226:227], v247 offset:4352
    v_mfma_f32_32x32x16_bf16 v[0:15], a[248:251], a[56:59], v[0:15]
    ds_read_b64_tr_b16 a[228:229], v247 offset:5120
    ds_read_b64_tr_b16 a[230:231], v247 offset:5376
    buffer_load_dwordx4 v124, s[48:51], s23 offen offset:2048 lds
    v_mfma_f32_32x32x16_bf16 v[0:15], a[252:255], a[60:63], v[0:15]
    ds_read_b64_tr_b16 a[232:233], v247 offset:6144
    ds_read_b64_tr_b16 a[234:235], v247 offset:6400
    s_waitcnt vmcnt(5)
    s_barrier
    s_waitcnt lgkmcnt(6)
    s_nop 0
    v_mfma_f32_32x32x16_bf16 v[16:31], a[208:211], a[0:3], 0
    ds_read_b64_tr_b16 a[236:237], v247 offset:7168
    ds_read_b64_tr_b16 a[238:239], v247 offset:7424
    buffer_load_dwordx4 v125, s[48:51], s23 offen offset:3072 lds
    ds_read_b128 a[160:163], v253 offset:0
    ds_read_b128 a[164:167], v253 offset:8192
    ds_read_b128 a[168:171], v253 offset:16384
    v_mfma_f32_32x32x16_bf16 v[16:31], a[212:215], a[4:7], v[16:31]
    ds_read_b64_tr_b16 a[240:241], v247 offset:8192
    ds_read_b64_tr_b16 a[242:243], v247 offset:8448
    ds_read_b128 a[172:175], v253 offset:24576
    v_mfma_f32_32x32x16_bf16 v[16:31], a[216:219], a[8:11], v[16:31]
    ds_read_b64_tr_b16 a[244:245], v247 offset:9216
    ds_read_b64_tr_b16 a[246:247], v247 offset:9472
    s_add_u32 m0, s74, 135168
    s_add_u32 s23, s79, 81920
    buffer_load_dwordx4 v233, s[48:51], s23 offen offset:0 lds
    v_mfma_f32_32x32x16_bf16 v[16:31], a[220:223], a[12:15], v[16:31]
    ds_read_b64_tr_b16 a[248:249], v247 offset:10240
    ds_read_b64_tr_b16 a[250:251], v247 offset:10496
    s_waitcnt lgkmcnt(10)
    v_mfma_f32_32x32x16_bf16 v[16:31], a[224:227], a[16:19], v[16:31]
    ds_read_b64_tr_b16 a[252:253], v247 offset:11264
    ds_read_b64_tr_b16 a[254:255], v247 offset:11520
    buffer_load_dwordx4 v123, s[48:51], s23 offen offset:1024 lds
    s_waitcnt lgkmcnt(6)
    v_mfma_f32_32x32x16_bf16 v[128:143], a[160:163], v[192:195], 0
    v_mfma_f32_32x32x16_bf16 v[16:31], a[228:231], a[20:23], v[16:31]
    ds_read_b64_tr_b16 a[208:209], v247 offset:12288
    ds_read_b64_tr_b16 a[210:211], v247 offset:12544
    v_mfma_f32_32x32x16_bf16 v[144:159], a[168:171], v[200:203], 0
    v_mfma_f32_32x32x16_bf16 v[16:31], a[232:235], a[24:27], v[16:31]
    ds_read_b64_tr_b16 a[212:213], v247 offset:13312
    ds_read_b64_tr_b16 a[214:215], v247 offset:13568
    s_add_u32 m0, s74, 0
    s_add_u32 s19, s78, 376832
    buffer_load_dwordx4 v233, s[44:47], s19 offen offset:0 lds
    v_mfma_f32_32x32x16_bf16 v[128:143], a[164:167], v[196:199], v[128:143]
    v_mfma_f32_32x32x16_bf16 v[16:31], a[236:239], a[28:31], v[16:31]
    ds_read_b64_tr_b16 a[216:217], v247 offset:14336
    ds_read_b64_tr_b16 a[218:219], v247 offset:14592
    v_mfma_f32_32x32x16_bf16 v[144:159], a[172:175], v[204:207], v[144:159]
    s_waitcnt lgkmcnt(6)
    v_mfma_f32_32x32x16_bf16 v[16:31], a[240:243], a[32:35], v[16:31]
    ds_read_b64_tr_b16 a[220:221], v247 offset:15360
    ds_read_b64_tr_b16 a[222:223], v247 offset:15616
    buffer_load_dwordx4 v123, s[44:47], s19 offen offset:1024 lds
    v_mfma_f32_32x32x16_bf16 v[16:31], a[244:247], a[36:39], v[16:31]
    ds_read_b64_tr_b16 a[224:225], v246 offset:32768
    ds_read_b64_tr_b16 a[226:227], v246 offset:33024
    v_mfma_f32_32x32x16_bf16 v[16:31], a[248:251], a[40:43], v[16:31]
    ds_read_b64_tr_b16 a[228:229], v246 offset:33792
    ds_read_b64_tr_b16 a[230:231], v246 offset:34048
    s_add_u32 s19, s79, 0
    s_add_u32 m0, s74, 2048
    s_nop 0
    buffer_load_dwordx4 v233, s[48:51], s19 offen offset:0 lds
    v_add_f32 v136, 0x358637bd, v136
    v_rcp_f32_e64 v136, v136
    v_mfma_f32_32x32x16_bf16 v[16:31], a[252:255], a[44:47], v[16:31]
    ds_read_b64_tr_b16 a[232:233], v246 offset:34816
    ds_read_b64_tr_b16 a[234:235], v246 offset:35072
    v_add_f32 v152, 0x358637bd, v152
    v_rcp_f32 v152, v152
    s_waitcnt lgkmcnt(6)
    v_mfma_f32_32x32x16_bf16 v[16:31], a[208:211], a[48:51], v[16:31]
    ds_read_b64_tr_b16 a[236:237], v246 offset:35840
    ds_read_b64_tr_b16 a[238:239], v246 offset:36096
    buffer_load_dwordx4 v123, s[48:51], s19 offen offset:1024 lds
    v_mul_f32 v128, v128, v136
    v_mul_f32 v129, v129, v136
    v_mul_f32 v130, v130, v136
    v_mfma_f32_32x32x16_bf16 v[16:31], a[212:215], a[52:55], v[16:31]
    ds_read_b64_tr_b16 a[240:241], v246 offset:36864
    ds_read_b64_tr_b16 a[242:243], v246 offset:37120
    v_mul_f32 v131, v131, v136
    v_mul_f32 v132, v132, v136
    v_mul_f32 v133, v133, v136
    v_mfma_f32_32x32x16_bf16 v[16:31], a[216:219], a[56:59], v[16:31]
    ds_read_b64_tr_b16 a[244:245], v246 offset:37888
    ds_read_b64_tr_b16 a[246:247], v246 offset:38144
    s_add_u32 m0, s74, 4096
    s_add_u32 s19, s79, 16384
    buffer_load_dwordx4 v233, s[48:51], s19 offen offset:0 lds
    v_mul_f32_e64 v134, v134, v136
    v_mfma_f32_32x32x16_bf16 v[16:31], a[220:223], a[60:63], v[16:31]
    ds_read_b64_tr_b16 a[248:249], v246 offset:38912
    ds_read_b64_tr_b16 a[250:251], v246 offset:39168
    v_mul_f32 v135, v135, v136
    v_cvt_pk_bf16_f32 v128, v128, v129
    v_cvt_pk_bf16_f32 v129, v130, v131
    s_waitcnt lgkmcnt(6)
    v_mfma_f32_32x32x16_bf16 v[0:15], a[224:227], a[64:67], v[0:15]
    ds_read_b64_tr_b16 a[252:253], v246 offset:39936
    ds_read_b64_tr_b16 a[254:255], v246 offset:40192
    buffer_load_dwordx4 v123, s[48:51], s19 offen offset:1024 lds
    v_cvt_pk_bf16_f32 v130, v132, v133
    v_cvt_pk_bf16_f32 v131, v134, v135
    buffer_store_dwordx4 v[128:131], v230, s[52:55], s18 offen offset:0 sc1
    v_mfma_f32_32x32x16_bf16 v[0:15], a[228:231], a[68:71], v[0:15]
    ds_read_b64_tr_b16 a[208:209], v246 offset:40960
    ds_read_b64_tr_b16 a[210:211], v246 offset:41216
    v_mul_f32 v144, v144, v152
    v_mul_f32 v145, v145, v152
    v_mul_f32_e64 v146, v146, v152
    v_mfma_f32_32x32x16_bf16 v[0:15], a[232:235], a[72:75], v[0:15]
    ds_read_b64_tr_b16 a[212:213], v246 offset:41984
    ds_read_b64_tr_b16 a[214:215], v246 offset:42240
    v_mul_f32 v147, v147, v152
    v_mul_f32 v148, v148, v152
    v_mul_f32 v149, v149, v152
    v_mul_f32 v150, v150, v152
    v_mfma_f32_32x32x16_bf16 v[0:15], a[236:239], a[76:79], v[0:15]
    ds_read_b64_tr_b16 a[216:217], v246 offset:43008
    ds_read_b64_tr_b16 a[218:219], v246 offset:43264
    buffer_load_dwordx4 v124, s[48:51], s19 offen offset:2048 lds
    v_mul_f32 v151, v151, v152
    v_cvt_pk_bf16_f32 v144, v144, v145
    s_waitcnt lgkmcnt(6)
    v_mfma_f32_32x32x16_bf16 v[0:15], a[240:243], a[80:83], v[0:15]
    ds_read_b64_tr_b16 a[220:221], v246 offset:44032
    ds_read_b64_tr_b16 a[222:223], v246 offset:44288
    v_cvt_pk_bf16_f32 v145, v146, v147
    v_cvt_pk_bf16_f32 v146, v148, v149
    v_cvt_pk_bf16_f32 v147, v150, v151
    buffer_store_dwordx4 v[144:147], v230, s[52:55], s18 offen offset:1024 sc1
    v_mfma_f32_32x32x16_bf16 v[0:15], a[244:247], a[84:87], v[0:15]
    ds_read_b64_tr_b16 a[224:225], v246 offset:45056
    ds_read_b64_tr_b16 a[226:227], v246 offset:45312
    v_mfma_f32_32x32x16_bf16 v[0:15], a[248:251], a[88:91], v[0:15]
    ds_read_b64_tr_b16 a[228:229], v246 offset:46080
    ds_read_b64_tr_b16 a[230:231], v246 offset:46336
    buffer_load_dwordx4 v125, s[48:51], s19 offen offset:3072 lds
    v_mfma_f32_32x32x16_bf16 v[0:15], a[252:255], a[92:95], v[0:15]
    ds_read_b64_tr_b16 a[232:233], v246 offset:47104
    ds_read_b64_tr_b16 a[234:235], v246 offset:47360
    s_waitcnt lgkmcnt(6)
    v_mfma_f32_32x32x16_bf16 v[0:15], a[208:211], a[96:99], v[0:15]
    ds_read_b64_tr_b16 a[236:237], v246 offset:48128
    ds_read_b64_tr_b16 a[238:239], v246 offset:48384
    s_nop 0
    v_mfma_f32_32x32x16_bf16 v[0:15], a[212:215], a[100:103], v[0:15]
    ds_read_b64_tr_b16 a[240:241], v247 offset:32768
    ds_read_b64_tr_b16 a[242:243], v247 offset:33024
    v_mfma_f32_32x32x16_bf16 v[0:15], a[216:219], a[104:107], v[0:15]
    ds_read_b64_tr_b16 a[244:245], v247 offset:33792
    ds_read_b64_tr_b16 a[246:247], v247 offset:34048
    v_mfma_f32_32x32x16_bf16 v[0:15], a[220:223], a[108:111], v[0:15]
    ds_read_b64_tr_b16 a[248:249], v247 offset:34816
    ds_read_b64_tr_b16 a[250:251], v247 offset:35072
    s_waitcnt lgkmcnt(6)
    v_mfma_f32_32x32x16_bf16 v[0:15], a[224:227], a[112:115], v[0:15]
    ds_read_b64_tr_b16 a[252:253], v247 offset:35840
    ds_read_b64_tr_b16 a[254:255], v247 offset:36096
    v_mfma_f32_32x32x16_bf16 v[0:15], a[228:231], a[116:119], v[0:15]
    ds_read_b64_tr_b16 a[208:209], v247 offset:36864
    ds_read_b64_tr_b16 a[210:211], v247 offset:37120
    s_nop 0
    v_mfma_f32_32x32x16_bf16 v[0:15], a[232:235], a[120:123], v[0:15]
    ds_read_b64_tr_b16 a[212:213], v247 offset:37888
    ds_read_b64_tr_b16 a[214:215], v247 offset:38144
    v_mov_b32 v228, s68
    s_waitcnt vmcnt(14)
    buffer_store_dword v228, off, s[52:55], s14 sc1
    v_mfma_f32_32x32x16_bf16 v[0:15], a[236:239], a[124:127], v[0:15]
    ds_read_b64_tr_b16 a[216:217], v247 offset:38912
    ds_read_b64_tr_b16 a[218:219], v247 offset:39168
    s_barrier
    s_waitcnt lgkmcnt(6)
    v_mfma_f32_32x32x16_bf16 v[16:31], a[240:243], a[64:67], v[16:31]
    ds_read_b64_tr_b16 a[220:221], v247 offset:39936
    ds_read_b64_tr_b16 a[222:223], v247 offset:40192
    v_mfma_f32_32x32x16_bf16 v[16:31], a[244:247], a[68:71], v[16:31]
    ds_read_b64_tr_b16 a[224:225], v247 offset:40960
    ds_read_b64_tr_b16 a[226:227], v247 offset:41216
    v_mfma_f32_32x32x16_bf16 v[16:31], a[248:251], a[72:75], v[16:31]
    ds_read_b64_tr_b16 a[228:229], v247 offset:41984
    ds_read_b64_tr_b16 a[230:231], v247 offset:42240
    v_mfma_f32_32x32x16_bf16 v[16:31], a[252:255], a[76:79], v[16:31]
    ds_read_b64_tr_b16 a[232:233], v247 offset:43008
    ds_read_b64_tr_b16 a[234:235], v247 offset:43264
    v_max_f32 v0, 0, v0
    v_max_f32 v1, 0, v1
    v_max_f32 v2, 0, v2
    s_waitcnt lgkmcnt(6)
    v_mfma_f32_32x32x16_bf16 v[16:31], a[208:211], a[80:83], v[16:31]
    ds_read_b64_tr_b16 a[236:237], v247 offset:44032
    ds_read_b64_tr_b16 a[238:239], v247 offset:44288
    v_lshlrev_b32 v224, 6, v230
    v_min_u32 v224, 13312, v224
    s_and_b32 s70, s30, 3
    s_lshl2_add_u32 s70, s31, s70
    s_lshl2_add_u32 s70, s70, s3
    s_mul_i32 s70, s70, 14336
    buffer_load_dword v225, v224, s[44:47], s70 offen offset:384
    v_mfma_f32_32x32x16_bf16 v[16:31], a[212:215], a[84:87], v[16:31]
    ds_read_b64_tr_b16 a[240:241], v247 offset:45056
    ds_read_b64_tr_b16 a[242:243], v247 offset:45312
    v_max_f32 v3, 0, v3
    v_max_f32 v4, 0, v4
    v_max_f32 v5, 0, v5
    v_mfma_f32_32x32x16_bf16 v[16:31], a[216:219], a[88:91], v[16:31]
    ds_read_b64_tr_b16 a[244:245], v247 offset:46080
    ds_read_b64_tr_b16 a[246:247], v247 offset:46336
    v_max_f32 v6, 0, v6
    v_max_f32 v7, 0, v7
    v_mul_f32 v0, v0, v8
    v_mul_f32_e64 v1, v1, v9
    v_mfma_f32_32x32x16_bf16 v[16:31], a[220:223], a[92:95], v[16:31]
    ds_read_b64_tr_b16 a[248:249], v247 offset:47104
    ds_read_b64_tr_b16 a[250:251], v247 offset:47360
    v_mul_f32 v2, v2, v10
    v_mul_f32 v3, v3, v11
    v_mul_f32 v4, v4, v12
    s_waitcnt lgkmcnt(6)
    v_mfma_f32_32x32x16_bf16 v[16:31], a[224:227], a[96:99], v[16:31]
    ds_read_b64_tr_b16 a[252:253], v247 offset:48128
    ds_read_b64_tr_b16 a[254:255], v247 offset:48384
    v_mul_f32 v5, v5, v13
    v_mul_f32 v6, v6, v14
    v_mul_f32_e64 v7, v7, v15
    v_cvt_pk_bf16_f32 v0, v0, v1
    v_mfma_f32_32x32x16_bf16 v[16:31], a[228:231], a[100:103], v[16:31]
    v_cvt_pk_bf16_f32 v1, v2, v3
    v_cvt_pk_bf16_f32 v2, v4, v5
    v_cvt_pk_bf16_f32 v3, v6, v7
    v_mfma_f32_32x32x16_bf16 v[16:31], a[232:235], a[104:107], v[16:31]
    buffer_store_dwordx4 v[0:3], v230, s[52:55], s81 offen offset:0 sc1
    v_mfma_f32_32x32x16_bf16 v[16:31], a[236:239], a[108:111], v[16:31]
    s_waitcnt lgkmcnt(0)
    v_mfma_f32_32x32x16_bf16 v[16:31], a[240:243], a[112:115], v[16:31]
    v_mfma_f32_32x32x16_bf16 v[16:31], a[244:247], a[116:119], v[16:31]
    v_mfma_f32_32x32x16_bf16 v[16:31], a[248:251], a[120:123], v[16:31]
    v_mfma_f32_32x32x16_bf16 v[16:31], a[252:255], a[124:127], v[16:31]
    s_nop 11
    v_max_f32 v16, 0, v16
    v_max_f32 v17, 0, v17
    v_max_f32 v18, 0, v18
    v_max_f32 v19, 0, v19
    v_max_f32 v20, 0, v20
    v_max_f32 v21, 0, v21
    v_max_f32 v22, 0, v22
    v_max_f32 v23, 0, v23
    v_mul_f32_e64 v16, v16, v24
    v_mul_f32_e64 v17, v17, v25
    v_mul_f32_e64 v18, v18, v26
    v_mul_f32_e64 v19, v19, v27
    v_mul_f32_e64 v20, v20, v28
    v_mul_f32_e64 v21, v21, v29
    v_mul_f32_e64 v22, v22, v30
    v_mul_f32_e64 v23, v23, v31
    v_cvt_pk_bf16_f32 v16, v16, v17
    v_cvt_pk_bf16_f32 v17, v18, v19
    v_cvt_pk_bf16_f32 v18, v20, v21
    v_cvt_pk_bf16_f32 v19, v22, v23
    buffer_store_dwordx4 v[16:19], v230, s[52:55], s81 offen offset:1024 sc1
    s_barrier
    v_subrev_u32 v237, 65536, v254
    v_subrev_u32 v238, 65536, v255
    s_add_u32 m0, s74, 32768
    s_add_u32 s23, s78, 131072
    buffer_load_dwordx4 v233, s[44:47], s23 offen offset:0 lds
    buffer_load_dwordx4 v123, s[44:47], s23 offen offset:1024 lds
    s_nop 0
    buffer_load_dwordx4 v124, s[44:47], s23 offen offset:2048 lds
    buffer_load_dwordx4 v125, s[44:47], s23 offen offset:3072 lds
    s_add_u32 m0, s74, 36864
    s_add_u32 s23, s78, 163840
    buffer_load_dwordx4 v233, s[44:47], s23 offen offset:0 lds
    buffer_load_dwordx4 v123, s[44:47], s23 offen offset:1024 lds
    buffer_load_dwordx4 v124, s[44:47], s23 offen offset:2048 lds
    buffer_load_dwordx4 v125, s[44:47], s23 offen offset:3072 lds
    s_add_u32 m0, s74, 65536
    s_add_u32 s19, s78, 311296
    buffer_load_dwordx4 v233, s[44:47], s19 offen offset:0 lds
    buffer_load_dwordx4 v123, s[44:47], s19 offen offset:1024 lds
    buffer_load_dwordx4 v124, s[44:47], s19 offen offset:2048 lds
    buffer_load_dwordx4 v125, s[44:47], s19 offen offset:3072 lds
    s_add_u32 m0, s74, 69632
    s_add_u32 s19, s78, 344064
    buffer_load_dwordx4 v233, s[44:47], s19 offen offset:0 lds
    buffer_load_dwordx4 v123, s[44:47], s19 offen offset:1024 lds
    s_waitcnt vmcnt(19)
    v_mov_b32_e64 v228, s68
    s_waitcnt vmcnt(14)
    buffer_store_dword v228, off, s[52:55], s24 sc1
    buffer_load_dwordx4 v124, s[44:47], s19 offen offset:2048 lds
    buffer_load_dwordx4 v125, s[44:47], s19 offen offset:3072 lds
    s_add_u32 m0, s74, 98304
    s_add_u32 s0, s79, 98304
    buffer_load_dwordx4 v233, s[48:51], s0 offen offset:0 lds
    buffer_load_dwordx4 v123, s[48:51], s0 offen offset:1024 lds
    buffer_load_dwordx4 v124, s[48:51], s0 offen offset:2048 lds
    buffer_load_dwordx4 v125, s[48:51], s0 offen offset:3072 lds
    s_add_u32 m0, s74, 102400
    s_add_u32 s0, s78, 196608
    buffer_load_dwordx4 v233, s[44:47], s0 offen offset:0 lds
    buffer_load_dwordx4 v123, s[44:47], s0 offen offset:1024 lds
    buffer_load_dwordx4 v124, s[44:47], s0 offen offset:2048 lds
    buffer_load_dwordx4 v125, s[44:47], s0 offen offset:3072 lds
    s_load_dwordx8 s[60:67], s[52:53], s8 glc
    s_waitcnt vmcnt(17)
    ds_read_b64_tr_b16 v[64:65], v248 offset:32768
    ds_read_b64_tr_b16 v[66:67], v248 offset:33792
    ds_read_b64_tr_b16 v[68:69], v249 offset:32768
    s_nop 0
    ds_read_b64_tr_b16 v[70:71], v249 offset:33792
    ds_read_b64_tr_b16 v[72:73], v248 offset:34816
    ds_read_b64_tr_b16 v[74:75], v248 offset:35840
    ds_read_b64_tr_b16 v[76:77], v249 offset:34816
    ds_read_b64_tr_b16 v[78:79], v249 offset:35840
    ds_read_b64_tr_b16 v[80:81], v248 offset:36864
    ds_read_b64_tr_b16 v[82:83], v248 offset:37888
    ds_read_b64_tr_b16 v[84:85], v249 offset:36864
    ds_read_b64_tr_b16 v[86:87], v249 offset:37888
    ds_read_b64_tr_b16 v[88:89], v248 offset:38912
    ds_read_b64_tr_b16 v[90:91], v248 offset:39936
    ds_read_b64_tr_b16 v[92:93], v249 offset:38912
    ds_read_b64_tr_b16 v[94:95], v249 offset:39936
    s_waitcnt vmcnt(8)
    ds_read_b64_tr_b16 a[176:177], v237 offset:0
    ds_read_b64_tr_b16 a[178:179], v237 offset:1024
    s_nop 0
    ds_read_b64_tr_b16 a[180:181], v238 offset:0
    ds_read_b64_tr_b16 a[182:183], v238 offset:1024
    ds_read_b64_tr_b16 a[184:185], v237 offset:2048
    ds_read_b64_tr_b16 a[186:187], v237 offset:3072
    ds_read_b64_tr_b16 a[188:189], v238 offset:2048
    ds_read_b64_tr_b16 a[190:191], v238 offset:3072
    ds_read_b64_tr_b16 a[192:193], v237 offset:4096
    ds_read_b64_tr_b16 a[194:195], v237 offset:5120
    ds_read_b64_tr_b16 a[196:197], v238 offset:4096
    ds_read_b64_tr_b16 a[198:199], v238 offset:5120
    ds_read_b64_tr_b16 a[200:201], v237 offset:6144
    ds_read_b64_tr_b16 a[202:203], v237 offset:7168
    ds_read_b64_tr_b16 a[204:205], v238 offset:6144
    ds_read_b64_tr_b16 a[206:207], v238 offset:7168
    s_waitcnt lgkmcnt(0)
    s_mov_b32 s7, 0
L_sck_18:
    s_waitcnt lgkmcnt(0)
    s_cmp_eq_u64 s[60:61], s[86:87]
    s_cbranch_scc0 L_slp_17
    s_cmp_eq_u64 s[62:63], s[86:87]
    s_cbranch_scc0 L_slp_17
    s_cmp_eq_u64 s[64:65], s[86:87]
    s_cbranch_scc0 L_slp_17
    s_cmp_eq_u64 s[66:67], s[86:87]
    s_cbranch_scc1 L_sok_16
L_slp_17:
    s_add_u32 s7, s7, 1
    s_cmp_gt_u32 s7, 0x40000
    s_cbranch_scc1 L_sok_16
    s_load_dwordx8 s[60:67], s[52:53], s8 glc
    s_branch L_sck_18
L_sok_16:
    s_add_u32 s8, s9, 16384
    s_load_dwordx8 s[60:67], s[52:53], s8 glc
    s_add_u32 s25, s82, 0
    buffer_load_dwordx4 a[0:3], v230, s[52:55], s25 offen offset:0 sc1
    s_add_u32 s20, s21, 0
    buffer_load_dwordx4 a[4:7], v230, s[52:55], s20 offen offset:0 sc1
    buffer_load_dwordx4 a[8:11], v230, s[52:55], s25 offen offset:1024 sc1
    buffer_load_dwordx4 a[12:15], v230, s[52:55], s20 offen offset:1024 sc1
    buffer_load_dwordx4 a[16:19], v230, s[52:55], s25 offen offset:2048 sc1
    buffer_load_dwordx4 a[20:23], v230, s[52:55], s20 offen offset:2048 sc1
    buffer_load_dwordx4 a[24:27], v230, s[52:55], s25 offen offset:3072 sc1
    buffer_load_dwordx4 a[28:31], v230, s[52:55], s20 offen offset:3072 sc1
L_phase2:
    v_add_u32 v241, s74, v230
    s_waitcnt vmcnt(6)
    v_mfma_f32_32x32x16_bf16 v[0:15], a[128:131], a[0:3], 0
    s_add_u32 m0, s74, 32768
    s_add_u32 s0, s78, 229376
    buffer_load_dwordx4 v233, s[44:47], s0 offen offset:0 lds
    v_mfma_f32_32x32x16_bf16 v[16:31], a[132:135], a[0:3], 0
    s_add_u32 s25, s82, 8192
    buffer_load_dwordx4 a[32:35], v230, s[52:55], s25 offen offset:0 sc1
    v_mfma_f32_32x32x16_bf16 v[32:47], a[128:131], a[4:7], 0
    s_add_u32 s20, s21, 8192
    buffer_load_dwordx4 a[36:39], v230, s[52:55], s20 offen offset:0 sc1
    v_mfma_f32_32x32x16_bf16 v[48:63], a[132:135], a[4:7], 0
    buffer_load_dwordx4 a[40:43], v230, s[52:55], s25 offen offset:1024 sc1
    v_mov_b32 v228, s68
    s_waitcnt vmcnt(6)
    buffer_store_dword v228, off, s[52:55], s15 sc1
    v_mfma_f32_32x32x16_bf16 v[0:15], a[136:139], a[8:11], v[0:15]
    buffer_load_dwordx4 v123, s[44:47], s0 offen offset:1024 lds
    v_mfma_f32_32x32x16_bf16 v[16:31], a[140:143], a[8:11], v[16:31]
    buffer_load_dwordx4 a[44:47], v230, s[52:55], s20 offen offset:1024 sc1
    v_mfma_f32_32x32x16_bf16 v[32:47], a[136:139], a[12:15], v[32:47]
    buffer_load_dwordx4 a[48:51], v230, s[52:55], s25 offen offset:2048 sc1
    v_mfma_f32_32x32x16_bf16 v[48:63], a[140:143], a[12:15], v[48:63]
    buffer_load_dwordx4 a[52:55], v230, s[52:55], s20 offen offset:2048 sc1
    v_mfma_f32_32x32x16_bf16 v[0:15], a[144:147], a[16:19], v[0:15]
    buffer_load_dwordx4 v124, s[44:47], s0 offen offset:2048 lds
    v_mfma_f32_32x32x16_bf16 v[16:31], a[148:151], a[16:19], v[16:31]
    buffer_load_dwordx4 v125, s[44:47], s0 offen offset:3072 lds
    v_mfma_f32_32x32x16_bf16 v[32:47], a[144:147], a[20:23], v[32:47]
    buffer_load_dwordx4 a[56:59], v230, s[52:55], s25 offen offset:3072 sc1
    v_mfma_f32_32x32x16_bf16 v[48:63], a[148:151], a[20:23], v[48:63]
    buffer_load_dwordx4 a[60:63], v230, s[52:55], s20 offen offset:3072 sc1
    s_waitcnt vmcnt(13)
    v_mfma_f32_32x32x16_bf16 v[0:15], a[152:155], a[24:27], v[0:15]
    s_add_u32 m0, s74, 36864
    s_add_u32 s0, s78, 65536
    buffer_load_dwordx4 v233, s[44:47], s0 offen offset:0 lds
    v_mfma_f32_32x32x16_bf16 v[16:31], a[156:159], a[24:27], v[16:31]
    buffer_load_dwordx4 v123, s[44:47], s0 offen offset:1024 lds
    s_nop 0
    v_mfma_f32_32x32x16_bf16 v[32:47], a[152:155], a[28:31], v[32:47]
    s_add_u32 s25, s82, 16384
    buffer_load_dwordx4 a[64:67], v230, s[52:55], s25 offen offset:0 sc1
    v_mfma_f32_32x32x16_bf16 v[48:63], a[156:159], a[28:31], v[48:63]
    s_add_u32 s20, s21, 16384
    buffer_load_dwordx4 a[68:71], v230, s[52:55], s20 offen offset:0 sc1
    s_mov_b32 s7, 0
L_sck_21:
    s_waitcnt lgkmcnt(0)
    s_cmp_eq_u64 s[60:61], s[86:87]
    s_cbranch_scc0 L_slp_20
    s_cmp_eq_u64 s[62:63], s[86:87]
    s_cbranch_scc0 L_slp_20
    s_cmp_eq_u64 s[64:65], s[86:87]
    s_cbranch_scc0 L_slp_20
    s_cmp_eq_u64 s[66:67], s[86:87]
    s_cbranch_scc1 L_sok_19
L_slp_20:
    s_add_u32 s7, s7, 1
    s_cmp_gt_u32 s7, 0x40000
    s_cbranch_scc1 L_sok_19
    s_load_dwordx8 s[60:67], s[52:53], s8 glc
    s_branch L_sck_21
L_sok_19:
    s_waitcnt vmcnt(14)
    v_mfma_f32_32x32x16_bf16 v[0:15], v[64:67], a[32:35], v[0:15]
    buffer_load_dwordx4 v124, s[44:47], s0 offen offset:2048 lds
    v_mfma_f32_32x32x16_bf16 v[16:31], v[68:71], a[32:35], v[16:31]
    buffer_load_dwordx4 v125, s[44:47], s0 offen offset:3072 lds
    v_mfma_f32_32x32x16_bf16 v[32:47], v[64:67], a[36:39], v[32:47]
    buffer_load_dwordx4 a[72:75], v230, s[52:55], s25 offen offset:1024 sc1
    v_mfma_f32_32x32x16_bf16 v[48:63], v[68:71], a[36:39], v[48:63]
    buffer_load_dwordx4 a[76:79], v230, s[52:55], s20 offen offset:1024 sc1
    s_barrier
    s_waitcnt vmcnt(14)
    v_mfma_f32_32x32x16_bf16 v[0:15], v[72:75], a[40:43], v[0:15]
    s_add_u32 m0, s74, 65536
    s_add_u32 s0, s78, 98304
    buffer_load_dwordx4 v233, s[44:47], s0 offen offset:0 lds
    v_mfma_f32_32x32x16_bf16 v[16:31], v[76:79], a[40:43], v[16:31]
    buffer_load_dwordx4 v123, s[44:47], s0 offen offset:1024 lds
    v_mfma_f32_32x32x16_bf16 v[32:47], v[72:75], a[44:47], v[32:47]
    buffer_load_dwordx4 a[80:83], v230, s[52:55], s25 offen offset:2048 sc1
    v_mfma_f32_32x32x16_bf16 v[48:63], v[76:79], a[44:47], v[48:63]
    buffer_load_dwordx4 a[84:87], v230, s[52:55], s20 offen offset:2048 sc1
    s_waitcnt vmcnt(16)
    v_mfma_f32_32x32x16_bf16 v[0:15], v[80:83], a[48:51], v[0:15]
    buffer_load_dwordx4 v124, s[44:47], s0 offen offset:2048 lds
    v_mfma_f32_32x32x16_bf16 v[16:31], v[84:87], a[48:51], v[16:31]
    buffer_load_dwordx4 v125, s[44:47], s0 offen offset:3072 lds
    v_mfma_f32_32x32x16_bf16 v[32:47], v[80:83], a[52:55], v[32:47]
    s_nop 0
    buffer_load_dwordx4 a[88:91], v230, s[52:55], s25 offen offset:3072 sc1
    v_mfma_f32_32x32x16_bf16 v[48:63], v[84:87], a[52:55], v[48:63]
    buffer_load_dwordx4 a[92:95], v230, s[52:55], s20 offen offset:3072 sc1
    s_waitcnt vmcnt(16)
    v_mfma_f32_32x32x16_bf16 v[0:15], v[88:91], a[56:59], v[0:15]
    s_add_u32 m0, s74, 69632
    s_add_u32 s0, s78, 393216
    buffer_load_dwordx4 v233, s[44:47], s0 offen offset:0 lds
    s_nop 0
    v_mfma_f32_32x32x16_bf16 v[16:31], v[92:95], a[56:59], v[16:31]
    buffer_load_dwordx4 v123, s[44:47], s0 offen offset:1024 lds
    v_mfma_f32_32x32x16_bf16 v[32:47], v[88:91], a[60:63], v[32:47]
    s_add_u32 s25, s82, 20480
    buffer_load_dwordx4 a[96:99], v230, s[52:55], s25 offen offset:0 sc1
    v_mfma_f32_32x32x16_bf16 v[48:63], v[92:95], a[60:63], v[48:63]
    s_add_u32 s20, s21, 20480
    s_nop 0
    buffer_load_dwordx4 a[100:103], v230, s[52:55], s20 offen offset:0 sc1
    s_waitcnt vmcnt(16)
    v_mfma_f32_32x32x16_bf16 v[0:15], v[96:99], a[64:67], v[0:15]
    buffer_load_dwordx4 v124, s[44:47], s0 offen offset:2048 lds
    v_mfma_f32_32x32x16_bf16 v[16:31], v[100:103], a[64:67], v[16:31]
    buffer_load_dwordx4 v125, s[44:47], s0 offen offset:3072 lds
    v_mfma_f32_32x32x16_bf16 v[32:47], v[96:99], a[68:71], v[32:47]
    buffer_load_dwordx4 a[104:107], v230, s[52:55], s25 offen offset:1024 sc1
    v_mfma_f32_32x32x16_bf16 v[48:63], v[100:103], a[68:71], v[48:63]
    buffer_load_dwordx4 a[108:111], v230, s[52:55], s20 offen offset:1024 sc1
    s_waitcnt vmcnt(16)
    v_mfma_f32_32x32x16_bf16 v[0:15], v[104:107], a[72:75], v[0:15]
    buffer_load_dwordx4 a[112:115], v230, s[52:55], s25 offen offset:2048 sc1
    v_mfma_f32_32x32x16_bf16 v[16:31], v[108:111], a[72:75], v[16:31]
    buffer_load_dwordx4 a[116:119], v230, s[52:55], s20 offen offset:2048 sc1
    v_mfma_f32_32x32x16_bf16 v[32:47], v[104:107], a[76:79], v[32:47]
    v_mfma_f32_32x32x16_bf16 v[48:63], v[108:111], a[76:79], v[48:63]
    s_load_dwordx8 s[60:67], s[52:53], s9 glc
    s_waitcnt vmcnt(14)
    v_mfma_f32_32x32x16_bf16 v[0:15], v[112:115], a[80:83], v[0:15]
    buffer_load_dwordx4 a[120:123], v230, s[52:55], s25 offen offset:3072 sc1
    v_mfma_f32_32x32x16_bf16 v[16:31], v[116:119], a[80:83], v[16:31]
    buffer_load_dwordx4 a[124:127], v230, s[52:55], s20 offen offset:3072 sc1
    v_mfma_f32_32x32x16_bf16 v[32:47], v[112:115], a[84:87], v[32:47]
    v_mfma_f32_32x32x16_bf16 v[48:63], v[116:119], a[84:87], v[48:63]
    s_waitcnt vmcnt(12)
    v_mfma_f32_32x32x16_bf16 v[0:15], a[176:179], a[88:91], v[0:15]
    s_add_u32 s25, s83, 0
    buffer_load_dwordx4 a[0:3], v230, s[52:55], s25 offen offset:0 sc1
    v_mfma_f32_32x32x16_bf16 v[16:31], a[180:183], a[88:91], v[16:31]
    s_add_u32 s20, s22, 0
    buffer_load_dwordx4 a[4:7], v230, s[52:55], s20 offen offset:0 sc1
    v_mfma_f32_32x32x16_bf16 v[32:47], a[176:179], a[92:95], v[32:47]
    v_mfma_f32_32x32x16_bf16 v[48:63], a[180:183], a[92:95], v[48:63]
    s_waitcnt vmcnt(10)
    v_mfma_f32_32x32x16_bf16 v[0:15], a[184:187], a[96:99], v[0:15]
    buffer_load_dwordx4 a[8:11], v230, s[52:55], s25 offen offset:1024 sc1
    v_mfma_f32_32x32x16_bf16 v[16:31], a[188:191], a[96:99], v[16:31]
    buffer_load_dwordx4 a[12:15], v230, s[52:55], s20 offen offset:1024 sc1
    v_mfma_f32_32x32x16_bf16 v[32:47], a[184:187], a[100:103], v[32:47]
    v_mfma_f32_32x32x16_bf16 v[48:63], a[188:191], a[100:103], v[48:63]
    s_mov_b32 s7, 0
L_sck_24:
    s_waitcnt lgkmcnt(0)
    s_cmp_eq_u64 s[60:61], s[86:87]
    s_cbranch_scc0 L_slp_23
    s_cmp_eq_u64 s[62:63], s[86:87]
    s_cbranch_scc0 L_slp_23
    s_cmp_eq_u64 s[64:65], s[86:87]
    s_cbranch_scc0 L_slp_23
    s_cmp_eq_u64 s[66:67], s[86:87]
    s_cbranch_scc1 L_sok_22
L_slp_23:
    s_add_u32 s7, s7, 1
    s_cmp_gt_u32 s7, 0x40000
    s_cbranch_scc1 L_sok_22
    s_load_dwordx8 s[60:67], s[52:53], s9 glc
    s_branch L_sck_24
L_sok_22:
    s_waitcnt vmcnt(8)
    v_mfma_f32_32x32x16_bf16 v[0:15], a[192:195], a[104:107], v[0:15]
    ds_read_b64_tr_b16 a[232:233], v248 offset:0
    buffer_load_dwordx4 a[16:19], v230, s[52:55], s25 offen offset:2048 sc1
    v_mfma_f32_32x32x16_bf16 v[16:31], a[196:199], a[104:107], v[16:31]
    ds_read_b64_tr_b16 a[234:235], v248 offset:1024
    buffer_load_dwordx4 a[20:23], v230, s[52:55], s20 offen offset:2048 sc1
    v_mfma_f32_32x32x16_bf16 v[32:47], a[192:195], a[108:111], v[32:47]
    ds_read_b64_tr_b16 a[236:237], v249 offset:0
    v_mfma_f32_32x32x16_bf16 v[48:63], a[196:199], a[108:111], v[48:63]
    s_nop 0
    ds_read_b64_tr_b16 a[238:239], v249 offset:1024
    s_waitcnt vmcnt(8)
    v_mfma_f32_32x32x16_bf16 v[0:15], a[200:203], a[112:115], v[0:15]
    ds_read_b64_tr_b16 a[240:241], v248 offset:2048
    buffer_load_dwordx4 a[24:27], v230, s[52:55], s25 offen offset:3072 sc1
    v_mfma_f32_32x32x16_bf16 v[16:31], a[204:207], a[112:115], v[16:31]
    ds_read_b64_tr_b16 a[242:243], v248 offset:3072
    buffer_load_dwordx4 a[28:31], v230, s[52:55], s20 offen offset:3072 sc1
    v_mfma_f32_32x32x16_bf16 v[32:47], a[200:203], a[116:119], v[32:47]
    ds_read_b64_tr_b16 a[244:245], v249 offset:2048
    v_mfma_f32_32x32x16_bf16 v[48:63], a[204:207], a[116:119], v[48:63]
    ds_read_b64_tr_b16 a[246:247], v249 offset:3072
    s_waitcnt vmcnt(8)
    s_waitcnt lgkmcnt(4)
    v_mfma_f32_32x32x16_bf16 v[0:15], a[232:235], a[120:123], v[0:15]
    ds_read_b64_tr_b16 a[248:249], v248 offset:4096
    s_add_u32 s25, s83, 4096
    buffer_load_dwordx4 a[32:35], v230, s[52:55], s25 offen offset:0 sc1
    v_mfma_f32_32x32x16_bf16 v[16:31], a[236:239], a[120:123], v[16:31]
    ds_read_b64_tr_b16 a[250:251], v248 offset:5120
    s_add_u32 s20, s22, 4096
    buffer_load_dwordx4 a[36:39], v230, s[52:55], s20 offen offset:0 sc1
    v_mfma_f32_32x32x16_bf16 v[32:47], a[232:235], a[124:127], v[32:47]
    ds_read_b64_tr_b16 a[252:253], v249 offset:4096
    v_mfma_f32_32x32x16_bf16 v[48:63], a[236:239], a[124:127], v[48:63]
    ds_read_b64_tr_b16 a[254:255], v249 offset:5120
    s_waitcnt vmcnt(8)
    s_waitcnt lgkmcnt(4)
    v_mfma_f32_32x32x16_bf16 v[128:143], a[240:243], a[0:3], 0
    ds_read_b64_tr_b16 a[128:129], v248 offset:6144
    buffer_load_dwordx4 a[40:43], v230, s[52:55], s25 offen offset:1024 sc1
    v_mfma_f32_32x32x16_bf16 v[144:159], a[244:247], a[0:3], 0
    ds_read_b64_tr_b16 a[130:131], v248 offset:7168
    buffer_load_dwordx4 a[44:47], v230, s[52:55], s20 offen offset:1024 sc1
    v_mfma_f32_32x32x16_bf16 v[160:175], a[240:243], a[4:7], 0
    ds_read_b64_tr_b16 a[132:133], v249 offset:6144
    v_mfma_f32_32x32x16_bf16 v[176:191], a[244:247], a[4:7], 0
    ds_read_b64_tr_b16 a[134:135], v249 offset:7168
    s_waitcnt vmcnt(8)
    s_waitcnt lgkmcnt(4)
    v_mfma_f32_32x32x16_bf16 v[128:143], a[248:251], a[8:11], v[128:143]
    ds_read_b64_tr_b16 a[136:137], v254 offset:0
    buffer_load_dwordx4 a[48:51], v230, s[52:55], s25 offen offset:2048 sc1
    v_mfma_f32_32x32x16_bf16 v[144:159], a[252:255], a[8:11], v[144:159]
    ds_read_b64_tr_b16 a[138:139], v254 offset:1024
    buffer_load_dwordx4 a[52:55], v230, s[52:55], s20 offen offset:2048 sc1
    v_mfma_f32_32x32x16_bf16 v[160:175], a[248:251], a[12:15], v[160:175]
    ds_read_b64_tr_b16 a[140:141], v255 offset:0
    v_mfma_f32_32x32x16_bf16 v[176:191], a[252:255], a[12:15], v[176:191]
    ds_read_b64_tr_b16 a[142:143], v255 offset:1024
    s_waitcnt vmcnt(8)
    s_waitcnt lgkmcnt(4)
    v_mfma_f32_32x32x16_bf16 v[128:143], a[128:131], a[16:19], v[128:143]
    ds_read_b64_tr_b16 a[144:145], v254 offset:2048
    buffer_load_dwordx4 a[56:59], v230, s[52:55], s25 offen offset:3072 sc1
    v_mfma_f32_32x32x16_bf16 v[144:159], a[132:135], a[16:19], v[144:159]
    ds_read_b64_tr_b16 a[146:147], v254 offset:3072
    buffer_load_dwordx4 a[60:63], v230, s[52:55], s20 offen offset:3072 sc1
    v_mfma_f32_32x32x16_bf16 v[160:175], a[128:131], a[20:23], v[160:175]
    ds_read_b64_tr_b16 a[148:149], v255 offset:2048
    v_mfma_f32_32x32x16_bf16 v[176:191], a[132:135], a[20:23], v[176:191]
    ds_read_b64_tr_b16 a[150:151], v255 offset:3072
    s_waitcnt vmcnt(8)
    s_waitcnt lgkmcnt(4)
    v_mfma_f32_32x32x16_bf16 v[128:143], a[136:139], a[24:27], v[128:143]
    ds_read_b64_tr_b16 a[152:153], v254 offset:4096
    s_add_u32 m0, s74, 0
    s_add_u32 s0, s78, 425984
    buffer_load_dwordx4 v233, s[44:47], s0 offen offset:0 lds
    v_mfma_f32_32x32x16_bf16 v[144:159], a[140:143], a[24:27], v[144:159]
    s_nop 0
    ds_read_b64_tr_b16 a[154:155], v254 offset:5120
    buffer_load_dwordx4 v123, s[44:47], s0 offen offset:1024 lds
    v_mfma_f32_32x32x16_bf16 v[160:175], a[136:139], a[28:31], v[160:175]
    ds_read_b64_tr_b16 a[156:157], v255 offset:4096
    s_add_u32 s25, s82, 12288
    buffer_load_dwordx4 a[64:67], v230, s[52:55], s25 offen offset:0 sc1
    v_mfma_f32_32x32x16_bf16 v[176:191], a[140:143], a[28:31], v[176:191]
    ds_read_b64_tr_b16 a[158:159], v255 offset:5120
    s_add_u32 s20, s21, 12288
    buffer_load_dwordx4 a[68:71], v230, s[52:55], s20 offen offset:0 sc1
    s_waitcnt vmcnt(10)
    s_waitcnt lgkmcnt(4)
    v_mfma_f32_32x32x16_bf16 v[128:143], a[144:147], a[32:35], v[128:143]
    ds_read_b64_tr_b16 a[176:177], v237 offset:32768
    buffer_load_dwordx4 v124, s[44:47], s0 offen offset:2048 lds
    v_mfma_f32_32x32x16_bf16 v[144:159], a[148:151], a[32:35], v[144:159]
    ds_read_b64_tr_b16 a[178:179], v237 offset:33792
    buffer_load_dwordx4 v125, s[44:47], s0 offen offset:3072 lds
    v_mfma_f32_32x32x16_bf16 v[160:175], a[144:147], a[36:39], v[160:175]
    ds_read_b64_tr_b16 a[180:181], v238 offset:32768
    buffer_load_dwordx4 a[72:75], v230, s[52:55], s25 offen offset:1024 sc1
    v_mfma_f32_32x32x16_bf16 v[176:191], a[148:151], a[36:39], v[176:191]
    ds_read_b64_tr_b16 a[182:183], v238 offset:33792
    buffer_load_dwordx4 a[76:79], v230, s[52:55], s20 offen offset:1024 sc1
    s_waitcnt vmcnt(12)
    s_waitcnt lgkmcnt(4)
    v_mfma_f32_32x32x16_bf16 v[128:143], a[152:155], a[40:43], v[128:143]
    ds_read_b64_tr_b16 a[184:185], v237 offset:34816
    buffer_load_dwordx4 a[80:83], v230, s[52:55], s25 offen offset:2048 sc1
    v_mfma_f32_32x32x16_bf16 v[144:159], a[156:159], a[40:43], v[144:159]
    ds_read_b64_tr_b16 a[186:187], v237 offset:35840
    buffer_load_dwordx4 a[84:87], v230, s[52:55], s20 offen offset:2048 sc1
    v_mfma_f32_32x32x16_bf16 v[160:175], a[152:155], a[44:47], v[160:175]
    ds_read_b64_tr_b16 a[188:189], v238 offset:34816
    v_mfma_f32_32x32x16_bf16 v[176:191], a[156:159], a[44:47], v[176:191]
    ds_read_b64_tr_b16 a[190:191], v238 offset:35840
    s_waitcnt vmcnt(12)
    s_waitcnt lgkmcnt(4)
    v_mfma_f32_32x32x16_bf16 v[128:143], a[176:179], a[48:51], v[128:143]
    ds_read_b64_tr_b16 a[208:209], v237 offset:36864
    v_lshrrev_b32 v224, 7, v230
    v_lshlrev_b32 v225, 4, v224
    v_xor_b32_e64 v225, v225, v230
    v_and_b32 v225, 0x70, v225
    v_lshl_add_u32 v224, v224, 10, v225
    s_lshl_b32 s70, s30, 16
    s_lshl_b32 s1, s3, 14
    s_add_u32 s70, s70, s1
    s_lshl_b32 s1, s31, 7
    s_add_u32 s70, s70, s1
    s_add_u32 m0, s74, 135168
    s_nop 0
    buffer_load_dwordx4 v224, s[32:35], s70 offen lds
    v_mfma_f32_32x32x16_bf16 v[144:159], a[180:183], a[48:51], v[144:159]
    ds_read_b64_tr_b16 a[210:211], v237 offset:37888
    s_add_u32 s70, s70, 7168
    buffer_load_dwordx4 v224, s[32:35], s70 offen offset:1024 lds
    v_mfma_f32_32x32x16_bf16 v[160:175], a[176:179], a[52:55], v[160:175]
    ds_read_b64_tr_b16 a[212:213], v238 offset:36864
    buffer_load_dwordx4 a[88:91], v230, s[52:55], s25 offen offset:3072 sc1
    v_mfma_f32_32x32x16_bf16 v[176:191], a[180:183], a[52:55], v[176:191]
    ds_read_b64_tr_b16 a[214:215], v238 offset:37888
    buffer_load_dwordx4 a[92:95], v230, s[52:55], s20 offen offset:3072 sc1
    s_waitcnt vmcnt(14)
    s_waitcnt lgkmcnt(4)
    v_mfma_f32_32x32x16_bf16 v[128:143], a[184:187], a[56:59], v[128:143]
    ds_read_b64_tr_b16 a[216:217], v237 offset:38912
    s_add_u32 s25, s82, 4096
    buffer_load_dwordx4 a[96:99], v230, s[52:55], s25 offen offset:0 sc1
    v_mfma_f32_32x32x16_bf16 v[144:159], a[188:191], a[56:59], v[144:159]
    ds_read_b64_tr_b16 a[218:219], v237 offset:39936
    s_add_u32 s20, s21, 4096
    buffer_load_dwordx4 a[100:103], v230, s[52:55], s20 offen offset:0 sc1
    v_mfma_f32_32x32x16_bf16 v[160:175], a[184:187], a[60:63], v[160:175]
    ds_read_b64_tr_b16 a[220:221], v238 offset:38912
    v_mfma_f32_32x32x16_bf16 v[176:191], a[188:191], a[60:63], v[176:191]
    ds_read_b64_tr_b16 a[222:223], v238 offset:39936
    v_add_u32 v239, 131072, v241
    v_add_u32 v240, 65536, v241
    s_waitcnt vmcnt(12)
    s_waitcnt lgkmcnt(4)
    v_mfma_f32_32x32x16_bf16 v[0:15], a[208:211], a[64:67], v[0:15]
    ds_read_b64_tr_b16 a[224:225], v248 offset:32768
    buffer_load_dwordx4 a[104:107], v230, s[52:55], s25 offen offset:1024 sc1
    v_mfma_f32_32x32x16_bf16 v[16:31], a[212:215], a[64:67], v[16:31]
    ds_read_b64_tr_b16 a[226:227], v248 offset:33792
    buffer_load_dwordx4 a[108:111], v230, s[52:55], s20 offen offset:1024 sc1
    v_mfma_f32_32x32x16_bf16 v[32:47], a[208:211], a[68:71], v[32:47]
    ds_read_b64_tr_b16 a[228:229], v249 offset:32768
    ds_write_b128 v239, v[176:179] offset:0
    v_mfma_f32_32x32x16_bf16 v[48:63], a[212:215], a[68:71], v[48:63]
    ds_read_b64_tr_b16 a[230:231], v249 offset:33792
    ds_write_b128 v239, v[180:183] offset:1024
    s_waitcnt vmcnt(10)
    s_waitcnt lgkmcnt(6)
    v_mfma_f32_32x32x16_bf16 v[0:15], a[216:219], a[72:75], v[0:15]
    ds_read_b64_tr_b16 a[232:233], v248 offset:34816
    buffer_load_dwordx4 a[112:115], v230, s[52:55], s25 offen offset:2048 sc1
    v_mfma_f32_32x32x16_bf16 v[16:31], a[220:223], a[72:75], v[16:31]
    ds_read_b64_tr_b16 a[234:235], v248 offset:35840
    buffer_load_dwordx4 a[116:119], v230, s[52:55], s20 offen offset:2048 sc1
    v_mfma_f32_32x32x16_bf16 v[32:47], a[216:219], a[76:79], v[32:47]
    ds_read_b64_tr_b16 a[236:237], v249 offset:34816
    ds_write_b128 v239, v[184:187] offset:2048
    v_mfma_f32_32x32x16_bf16 v[48:63], a[220:223], a[76:79], v[48:63]
    ds_read_b64_tr_b16 a[238:239], v249 offset:35840
    ds_write_b128 v239, v[188:191] offset:3072
    s_waitcnt vmcnt(10)
    s_waitcnt lgkmcnt(7)
    ds_read_b64_tr_b16 a[240:241], v248 offset:36864
    buffer_load_dwordx4 a[120:123], v230, s[52:55], s25 offen offset:3072 sc1
    v_mfma_f32_32x32x16_bf16 v[16:31], a[228:231], a[80:83], v[16:31]
    ds_read_b64_tr_b16 a[242:243], v248 offset:37888
    buffer_load_dwordx4 a[124:127], v230, s[52:55], s20 offen offset:3072 sc1
    v_mfma_f32_32x32x16_bf16 v[32:47], a[224:227], a[84:87], v[32:47]
    ds_read_b64_tr_b16 a[244:245], v249 offset:36864
    ds_write_b128 v241, v[160:163] offset:4096
    v_mfma_f32_32x32x16_bf16 v[48:63], a[228:231], a[84:87], v[48:63]
    ds_read_b64_tr_b16 a[246:247], v249 offset:37888
    ds_write_b128 v241, v[164:167] offset:5120
    ds_write_b128 v241, v[168:171] offset:6144
    ds_write_b128 v241, v[172:175] offset:7168
    ds_write_b128 v240, v[144:147] offset:32768
    ds_write_b128 v240, v[148:151] offset:33792
    ds_write_b128 v240, v[152:155] offset:34816
    ds_write_b128 v240, v[156:159] offset:35840
    v_and_b32 v224, 0x1f0, v230
    v_lshlrev_b32 v224, 3, v224
    v_lshrrev_b32 v225, 9, v230
    v_lshl_add_u32 v224, v225, 3, v224
    v_and_b32 v226, 0x100, v230
    v_mul_u32_u24_e64 v226, 24, v226
    s_lshl_b32 s70, s11, 14
    s_and_b32 s71, s3, 1
    s_lshl_b32 s71, s71, 6
    s_add_u32 s70, s70, s71
    s_add_u32 s70, s70, 135168
    v_add3_u32 v224, v224, v226, s70
    v_xor_b32 v232, 8192, v241
    v_xor_b32 v234, 16384, v241
    v_xor_b32 v235, 24576, v241
    v_add_u32 v236, 98304, v232
    v_add_u32 v244, 131072, v235
    s_waitcnt vmcnt(10)
    s_waitcnt lgkmcnt(0)
    s_barrier
    s_waitcnt vmcnt(8)
    ds_read_b64_tr_b16 a[248:249], v248 offset:38912
    s_add_u32 s25, s82, 24576
    buffer_load_dwordx4 a[0:3], v230, s[52:55], s25 offen offset:0 sc1
    ds_read_b128 v[64:67], v236 offset:0
    ds_read_b128 v[68:71], v236 offset:1024
    ds_read_b128 v[72:75], v236 offset:2048
    v_mfma_f32_32x32x16_bf16 v[16:31], a[236:239], a[88:91], v[16:31]
    ds_read_b64_tr_b16 a[250:251], v248 offset:39936
    s_add_u32 s20, s21, 24576
    buffer_load_dwordx4 a[4:7], v230, s[52:55], s20 offen offset:0 sc1
    ds_read_b128 v[76:79], v236 offset:3072
    ds_read_b128 v[80:83], v234 offset:4096
    ds_read_b128 v[84:87], v234 offset:5120
    v_mfma_f32_32x32x16_bf16 v[32:47], a[232:235], a[92:95], v[32:47]
    ds_read_b64_tr_b16 a[252:253], v249 offset:38912
    ds_read_b128 v[88:91], v234 offset:6144
    ds_read_b128 v[92:95], v234 offset:7168
    v_and_b32 v225, 0x70, v230
    v_mfma_f32_32x32x16_bf16 v[48:63], a[236:239], a[92:95], v[48:63]
    ds_read_b64_tr_b16 a[254:255], v249 offset:39936
    v_xor_b32 v224, v224, v225
    v_xor_b32 v225, 16, v224
    v_xor_b32 v226, 32, v224
    s_waitcnt vmcnt(8)
    ds_read_b64_tr_b16 a[128:129], v237 offset:0
    buffer_load_dwordx4 a[8:11], v230, s[52:55], s25 offen offset:1024 sc1
    v_xor_b32_e64 v227, 48, v224
    ds_read_b64 v[192:193], v224
    ds_read_b64 v[194:195], v225
    v_mfma_f32_32x32x16_bf16 v[16:31], a[244:247], a[96:99], v[16:31]
    ds_read_b64_tr_b16 a[130:131], v237 offset:1024
    buffer_load_dwordx4 a[12:15], v230, s[52:55], s20 offen offset:1024 sc1
    ds_read_b64 v[196:197], v226
    ds_read_b64 v[198:199], v227
    ds_read_b128 v[96:99], v244 offset:0
    v_mfma_f32_32x32x16_bf16 v[32:47], a[240:243], a[100:103], v[32:47]
    ds_read_b64_tr_b16 a[132:133], v238 offset:0
    ds_read_b128 v[100:103], v244 offset:1024
    ds_read_b128 v[104:107], v244 offset:2048
    ds_read_b128 v[108:111], v244 offset:3072
    v_mfma_f32_32x32x16_bf16 v[48:63], a[244:247], a[100:103], v[48:63]
    ds_read_b64_tr_b16 a[134:135], v238 offset:1024
    v_add_u32 v245, 65536, v235
    v_and_b32 v246, 0x1f0, v230
    v_lshlrev_b32 v246, 6, v246
    s_waitcnt vmcnt(8)
    s_waitcnt lgkmcnt(12)
    ds_read_b64_tr_b16 a[136:137], v237 offset:2048
    buffer_load_dwordx4 a[16:19], v230, s[52:55], s25 offen offset:2048 sc1
    v_lshrrev_b32 v247, 9, v230
    v_lshl_add_u32 v246, v247, 4, v246
    v_mfma_f32_32x32x16_bf16 v[16:31], a[252:255], a[104:107], v[16:31]
    ds_read_b64_tr_b16 a[138:139], v237 offset:3072
    buffer_load_dwordx4 a[20:23], v230, s[52:55], s20 offen offset:2048 sc1
    v_add_f32 v128, v128, v64
    v_add_f32 v129, v129, v65
    v_add_f32 v130, v130, v66
    v_mfma_f32_32x32x16_bf16 v[32:47], a[248:251], a[108:111], v[32:47]
    ds_read_b64_tr_b16 a[140:141], v238 offset:2048
    v_add_f32 v131, v131, v67
    v_add_f32 v132, v132, v68
    v_add_f32 v133, v133, v69
    v_mfma_f32_32x32x16_bf16 v[48:63], a[252:255], a[108:111], v[48:63]
    ds_read_b64_tr_b16 a[142:143], v238 offset:3072
    v_add_f32 v134, v134, v70
    v_add_f32 v135, v135, v71
    v_add_f32_e64 v136, v136, v72
    s_waitcnt vmcnt(8)
    s_waitcnt lgkmcnt(4)
    ds_read_b64_tr_b16 a[144:145], v237 offset:4096
    ds_read_b64_tr_b16 a[146:147], v237 offset:5120
    buffer_load_dwordx4 a[24:27], v230, s[52:55], s25 offen offset:3072 sc1
    v_add_f32 v137, v137, v73
    v_add_f32 v138, v138, v74
    v_add_f32 v139, v139, v75
    v_mfma_f32_32x32x16_bf16 v[16:31], a[132:135], a[112:115], v[16:31]
    ds_read_b64_tr_b16 a[148:149], v238 offset:4096
    ds_read_b64_tr_b16 a[150:151], v238 offset:5120
    buffer_load_dwordx4 a[28:31], v230, s[52:55], s20 offen offset:3072 sc1
    v_add_f32 v140, v140, v76
    v_add_f32 v141, v141, v77
    v_add_f32 v142, v142, v78
    v_mfma_f32_32x32x16_bf16 v[32:47], a[128:131], a[116:119], v[32:47]
    ds_read_b64_tr_b16 a[152:153], v237 offset:6144
    ds_read_b64_tr_b16 a[154:155], v237 offset:7168
    v_add_f32 v143, v143, v79
    v_add_f32 v80, v80, v96
    v_mfma_f32_32x32x16_bf16 v[48:63], a[132:135], a[116:119], v[48:63]
    ds_read_b64_tr_b16 a[156:157], v238 offset:6144
    ds_read_b64_tr_b16 a[158:159], v238 offset:7168
    v_add_f32 v81, v81, v97
    v_add_f32 v82, v82, v98
    v_add_f32 v83, v83, v99
    s_waitcnt vmcnt(8)
    s_waitcnt lgkmcnt(8)
    ds_read_b64_tr_b16 a[176:177], v248 offset:0
    ds_read_b64_tr_b16 a[178:179], v248 offset:1024
    v_add_f32 v84, v84, v100
    v_add_f32 v85, v85, v101
    v_add_f32 v86, v86, v102
    v_mfma_f32_32x32x16_bf16 v[16:31], a[140:143], a[120:123], v[16:31]
    ds_read_b64_tr_b16 a[180:181], v249 offset:0
    ds_read_b64_tr_b16 a[182:183], v249 offset:1024
    v_add_f32 v87, v87, v103
    v_add_f32 v88, v88, v104
    v_add_f32 v89, v89, v105
    v_mfma_f32_32x32x16_bf16 v[32:47], a[136:139], a[124:127], v[32:47]
    ds_read_b64_tr_b16 a[184:185], v248 offset:2048
    ds_read_b64_tr_b16 a[186:187], v248 offset:3072
    v_add_f32 v90, v90, v106
    v_add_f32 v91, v91, v107
    v_add_f32 v92, v92, v108
    v_mfma_f32_32x32x16_bf16 v[48:63], a[140:143], a[124:127], v[48:63]
    ds_read_b64_tr_b16 a[188:189], v249 offset:2048
    ds_read_b64_tr_b16 a[190:191], v249 offset:3072
    v_add_f32 v93, v93, v109
    v_add_f32 v94, v94, v110
    v_add_f32 v95, v95, v111
    s_waitcnt lgkmcnt(0)
    s_waitcnt vmcnt(0)
    v_mfma_f32_32x32x16_bf16 v[16:31], a[148:151], a[0:3], v[16:31]
    v_add_f32 v64, v128, v80
    v_add_f32 v65, v129, v81
    v_add_f32 v66, v130, v82
    v_mfma_f32_32x32x16_bf16 v[16:31], a[156:159], a[8:11], v[16:31]
    v_add_f32 v67, v131, v83
    v_add_f32 v68, v132, v84
    v_add_f32 v69, v133, v85
    v_mfma_f32_32x32x16_bf16 v[16:31], a[180:183], a[16:19], v[16:31]
    v_add_f32 v70, v134, v86
    v_add_f32 v71, v135, v87
    v_add_f32 v72, v136, v88
    v_mfma_f32_32x32x16_bf16 v[16:31], a[188:191], a[24:27], v[16:31]
    v_add_f32 v73, v137, v89
    v_add_f32 v74, v138, v90
    v_add_f32 v75, v139, v91
    v_mfma_f32_32x32x16_bf16 v[32:47], a[144:147], a[4:7], v[32:47]
    v_add_f32 v76, v140, v92
    v_add_f32 v77, v141, v93
    v_add_f32 v78, v142, v94
    v_mfma_f32_32x32x16_bf16 v[32:47], a[152:155], a[12:15], v[32:47]
    s_nop 3
    ds_write_b128 v241, v[16:19] offset:32768
    v_add_f32 v79, v143, v95
    v_mfma_f32_32x32x16_bf16 v[32:47], a[176:179], a[20:23], v[32:47]
    ds_write_b128 v241, v[20:23] offset:33792
    v_lshlrev_b32_e64 v200, 16, v192
    v_mfma_f32_32x32x16_bf16 v[32:47], a[184:187], a[28:31], v[32:47]
    ds_write_b128 v241, v[24:27] offset:34816
    ds_write_b128 v241, v[28:31] offset:35840
    v_and_b32 v201, 0xffff0000, v192
    v_mfma_f32_32x32x16_bf16 v[48:63], a[148:151], a[4:7], v[48:63]
    v_lshlrev_b32 v202, 16, v193
    v_and_b32 v203, 0xffff0000, v193
    v_lshlrev_b32_e64 v204, 16, v194
    v_mfma_f32_32x32x16_bf16 v[48:63], a[156:159], a[12:15], v[48:63]
    s_nop 3
    ds_write_b128 v241, v[32:35] offset:36864
    v_and_b32 v205, 0xffff0000, v194
    v_mfma_f32_32x32x16_bf16 v[48:63], a[180:183], a[20:23], v[48:63]
    ds_write_b128 v241, v[36:39] offset:37888
    v_lshlrev_b32_e64 v206, 16, v195
    v_mfma_f32_32x32x16_bf16 v[48:63], a[188:191], a[28:31], v[48:63]
    ds_write_b128 v241, v[40:43] offset:38912
    ds_write_b128 v241, v[44:47] offset:39936
    v_and_b32 v207, 0xffff0000, v195
    v_mfma_f32_32x32x16_bf16 v[0:15], a[224:227], a[80:83], v[0:15]
    v_lshlrev_b32 v208, 16, v196
    v_and_b32 v209, 0xffff0000, v196
    v_lshlrev_b32_e64 v210, 16, v197
    v_and_b32 v211, 0xffff0000, v197
    v_mfma_f32_32x32x16_bf16 v[0:15], a[232:235], a[88:91], v[0:15]
    s_nop 2
    ds_write_b128 v240, v[48:51] offset:0
    ds_write_b128 v240, v[52:55] offset:1024
    v_mfma_f32_32x32x16_bf16 v[0:15], a[240:243], a[96:99], v[0:15]
    ds_write_b128 v240, v[56:59] offset:2048
    ds_write_b128 v240, v[60:63] offset:3072
    v_mfma_f32_32x32x16_bf16 v[0:15], a[248:251], a[104:107], v[0:15]
    s_waitcnt lgkmcnt(0)
    s_barrier
    ds_read_b128 v[144:147], v232 offset:32768
    ds_read_b128 v[148:151], v232 offset:33792
    ds_read_b128 v[152:155], v232 offset:34816
    ds_read_b128 v[156:159], v232 offset:35840
    v_mfma_f32_32x32x16_bf16 v[0:15], a[128:131], a[112:115], v[0:15]
    ds_read_b128 v[160:163], v234 offset:36864
    ds_read_b128 v[164:167], v234 offset:37888
    ds_read_b128 v[168:171], v234 offset:38912
    ds_read_b128 v[172:175], v234 offset:39936
    v_mfma_f32_32x32x16_bf16 v[0:15], a[136:139], a[120:123], v[0:15]
    ds_read_b128 v[176:179], v245 offset:0
    ds_read_b128 v[180:183], v245 offset:1024
    ds_read_b128 v[184:187], v245 offset:2048
    ds_read_b128 v[188:191], v245 offset:3072
    v_mfma_f32_32x32x16_bf16 v[0:15], a[144:147], a[0:3], v[0:15]
    v_lshlrev_b32 v212, 16, v198
    v_and_b32 v213, 0xffff0000, v198
    v_lshlrev_b32 v214, 16, v199
    v_and_b32 v215, 0xffff0000, v199
    v_mfma_f32_32x32x16_bf16 v[0:15], a[152:155], a[8:11], v[0:15]
    s_waitcnt lgkmcnt(4)
    v_add_f32 v144, v144, v160
    v_add_f32 v145, v145, v161
    v_add_f32 v146, v146, v162
    v_add_f32 v147, v147, v163
    v_add_f32 v148, v148, v164
    v_mfma_f32_32x32x16_bf16 v[0:15], a[176:179], a[16:19], v[0:15]
    v_add_f32 v149, v149, v165
    v_add_f32 v150, v150, v166
    v_add_f32 v151, v151, v167
    v_add_f32 v152, v152, v168
    v_add_f32 v153, v153, v169
    v_add_f32 v154, v154, v170
    v_mfma_f32_32x32x16_bf16 v[0:15], a[184:187], a[24:27], v[0:15]
    v_add_f32 v155, v155, v171
    v_add_f32 v156, v156, v172
    v_add_f32 v157, v157, v173
    v_add_f32 v158, v158, v174
    v_add_f32 v159, v159, v175
    s_waitcnt lgkmcnt(0)
    v_add_f32 v144, v144, v176
    v_add_f32 v145, v145, v177
    v_add_f32 v146, v146, v178
    v_add_f32 v147, v147, v179
    v_add_f32 v148, v148, v180
    v_add_f32 v149, v149, v181
    v_add_f32 v150, v150, v182
    v_add_f32 v151, v151, v183
    v_add_f32 v152, v152, v184
    v_add_f32 v153, v153, v185
    v_add_f32 v154, v154, v186
    v_add_f32 v155, v155, v187
    v_add_f32 v156, v156, v188
    v_add_f32 v157, v157, v189
    v_add_f32 v158, v158, v190
    v_add_f32 v159, v159, v191
    s_mov_b32 s70, 0xbfb8aa3b
    s_mov_b32 s71, 0xbfb8aa3b
    v_pk_add_f32 v[0:1], v[0:1], v[144:145]
    v_pk_add_f32 v[2:3], v[2:3], v[146:147]
    v_pk_add_f32 v[4:5], v[4:5], v[148:149]
    v_pk_add_f32 v[6:7], v[6:7], v[150:151]
    v_pk_add_f32 v[8:9], v[8:9], v[152:153]
    v_pk_add_f32 v[10:11], v[10:11], v[154:155]
    v_pk_add_f32 v[12:13], v[12:13], v[156:157]
    v_pk_add_f32 v[14:15], v[14:15], v[158:159]
    v_pk_mul_f32 v[32:33], v[0:1], s[70:71]
    v_pk_mul_f32 v[34:35], v[2:3], s[70:71]
    v_pk_mul_f32 v[36:37], v[4:5], s[70:71]
    v_pk_mul_f32 v[38:39], v[6:7], s[70:71]
    v_pk_mul_f32 v[40:41], v[8:9], s[70:71]
    v_pk_mul_f32 v[42:43], v[10:11], s[70:71]
    v_pk_mul_f32 v[44:45], v[12:13], s[70:71]
    v_pk_mul_f32 v[46:47], v[14:15], s[70:71]
    v_exp_f32 v32, v32
    v_exp_f32 v33, v33
    v_exp_f32 v34, v34
    v_exp_f32 v35, v35
    v_exp_f32 v36, v36
    v_exp_f32 v37, v37
    v_exp_f32 v38, v38
    v_exp_f32 v39, v39
    v_exp_f32 v40, v40
    v_exp_f32 v41, v41
    v_exp_f32 v42, v42
    v_exp_f32 v43, v43
    v_exp_f32 v44, v44
    v_exp_f32 v45, v45
    v_exp_f32 v46, v46
    v_exp_f32 v47, v47
    v_pk_mul_f32 v[0:1], v[0:1], v[64:65]
    v_pk_mul_f32 v[2:3], v[2:3], v[66:67]
    v_pk_mul_f32 v[4:5], v[4:5], v[68:69]
    v_pk_mul_f32 v[6:7], v[6:7], v[70:71]
    v_pk_mul_f32 v[8:9], v[8:9], v[72:73]
    v_pk_mul_f32 v[10:11], v[10:11], v[74:75]
    v_pk_mul_f32 v[12:13], v[12:13], v[76:77]
    v_pk_mul_f32 v[14:15], v[14:15], v[78:79]
    v_pk_add_f32 v[32:33], v[32:33], 1.0 op_sel_hi:[1,0]
    v_pk_add_f32 v[34:35], v[34:35], 1.0 op_sel_hi:[1,0]
    v_pk_add_f32 v[36:37], v[36:37], 1.0 op_sel_hi:[1,0]
    v_pk_add_f32 v[38:39], v[38:39], 1.0 op_sel_hi:[1,0]
    v_pk_add_f32 v[40:41], v[40:41], 1.0 op_sel_hi:[1,0]
    v_pk_add_f32 v[42:43], v[42:43], 1.0 op_sel_hi:[1,0]
    v_pk_add_f32 v[44:45], v[44:45], 1.0 op_sel_hi:[1,0]
    v_pk_add_f32 v[46:47], v[46:47], 1.0 op_sel_hi:[1,0]
    v_rcp_f32 v32, v32
    v_rcp_f32 v33, v33
    v_rcp_f32 v34, v34
    v_rcp_f32 v35, v35
    v_rcp_f32 v36, v36
    v_rcp_f32 v37, v37
    v_rcp_f32 v38, v38
    v_rcp_f32 v39, v39
    v_rcp_f32 v40, v40
    v_rcp_f32 v41, v41
    v_rcp_f32 v42, v42
    v_rcp_f32 v43, v43
    v_rcp_f32 v44, v44
    v_rcp_f32 v45, v45
    v_rcp_f32 v46, v46
    v_rcp_f32 v47, v47
    v_pk_fma_f32 v[0:1], v[0:1], v[32:33], v[200:201]
    v_pk_fma_f32 v[2:3], v[2:3], v[34:35], v[202:203]
    v_pk_fma_f32 v[4:5], v[4:5], v[36:37], v[204:205]
    v_pk_fma_f32 v[6:7], v[6:7], v[38:39], v[206:207]
    v_pk_fma_f32 v[8:9], v[8:9], v[40:41], v[208:209]
    v_pk_fma_f32 v[10:11], v[10:11], v[42:43], v[210:211]
    v_pk_fma_f32 v[12:13], v[12:13], v[44:45], v[212:213]
    v_pk_fma_f32 v[14:15], v[14:15], v[46:47], v[214:215]
    v_cvt_pk_bf16_f32 v16, v0, v1
    v_cvt_pk_bf16_f32 v17, v2, v3
    v_cvt_pk_bf16_f32 v18, v4, v5
    v_cvt_pk_bf16_f32 v19, v6, v7
    v_cvt_pk_bf16_f32 v20, v8, v9
    v_cvt_pk_bf16_f32 v21, v10, v11
    v_cvt_pk_bf16_f32 v22, v12, v13
    v_cvt_pk_bf16_f32 v23, v14, v15
    v_permlane32_swap_b32 v16, v18
    v_permlane32_swap_b32 v17, v19
    v_permlane32_swap_b32 v20, v22
    v_permlane32_swap_b32 v21, v23
    buffer_store_dwordx4 v[16:19], v246, s[56:59], s10 offen offset:0
    buffer_store_dwordx4 v[20:23], v246, s[56:59], s10 offen offset:32
L_end:
    s_endpgm
L_code_end:

.section .rodata,"a"
.p2align 6
.amdhsa_kernel recurrent_scan__linear_kernel_hedgehog__glu_gated_reglu__prompt_kernel
  .amdhsa_next_free_vgpr 512
  .amdhsa_next_free_sgpr 102
  .amdhsa_accum_offset 256
  .amdhsa_group_segment_fixed_size 0
  .amdhsa_kernarg_size 88
  .amdhsa_user_sgpr_count 2
  .amdhsa_user_sgpr_kernarg_segment_ptr 1
  .amdhsa_system_sgpr_workgroup_id_x 1
.end_amdhsa_kernel
```
